```python
import torch

def _softmax(x, axis=-1):
    return torch.softmax(x, dim=axis)

def _gelu(x):
    return torch.nn.functional.gelu(x, approximate='tanh')

def _silu(x):
    return torch.nn.functional.silu(x)

def _sigmoid(x):
    return torch.sigmoid(x)

def _layernorm(x, axis=-1, eps=1e-05):
    m = x.mean(dim=axis, keepdim=True)
    v = x.var(dim=axis, keepdim=True, unbiased=False)
    return (x - m) / torch.sqrt(v + eps)

def _scatter_add(tgt, idx, src, axis=0):
    return tgt.clone().index_add_(axis, idx, src)

def _segment_sum(src, seg, n):
    out = torch.zeros((n,) + src.shape[1:], dtype=src.dtype)
    return out.index_add_(0, seg, src)

def _pad(x, pw):
    flat = tuple((v for pair in reversed(pw) for v in pair))
    return torch.nn.functional.pad(x, flat)
kernel_name = 'sequential_preLN__memory_aug_recurrent_mem_tr__glu_gated_bilinear__prompt'

def setup_inputs():

    _w = lambda a: (lambda t: t.to(torch.bfloat16) if t.is_floating_point() else t)(torch.as_tensor(a))

    def _A_setup():
        B, S, Dm = (1, 2048, 448)
        H, Dh = (16, 256)
        M, seg = (8, 32)
        seg = min(seg, S)
        S = S // seg * seg
        return {'x': _w((lambda *s: torch.randn(*s, dtype=torch.bfloat16) * 0.05)(B, S, Dm)), 'mem0': _w((lambda *s: torch.randn(*s, dtype=torch.bfloat16) * 0.2)(B, M, Dm)), 'Wq': _w((lambda *s: torch.randn(*s, dtype=torch.bfloat16) * 1.6)(Dm, H, Dh) * Dm ** (-0.5)), 'Wk': _w((lambda *s: torch.randn(*s, dtype=torch.bfloat16) * 1.6)(Dm, H, Dh) * Dm ** (-0.5)), 'Wv': _w((lambda *s: torch.randn(*s, dtype=torch.bfloat16) * 0.2)(Dm, H, Dh) * Dm ** (-0.5)), 'Wo': _w((lambda *s: torch.randn(*s, dtype=torch.bfloat16) * 0.2)(H, Dh, Dm) * (H * Dh) ** (-0.5)), 'seg_len': seg}
    _A_in = _A_setup()

    def _B_setup():
        B, S, D, F = (1, 2048, 448, 1792)
        return {'x': _w((lambda *s: torch.randn(*s, dtype=torch.bfloat16) * 0.05)(B, S, D)), 'w_gate': _w((lambda *s: torch.randn(*s, dtype=torch.bfloat16) * 0.2)(D, F) * D ** (-0.5)), 'w_up': _w((lambda *s: torch.randn(*s, dtype=torch.bfloat16) * 0.2)(D, F) * D ** (-0.5)), 'w_down': _w((lambda *s: torch.randn(*s, dtype=torch.bfloat16) * 0.2)(F, D) * F ** (-0.5))}
    _B_in = _B_setup()
    return {'A_x': _A_in['x'], 'A_mem0': _A_in['mem0'], 'A_Wq': _A_in['Wq'], 'A_Wk': _A_in['Wk'], 'A_Wv': _A_in['Wv'], 'A_Wo': _A_in['Wo'], 'A_seg_len': _A_in['seg_len'], 'B_x': _B_in['x'], 'B_w_gate': _B_in['w_gate'], 'B_w_up': _B_in['w_up'], 'B_w_down': _B_in['w_down']}

def reference(A_x, A_mem0, A_Wq, A_Wk, A_Wv, A_Wo, A_seg_len, B_x, B_w_gate, B_w_up, B_w_down):

    def _A_ref(x, mem0, Wq, Wk, Wv, Wo, seg_len):
        B, S, Dm = x.shape
        H, Dh = (Wq.shape[1], Wq.shape[2])
        M = mem0.shape[1]
        scale = Dh ** (-0.5)
        n_seg = S // seg_len
        L = M + seg_len
        idx = torch.arange(L)
        mask = (idx[:, None] < M) | (idx[:, None] >= idx[None, :])
        mem = mem0
        outs = []
        for s in range(n_seg):
            xs = x[:, s * seg_len:(s + 1) * seg_len, :].clone()
            h = torch.concatenate([mem, xs], axis=1)
            q = torch.einsum('btd,dhe->bhte', h, Wq)
            k = torch.einsum('btd,dhe->bhte', h, Wk)
            v = torch.einsum('btd,dhe->bhte', h, Wv)
            scores = torch.einsum('bhqe,bhke->bhqk', q, k) * scale
            scores = torch.where(mask[None, None], scores, -1000000000.0)
            p = _softmax(scores, axis=-1)
            o = torch.einsum('bhqk,bhke->bhqe', p, v)
            o = torch.einsum('bhte,hed->btd', o, Wo)
            mem = o[:, :M, :].clone()
            outs.append(o[:, M:, :])
        return torch.concatenate(outs, axis=1)

    def _B_ref(x, w_gate, w_up, w_down):
        g = torch.einsum('bsd,df->bsf', x, w_gate)
        u = torch.einsum('bsd,df->bsf', x, w_up)
        h = g * u
        return torch.einsum('bsf,fd->bsd', h, w_down)
    x = A_x
    h = x + _A_ref(_layernorm(x, axis=-1), A_mem0, A_Wq, A_Wk, A_Wv, A_Wo, A_seg_len)
    h2 = h + _B_ref(_layernorm(h, axis=-1), B_w_gate, B_w_up, B_w_down)
    return h2
```

```asm
; @launch kernel=prep_kernel grid=(720,1,1) block=(256,1,1) lds=0
; @launch kernel=fold_kernel grid=(336,1,1) block=(256,1,1) lds=0
; @launch kernel=chain_kernel grid=(256,1,1) block=(256,1,1) lds=143616
.amdgcn_target "amdgcn-amd-amdhsa--gfx950"
.text
.globl prep_kernel
.p2align 8
.type prep_kernel,@function
prep_kernel:
    s_cmp_ge_u32 s2, 720
    s_cbranch_scc1 .prep_kernel_end1
    s_load_dwordx4 s[4:7], s[0:1], 0
    s_load_dwordx2 s[8:9], s[0:1], 40
    s_load_dwordx4 s[12:15], s[0:1], 64
    s_load_dwordx2 s[10:11], s[0:1], 80
    s_load_dwordx2 s[16:17], s[0:1], 104
    v_lshrrev_b32 v2, 6, v0
    v_and_b32 v1, 63, v0
    s_nop 0
    v_readfirstlane_b32 s18, v2
    v_lshrrev_b32 v2, 4, v1
    v_and_b32 v3, 15, v1
    s_waitcnt lgkmcnt(0)
    s_cmp_lt_u32 s2, 32
    s_cbranch_scc1 .prep_kernel_ln2
    s_cmp_lt_u32 s2, 144
    s_cbranch_scc1 .prep_kernel_wot6
    s_cmp_lt_u32 s2, 200
    s_cbranch_scc1 .prep_kernel_wg7
    s_cmp_lt_u32 s2, 256
    s_cbranch_scc1 .prep_kernel_wu8
    s_cmp_lt_u32 s2, 312
    s_cbranch_scc1 .prep_kernel_wd9
    s_cmp_lt_u32 s2, 383
    s_cbranch_scc1 .prep_kernel_fill4
    s_cmp_eq_u32 s2, 383
    s_cbranch_scc1 .prep_kernel_misc5
    s_load_dwordx4 s[40:43], s[0:1], 16
    s_load_dwordx2 s[44:45], s[0:1], 32
    s_sub_u32 s30, s2, 384
    s_lshl_b32 s30, s30, 2
    s_add_u32 s30, s30, s18
    s_cmp_ge_u32 s30, 448
    s_cselect_b32 s31, 1, 0
    s_cmp_ge_u32 s30, 896
    s_cselect_b32 s31, 2, s31
    s_mul_i32 s32, s31, 448
    s_sub_u32 s32, s30, s32
    s_mul_i32 s33, s32, 0x925
    s_lshr_b32 s33, s33, 16
    s_mul_i32 s34, s33, 28
    s_sub_u32 s34, s32, s34
    s_waitcnt lgkmcnt(0)
    s_cmp_eq_u32 s31, 1
    s_cselect_b32 s20, s42, s40
    s_cselect_b32 s21, s43, s41
    s_cmp_eq_u32 s31, 2
    s_cselect_b32 s20, s44, s20
    s_cselect_b32 s21, s45, s21
    s_lshl_b32 s35, s34, 17
    s_lshl_b32 s36, s33, 9
    s_add_u32 s35, s35, s36
    s_add_u32 s20, s20, s35
    s_addc_u32 s21, s21, 0
    v_lshlrev_b32 v4, 13, v3
    v_lshl_add_u32 v4, v2, 4, v4
    global_load_dwordx4 v[16:19], v4, s[20:21] offset:0
    global_load_dwordx4 v[20:23], v4, s[20:21] offset:64
    global_load_dwordx4 v[24:27], v4, s[20:21] offset:128
    global_load_dwordx4 v[28:31], v4, s[20:21] offset:192
    global_load_dwordx4 v[32:35], v4, s[20:21] offset:256
    global_load_dwordx4 v[36:39], v4, s[20:21] offset:320
    global_load_dwordx4 v[40:43], v4, s[20:21] offset:384
    global_load_dwordx4 v[44:47], v4, s[20:21] offset:448
    s_mul_i32 s35, s31, 3670016
    s_lshl_b32 s36, s32, 13
    s_add_u32 s35, s35, s36
    s_add_u32 s35, s35, 0x541000
    s_add_u32 s26, s16, s35
    s_addc_u32 s27, s17, 0
    s_add_u32 s28, s26, 0x1000
    s_addc_u32 s29, s27, 0
    v_lshlrev_b32 v5, 4, v1
    s_waitcnt vmcnt(7)
    global_store_dwordx4 v5, v[16:19], s[26:27] offset:0
    s_waitcnt vmcnt(7)
    global_store_dwordx4 v5, v[20:23], s[26:27] offset:1024
    s_waitcnt vmcnt(7)
    global_store_dwordx4 v5, v[24:27], s[26:27] offset:2048
    s_waitcnt vmcnt(7)
    global_store_dwordx4 v5, v[28:31], s[26:27] offset:3072
    s_waitcnt vmcnt(7)
    global_store_dwordx4 v5, v[32:35], s[28:29] offset:0
    s_waitcnt vmcnt(7)
    global_store_dwordx4 v5, v[36:39], s[28:29] offset:1024
    s_waitcnt vmcnt(7)
    global_store_dwordx4 v5, v[40:43], s[28:29] offset:2048
    s_waitcnt vmcnt(7)
    global_store_dwordx4 v5, v[44:47], s[28:29] offset:3072
    s_branch .prep_kernel_end1
.prep_kernel_ln2:
    s_lshl_b32 s19, s2, 2
    s_add_u32 s19, s19, s18
    s_mul_i32 s20, s19, 14336
    v_mul_u32_u24 v4, 896, v3
    v_lshlrev_b32 v5, 3, v2
    v_add3_u32 v4, v4, v5, s20
    global_load_dwordx2 v[10:11], v4, s[4:5] offset:0
    global_load_dwordx2 v[12:13], v4, s[4:5] offset:32
    global_load_dwordx2 v[14:15], v4, s[4:5] offset:64
    global_load_dwordx2 v[16:17], v4, s[4:5] offset:96
    global_load_dwordx2 v[18:19], v4, s[4:5] offset:128
    global_load_dwordx2 v[20:21], v4, s[4:5] offset:160
    global_load_dwordx2 v[22:23], v4, s[4:5] offset:192
    global_load_dwordx2 v[24:25], v4, s[4:5] offset:224
    global_load_dwordx2 v[26:27], v4, s[4:5] offset:256
    global_load_dwordx2 v[28:29], v4, s[4:5] offset:288
    global_load_dwordx2 v[30:31], v4, s[4:5] offset:320
    global_load_dwordx2 v[32:33], v4, s[4:5] offset:352
    global_load_dwordx2 v[34:35], v4, s[4:5] offset:384
    global_load_dwordx2 v[36:37], v4, s[4:5] offset:416
    global_load_dwordx2 v[38:39], v4, s[4:5] offset:448
    global_load_dwordx2 v[40:41], v4, s[4:5] offset:480
    global_load_dwordx2 v[42:43], v4, s[4:5] offset:512
    global_load_dwordx2 v[44:45], v4, s[4:5] offset:544
    global_load_dwordx2 v[46:47], v4, s[4:5] offset:576
    global_load_dwordx2 v[48:49], v4, s[4:5] offset:608
    global_load_dwordx2 v[50:51], v4, s[4:5] offset:640
    global_load_dwordx2 v[52:53], v4, s[4:5] offset:672
    global_load_dwordx2 v[54:55], v4, s[4:5] offset:704
    global_load_dwordx2 v[56:57], v4, s[4:5] offset:736
    global_load_dwordx2 v[58:59], v4, s[4:5] offset:768
    global_load_dwordx2 v[60:61], v4, s[4:5] offset:800
    global_load_dwordx2 v[62:63], v4, s[4:5] offset:832
    global_load_dwordx2 v[64:65], v4, s[4:5] offset:864
    s_waitcnt vmcnt(0)
    v_lshlrev_b32 v70, 16, v10
    v_and_b32 v71, 0xffff0000, v10
    v_lshlrev_b32 v72, 16, v11
    v_and_b32 v73, 0xffff0000, v11
    v_lshlrev_b32 v74, 16, v12
    v_and_b32 v75, 0xffff0000, v12
    v_lshlrev_b32 v76, 16, v13
    v_and_b32 v77, 0xffff0000, v13
    v_lshlrev_b32 v78, 16, v14
    v_and_b32 v79, 0xffff0000, v14
    v_lshlrev_b32 v80, 16, v15
    v_and_b32 v81, 0xffff0000, v15
    v_lshlrev_b32 v82, 16, v16
    v_and_b32 v83, 0xffff0000, v16
    v_lshlrev_b32 v84, 16, v17
    v_and_b32 v85, 0xffff0000, v17
    v_lshlrev_b32 v86, 16, v18
    v_and_b32 v87, 0xffff0000, v18
    v_lshlrev_b32 v88, 16, v19
    v_and_b32 v89, 0xffff0000, v19
    v_lshlrev_b32 v90, 16, v20
    v_and_b32 v91, 0xffff0000, v20
    v_lshlrev_b32 v92, 16, v21
    v_and_b32 v93, 0xffff0000, v21
    v_lshlrev_b32 v94, 16, v22
    v_and_b32 v95, 0xffff0000, v22
    v_lshlrev_b32 v96, 16, v23
    v_and_b32 v97, 0xffff0000, v23
    v_lshlrev_b32 v98, 16, v24
    v_and_b32 v99, 0xffff0000, v24
    v_lshlrev_b32 v100, 16, v25
    v_and_b32 v101, 0xffff0000, v25
    v_lshlrev_b32 v102, 16, v26
    v_and_b32 v103, 0xffff0000, v26
    v_lshlrev_b32 v104, 16, v27
    v_and_b32 v105, 0xffff0000, v27
    v_lshlrev_b32 v106, 16, v28
    v_and_b32 v107, 0xffff0000, v28
    v_lshlrev_b32 v108, 16, v29
    v_and_b32 v109, 0xffff0000, v29
    v_lshlrev_b32 v110, 16, v30
    v_and_b32 v111, 0xffff0000, v30
    v_lshlrev_b32 v112, 16, v31
    v_and_b32 v113, 0xffff0000, v31
    v_lshlrev_b32 v114, 16, v32
    v_and_b32 v115, 0xffff0000, v32
    v_lshlrev_b32 v116, 16, v33
    v_and_b32 v117, 0xffff0000, v33
    v_lshlrev_b32 v118, 16, v34
    v_and_b32 v119, 0xffff0000, v34
    v_lshlrev_b32 v120, 16, v35
    v_and_b32 v121, 0xffff0000, v35
    v_lshlrev_b32 v122, 16, v36
    v_and_b32 v123, 0xffff0000, v36
    v_lshlrev_b32 v124, 16, v37
    v_and_b32 v125, 0xffff0000, v37
    v_lshlrev_b32 v126, 16, v38
    v_and_b32 v127, 0xffff0000, v38
    v_lshlrev_b32 v128, 16, v39
    v_and_b32 v129, 0xffff0000, v39
    v_lshlrev_b32 v130, 16, v40
    v_and_b32 v131, 0xffff0000, v40
    v_lshlrev_b32 v132, 16, v41
    v_and_b32 v133, 0xffff0000, v41
    v_lshlrev_b32 v134, 16, v42
    v_and_b32 v135, 0xffff0000, v42
    v_lshlrev_b32 v136, 16, v43
    v_and_b32 v137, 0xffff0000, v43
    v_lshlrev_b32 v138, 16, v44
    v_and_b32 v139, 0xffff0000, v44
    v_lshlrev_b32 v140, 16, v45
    v_and_b32 v141, 0xffff0000, v45
    v_lshlrev_b32 v142, 16, v46
    v_and_b32 v143, 0xffff0000, v46
    v_lshlrev_b32 v144, 16, v47
    v_and_b32 v145, 0xffff0000, v47
    v_lshlrev_b32 v146, 16, v48
    v_and_b32 v147, 0xffff0000, v48
    v_lshlrev_b32 v148, 16, v49
    v_and_b32 v149, 0xffff0000, v49
    v_lshlrev_b32 v150, 16, v50
    v_and_b32 v151, 0xffff0000, v50
    v_lshlrev_b32 v152, 16, v51
    v_and_b32 v153, 0xffff0000, v51
    v_lshlrev_b32 v154, 16, v52
    v_and_b32 v155, 0xffff0000, v52
    v_lshlrev_b32 v156, 16, v53
    v_and_b32 v157, 0xffff0000, v53
    v_lshlrev_b32 v158, 16, v54
    v_and_b32 v159, 0xffff0000, v54
    v_lshlrev_b32 v160, 16, v55
    v_and_b32 v161, 0xffff0000, v55
    v_lshlrev_b32 v162, 16, v56
    v_and_b32 v163, 0xffff0000, v56
    v_lshlrev_b32 v164, 16, v57
    v_and_b32 v165, 0xffff0000, v57
    v_lshlrev_b32 v166, 16, v58
    v_and_b32 v167, 0xffff0000, v58
    v_lshlrev_b32 v168, 16, v59
    v_and_b32 v169, 0xffff0000, v59
    v_lshlrev_b32 v170, 16, v60
    v_and_b32 v171, 0xffff0000, v60
    v_lshlrev_b32 v172, 16, v61
    v_and_b32 v173, 0xffff0000, v61
    v_lshlrev_b32 v174, 16, v62
    v_and_b32 v175, 0xffff0000, v62
    v_lshlrev_b32 v176, 16, v63
    v_and_b32 v177, 0xffff0000, v63
    v_lshlrev_b32 v178, 16, v64
    v_and_b32 v179, 0xffff0000, v64
    v_lshlrev_b32 v180, 16, v65
    v_and_b32 v181, 0xffff0000, v65
    v_add_f32 v5, v70, v71
    v_add_f32 v5, v5, v72
    v_add_f32 v5, v5, v73
    v_add_f32 v5, v5, v74
    v_add_f32 v5, v5, v75
    v_add_f32 v5, v5, v76
    v_add_f32 v5, v5, v77
    v_add_f32 v5, v5, v78
    v_add_f32 v5, v5, v79
    v_add_f32 v5, v5, v80
    v_add_f32 v5, v5, v81
    v_add_f32 v5, v5, v82
    v_add_f32 v5, v5, v83
    v_add_f32 v5, v5, v84
    v_add_f32 v5, v5, v85
    v_add_f32 v5, v5, v86
    v_add_f32 v5, v5, v87
    v_add_f32 v5, v5, v88
    v_add_f32 v5, v5, v89
    v_add_f32 v5, v5, v90
    v_add_f32 v5, v5, v91
    v_add_f32 v5, v5, v92
    v_add_f32 v5, v5, v93
    v_add_f32 v5, v5, v94
    v_add_f32 v5, v5, v95
    v_add_f32 v5, v5, v96
    v_add_f32 v5, v5, v97
    v_add_f32 v5, v5, v98
    v_add_f32 v5, v5, v99
    v_add_f32 v5, v5, v100
    v_add_f32 v5, v5, v101
    v_add_f32 v5, v5, v102
    v_add_f32 v5, v5, v103
    v_add_f32 v5, v5, v104
    v_add_f32 v5, v5, v105
    v_add_f32 v5, v5, v106
    v_add_f32 v5, v5, v107
    v_add_f32 v5, v5, v108
    v_add_f32 v5, v5, v109
    v_add_f32 v5, v5, v110
    v_add_f32 v5, v5, v111
    v_add_f32 v5, v5, v112
    v_add_f32 v5, v5, v113
    v_add_f32 v5, v5, v114
    v_add_f32 v5, v5, v115
    v_add_f32 v5, v5, v116
    v_add_f32 v5, v5, v117
    v_add_f32 v5, v5, v118
    v_add_f32 v5, v5, v119
    v_add_f32 v5, v5, v120
    v_add_f32 v5, v5, v121
    v_add_f32 v5, v5, v122
    v_add_f32 v5, v5, v123
    v_add_f32 v5, v5, v124
    v_add_f32 v5, v5, v125
    v_add_f32 v5, v5, v126
    v_add_f32 v5, v5, v127
    v_add_f32 v5, v5, v128
    v_add_f32 v5, v5, v129
    v_add_f32 v5, v5, v130
    v_add_f32 v5, v5, v131
    v_add_f32 v5, v5, v132
    v_add_f32 v5, v5, v133
    v_add_f32 v5, v5, v134
    v_add_f32 v5, v5, v135
    v_add_f32 v5, v5, v136
    v_add_f32 v5, v5, v137
    v_add_f32 v5, v5, v138
    v_add_f32 v5, v5, v139
    v_add_f32 v5, v5, v140
    v_add_f32 v5, v5, v141
    v_add_f32 v5, v5, v142
    v_add_f32 v5, v5, v143
    v_add_f32 v5, v5, v144
    v_add_f32 v5, v5, v145
    v_add_f32 v5, v5, v146
    v_add_f32 v5, v5, v147
    v_add_f32 v5, v5, v148
    v_add_f32 v5, v5, v149
    v_add_f32 v5, v5, v150
    v_add_f32 v5, v5, v151
    v_add_f32 v5, v5, v152
    v_add_f32 v5, v5, v153
    v_add_f32 v5, v5, v154
    v_add_f32 v5, v5, v155
    v_add_f32 v5, v5, v156
    v_add_f32 v5, v5, v157
    v_add_f32 v5, v5, v158
    v_add_f32 v5, v5, v159
    v_add_f32 v5, v5, v160
    v_add_f32 v5, v5, v161
    v_add_f32 v5, v5, v162
    v_add_f32 v5, v5, v163
    v_add_f32 v5, v5, v164
    v_add_f32 v5, v5, v165
    v_add_f32 v5, v5, v166
    v_add_f32 v5, v5, v167
    v_add_f32 v5, v5, v168
    v_add_f32 v5, v5, v169
    v_add_f32 v5, v5, v170
    v_add_f32 v5, v5, v171
    v_add_f32 v5, v5, v172
    v_add_f32 v5, v5, v173
    v_add_f32 v5, v5, v174
    v_add_f32 v5, v5, v175
    v_add_f32 v5, v5, v176
    v_add_f32 v5, v5, v177
    v_add_f32 v5, v5, v178
    v_add_f32 v5, v5, v179
    v_add_f32 v5, v5, v180
    v_add_f32 v5, v5, v181
    v_mov_b32 v6, v5
    s_nop 1
    v_permlane32_swap_b32 v5, v6
    s_nop 1
    v_add_f32 v5, v5, v6
    v_mov_b32 v6, v5
    s_nop 1
    v_permlane16_swap_b32 v5, v6
    s_nop 1
    v_add_f32 v5, v5, v6
    v_mul_f32 v5, 0x3b124925, v5
    v_sub_f32 v6, v70, v5
    v_mul_f32 v7, v6, v6
    v_sub_f32 v6, v71, v5
    v_fmac_f32 v7, v6, v6
    v_sub_f32 v6, v72, v5
    v_fmac_f32 v7, v6, v6
    v_sub_f32 v6, v73, v5
    v_fmac_f32 v7, v6, v6
    v_sub_f32 v6, v74, v5
    v_fmac_f32 v7, v6, v6
    v_sub_f32 v6, v75, v5
    v_fmac_f32 v7, v6, v6
    v_sub_f32 v6, v76, v5
    v_fmac_f32 v7, v6, v6
    v_sub_f32 v6, v77, v5
    v_fmac_f32 v7, v6, v6
    v_sub_f32 v6, v78, v5
    v_fmac_f32 v7, v6, v6
    v_sub_f32 v6, v79, v5
    v_fmac_f32 v7, v6, v6
    v_sub_f32 v6, v80, v5
    v_fmac_f32 v7, v6, v6
    v_sub_f32 v6, v81, v5
    v_fmac_f32 v7, v6, v6
    v_sub_f32 v6, v82, v5
    v_fmac_f32 v7, v6, v6
    v_sub_f32 v6, v83, v5
    v_fmac_f32 v7, v6, v6
    v_sub_f32 v6, v84, v5
    v_fmac_f32 v7, v6, v6
    v_sub_f32 v6, v85, v5
    v_fmac_f32 v7, v6, v6
    v_sub_f32 v6, v86, v5
    v_fmac_f32 v7, v6, v6
    v_sub_f32 v6, v87, v5
    v_fmac_f32 v7, v6, v6
    v_sub_f32 v6, v88, v5
    v_fmac_f32 v7, v6, v6
    v_sub_f32 v6, v89, v5
    v_fmac_f32 v7, v6, v6
    v_sub_f32 v6, v90, v5
    v_fmac_f32 v7, v6, v6
    v_sub_f32 v6, v91, v5
    v_fmac_f32 v7, v6, v6
    v_sub_f32 v6, v92, v5
    v_fmac_f32 v7, v6, v6
    v_sub_f32 v6, v93, v5
    v_fmac_f32 v7, v6, v6
    v_sub_f32 v6, v94, v5
    v_fmac_f32 v7, v6, v6
    v_sub_f32 v6, v95, v5
    v_fmac_f32 v7, v6, v6
    v_sub_f32 v6, v96, v5
    v_fmac_f32 v7, v6, v6
    v_sub_f32 v6, v97, v5
    v_fmac_f32 v7, v6, v6
    v_sub_f32 v6, v98, v5
    v_fmac_f32 v7, v6, v6
    v_sub_f32 v6, v99, v5
    v_fmac_f32 v7, v6, v6
    v_sub_f32 v6, v100, v5
    v_fmac_f32 v7, v6, v6
    v_sub_f32 v6, v101, v5
    v_fmac_f32 v7, v6, v6
    v_sub_f32 v6, v102, v5
    v_fmac_f32 v7, v6, v6
    v_sub_f32 v6, v103, v5
    v_fmac_f32 v7, v6, v6
    v_sub_f32 v6, v104, v5
    v_fmac_f32 v7, v6, v6
    v_sub_f32 v6, v105, v5
    v_fmac_f32 v7, v6, v6
    v_sub_f32 v6, v106, v5
    v_fmac_f32 v7, v6, v6
    v_sub_f32 v6, v107, v5
    v_fmac_f32 v7, v6, v6
    v_sub_f32 v6, v108, v5
    v_fmac_f32 v7, v6, v6
    v_sub_f32 v6, v109, v5
    v_fmac_f32 v7, v6, v6
    v_sub_f32 v6, v110, v5
    v_fmac_f32 v7, v6, v6
    v_sub_f32 v6, v111, v5
    v_fmac_f32 v7, v6, v6
    v_sub_f32 v6, v112, v5
    v_fmac_f32 v7, v6, v6
    v_sub_f32 v6, v113, v5
    v_fmac_f32 v7, v6, v6
    v_sub_f32 v6, v114, v5
    v_fmac_f32 v7, v6, v6
    v_sub_f32 v6, v115, v5
    v_fmac_f32 v7, v6, v6
    v_sub_f32 v6, v116, v5
    v_fmac_f32 v7, v6, v6
    v_sub_f32 v6, v117, v5
    v_fmac_f32 v7, v6, v6
    v_sub_f32 v6, v118, v5
    v_fmac_f32 v7, v6, v6
    v_sub_f32 v6, v119, v5
    v_fmac_f32 v7, v6, v6
    v_sub_f32 v6, v120, v5
    v_fmac_f32 v7, v6, v6
    v_sub_f32 v6, v121, v5
    v_fmac_f32 v7, v6, v6
    v_sub_f32 v6, v122, v5
    v_fmac_f32 v7, v6, v6
    v_sub_f32 v6, v123, v5
    v_fmac_f32 v7, v6, v6
    v_sub_f32 v6, v124, v5
    v_fmac_f32 v7, v6, v6
    v_sub_f32 v6, v125, v5
    v_fmac_f32 v7, v6, v6
    v_sub_f32 v6, v126, v5
    v_fmac_f32 v7, v6, v6
    v_sub_f32 v6, v127, v5
    v_fmac_f32 v7, v6, v6
    v_sub_f32 v6, v128, v5
    v_fmac_f32 v7, v6, v6
    v_sub_f32 v6, v129, v5
    v_fmac_f32 v7, v6, v6
    v_sub_f32 v6, v130, v5
    v_fmac_f32 v7, v6, v6
    v_sub_f32 v6, v131, v5
    v_fmac_f32 v7, v6, v6
    v_sub_f32 v6, v132, v5
    v_fmac_f32 v7, v6, v6
    v_sub_f32 v6, v133, v5
    v_fmac_f32 v7, v6, v6
    v_sub_f32 v6, v134, v5
    v_fmac_f32 v7, v6, v6
    v_sub_f32 v6, v135, v5
    v_fmac_f32 v7, v6, v6
    v_sub_f32 v6, v136, v5
    v_fmac_f32 v7, v6, v6
    v_sub_f32 v6, v137, v5
    v_fmac_f32 v7, v6, v6
    v_sub_f32 v6, v138, v5
    v_fmac_f32 v7, v6, v6
    v_sub_f32 v6, v139, v5
    v_fmac_f32 v7, v6, v6
    v_sub_f32 v6, v140, v5
    v_fmac_f32 v7, v6, v6
    v_sub_f32 v6, v141, v5
    v_fmac_f32 v7, v6, v6
    v_sub_f32 v6, v142, v5
    v_fmac_f32 v7, v6, v6
    v_sub_f32 v6, v143, v5
    v_fmac_f32 v7, v6, v6
    v_sub_f32 v6, v144, v5
    v_fmac_f32 v7, v6, v6
    v_sub_f32 v6, v145, v5
    v_fmac_f32 v7, v6, v6
    v_sub_f32 v6, v146, v5
    v_fmac_f32 v7, v6, v6
    v_sub_f32 v6, v147, v5
    v_fmac_f32 v7, v6, v6
    v_sub_f32 v6, v148, v5
    v_fmac_f32 v7, v6, v6
    v_sub_f32 v6, v149, v5
    v_fmac_f32 v7, v6, v6
    v_sub_f32 v6, v150, v5
    v_fmac_f32 v7, v6, v6
    v_sub_f32 v6, v151, v5
    v_fmac_f32 v7, v6, v6
    v_sub_f32 v6, v152, v5
    v_fmac_f32 v7, v6, v6
    v_sub_f32 v6, v153, v5
    v_fmac_f32 v7, v6, v6
    v_sub_f32 v6, v154, v5
    v_fmac_f32 v7, v6, v6
    v_sub_f32 v6, v155, v5
    v_fmac_f32 v7, v6, v6
    v_sub_f32 v6, v156, v5
    v_fmac_f32 v7, v6, v6
    v_sub_f32 v6, v157, v5
    v_fmac_f32 v7, v6, v6
    v_sub_f32 v6, v158, v5
    v_fmac_f32 v7, v6, v6
    v_sub_f32 v6, v159, v5
    v_fmac_f32 v7, v6, v6
    v_sub_f32 v6, v160, v5
    v_fmac_f32 v7, v6, v6
    v_sub_f32 v6, v161, v5
    v_fmac_f32 v7, v6, v6
    v_sub_f32 v6, v162, v5
    v_fmac_f32 v7, v6, v6
    v_sub_f32 v6, v163, v5
    v_fmac_f32 v7, v6, v6
    v_sub_f32 v6, v164, v5
    v_fmac_f32 v7, v6, v6
    v_sub_f32 v6, v165, v5
    v_fmac_f32 v7, v6, v6
    v_sub_f32 v6, v166, v5
    v_fmac_f32 v7, v6, v6
    v_sub_f32 v6, v167, v5
    v_fmac_f32 v7, v6, v6
    v_sub_f32 v6, v168, v5
    v_fmac_f32 v7, v6, v6
    v_sub_f32 v6, v169, v5
    v_fmac_f32 v7, v6, v6
    v_sub_f32 v6, v170, v5
    v_fmac_f32 v7, v6, v6
    v_sub_f32 v6, v171, v5
    v_fmac_f32 v7, v6, v6
    v_sub_f32 v6, v172, v5
    v_fmac_f32 v7, v6, v6
    v_sub_f32 v6, v173, v5
    v_fmac_f32 v7, v6, v6
    v_sub_f32 v6, v174, v5
    v_fmac_f32 v7, v6, v6
    v_sub_f32 v6, v175, v5
    v_fmac_f32 v7, v6, v6
    v_sub_f32 v6, v176, v5
    v_fmac_f32 v7, v6, v6
    v_sub_f32 v6, v177, v5
    v_fmac_f32 v7, v6, v6
    v_sub_f32 v6, v178, v5
    v_fmac_f32 v7, v6, v6
    v_sub_f32 v6, v179, v5
    v_fmac_f32 v7, v6, v6
    v_sub_f32 v6, v180, v5
    v_fmac_f32 v7, v6, v6
    v_sub_f32 v6, v181, v5
    v_fmac_f32 v7, v6, v6
    v_mov_b32 v6, v7
    s_nop 1
    v_permlane32_swap_b32 v7, v6
    s_nop 1
    v_add_f32 v7, v7, v6
    v_mov_b32 v6, v7
    s_nop 1
    v_permlane16_swap_b32 v7, v6
    s_nop 1
    v_add_f32 v7, v7, v6
    v_mul_f32 v7, 0x3b124925, v7
    v_cvt_pk_bf16_f32 v7, v7, v7
    v_lshlrev_b32 v7, 16, v7
    v_cvt_pk_bf16_f32 v5, v5, v5
    v_lshlrev_b32 v5, 16, v5
    v_add_f32 v7, 0x3727c5ac, v7
    v_cvt_pk_bf16_f32 v7, v7, v7
    v_lshlrev_b32 v7, 16, v7
    v_sqrt_f32 v7, v7
    s_nop 0
    v_cvt_pk_bf16_f32 v7, v7, v7
    v_lshlrev_b32 v7, 16, v7
    v_rcp_f32 v8, v7
    s_nop 0
    v_sub_f32 v70, v70, v5
    v_cvt_pk_bf16_f32 v70, v70, v70
    v_lshlrev_b32 v70, 16, v70
    v_mul_f32 v6, v70, v8
    v_fma_f32 v9, -v6, v7, v70
    v_fma_f32 v70, v9, v8, v6
    v_sub_f32 v71, v71, v5
    v_cvt_pk_bf16_f32 v71, v71, v71
    v_lshlrev_b32 v71, 16, v71
    v_mul_f32 v6, v71, v8
    v_fma_f32 v9, -v6, v7, v71
    v_fma_f32 v71, v9, v8, v6
    v_sub_f32 v72, v72, v5
    v_cvt_pk_bf16_f32 v72, v72, v72
    v_lshlrev_b32 v72, 16, v72
    v_mul_f32 v6, v72, v8
    v_fma_f32 v9, -v6, v7, v72
    v_fma_f32 v72, v9, v8, v6
    v_sub_f32 v73, v73, v5
    v_cvt_pk_bf16_f32 v73, v73, v73
    v_lshlrev_b32 v73, 16, v73
    v_mul_f32 v6, v73, v8
    v_fma_f32 v9, -v6, v7, v73
    v_fma_f32 v73, v9, v8, v6
    v_sub_f32 v74, v74, v5
    v_cvt_pk_bf16_f32 v74, v74, v74
    v_lshlrev_b32 v74, 16, v74
    v_mul_f32 v6, v74, v8
    v_fma_f32 v9, -v6, v7, v74
    v_fma_f32 v74, v9, v8, v6
    v_sub_f32 v75, v75, v5
    v_cvt_pk_bf16_f32 v75, v75, v75
    v_lshlrev_b32 v75, 16, v75
    v_mul_f32 v6, v75, v8
    v_fma_f32 v9, -v6, v7, v75
    v_fma_f32 v75, v9, v8, v6
    v_sub_f32 v76, v76, v5
    v_cvt_pk_bf16_f32 v76, v76, v76
    v_lshlrev_b32 v76, 16, v76
    v_mul_f32 v6, v76, v8
    v_fma_f32 v9, -v6, v7, v76
    v_fma_f32 v76, v9, v8, v6
    v_sub_f32 v77, v77, v5
    v_cvt_pk_bf16_f32 v77, v77, v77
    v_lshlrev_b32 v77, 16, v77
    v_mul_f32 v6, v77, v8
    v_fma_f32 v9, -v6, v7, v77
    v_fma_f32 v77, v9, v8, v6
    v_sub_f32 v78, v78, v5
    v_cvt_pk_bf16_f32 v78, v78, v78
    v_lshlrev_b32 v78, 16, v78
    v_mul_f32 v6, v78, v8
    v_fma_f32 v9, -v6, v7, v78
    v_fma_f32 v78, v9, v8, v6
    v_sub_f32 v79, v79, v5
    v_cvt_pk_bf16_f32 v79, v79, v79
    v_lshlrev_b32 v79, 16, v79
    v_mul_f32 v6, v79, v8
    v_fma_f32 v9, -v6, v7, v79
    v_fma_f32 v79, v9, v8, v6
    v_sub_f32 v80, v80, v5
    v_cvt_pk_bf16_f32 v80, v80, v80
    v_lshlrev_b32 v80, 16, v80
    v_mul_f32 v6, v80, v8
    v_fma_f32 v9, -v6, v7, v80
    v_fma_f32 v80, v9, v8, v6
    v_sub_f32 v81, v81, v5
    v_cvt_pk_bf16_f32 v81, v81, v81
    v_lshlrev_b32 v81, 16, v81
    v_mul_f32 v6, v81, v8
    v_fma_f32 v9, -v6, v7, v81
    v_fma_f32 v81, v9, v8, v6
    v_sub_f32 v82, v82, v5
    v_cvt_pk_bf16_f32 v82, v82, v82
    v_lshlrev_b32 v82, 16, v82
    v_mul_f32 v6, v82, v8
    v_fma_f32 v9, -v6, v7, v82
    v_fma_f32 v82, v9, v8, v6
    v_sub_f32 v83, v83, v5
    v_cvt_pk_bf16_f32 v83, v83, v83
    v_lshlrev_b32 v83, 16, v83
    v_mul_f32 v6, v83, v8
    v_fma_f32 v9, -v6, v7, v83
    v_fma_f32 v83, v9, v8, v6
    v_sub_f32 v84, v84, v5
    v_cvt_pk_bf16_f32 v84, v84, v84
    v_lshlrev_b32 v84, 16, v84
    v_mul_f32 v6, v84, v8
    v_fma_f32 v9, -v6, v7, v84
    v_fma_f32 v84, v9, v8, v6
    v_sub_f32 v85, v85, v5
    v_cvt_pk_bf16_f32 v85, v85, v85
    v_lshlrev_b32 v85, 16, v85
    v_mul_f32 v6, v85, v8
    v_fma_f32 v9, -v6, v7, v85
    v_fma_f32 v85, v9, v8, v6
    v_sub_f32 v86, v86, v5
    v_cvt_pk_bf16_f32 v86, v86, v86
    v_lshlrev_b32 v86, 16, v86
    v_mul_f32 v6, v86, v8
    v_fma_f32 v9, -v6, v7, v86
    v_fma_f32 v86, v9, v8, v6
    v_sub_f32 v87, v87, v5
    v_cvt_pk_bf16_f32 v87, v87, v87
    v_lshlrev_b32 v87, 16, v87
    v_mul_f32 v6, v87, v8
    v_fma_f32 v9, -v6, v7, v87
    v_fma_f32 v87, v9, v8, v6
    v_sub_f32 v88, v88, v5
    v_cvt_pk_bf16_f32 v88, v88, v88
    v_lshlrev_b32 v88, 16, v88
    v_mul_f32 v6, v88, v8
    v_fma_f32 v9, -v6, v7, v88
    v_fma_f32 v88, v9, v8, v6
    v_sub_f32 v89, v89, v5
    v_cvt_pk_bf16_f32 v89, v89, v89
    v_lshlrev_b32 v89, 16, v89
    v_mul_f32 v6, v89, v8
    v_fma_f32 v9, -v6, v7, v89
    v_fma_f32 v89, v9, v8, v6
    v_sub_f32 v90, v90, v5
    v_cvt_pk_bf16_f32 v90, v90, v90
    v_lshlrev_b32 v90, 16, v90
    v_mul_f32 v6, v90, v8
    v_fma_f32 v9, -v6, v7, v90
    v_fma_f32 v90, v9, v8, v6
    v_sub_f32 v91, v91, v5
    v_cvt_pk_bf16_f32 v91, v91, v91
    v_lshlrev_b32 v91, 16, v91
    v_mul_f32 v6, v91, v8
    v_fma_f32 v9, -v6, v7, v91
    v_fma_f32 v91, v9, v8, v6
    v_sub_f32 v92, v92, v5
    v_cvt_pk_bf16_f32 v92, v92, v92
    v_lshlrev_b32 v92, 16, v92
    v_mul_f32 v6, v92, v8
    v_fma_f32 v9, -v6, v7, v92
    v_fma_f32 v92, v9, v8, v6
    v_sub_f32 v93, v93, v5
    v_cvt_pk_bf16_f32 v93, v93, v93
    v_lshlrev_b32 v93, 16, v93
    v_mul_f32 v6, v93, v8
    v_fma_f32 v9, -v6, v7, v93
    v_fma_f32 v93, v9, v8, v6
    v_sub_f32 v94, v94, v5
    v_cvt_pk_bf16_f32 v94, v94, v94
    v_lshlrev_b32 v94, 16, v94
    v_mul_f32 v6, v94, v8
    v_fma_f32 v9, -v6, v7, v94
    v_fma_f32 v94, v9, v8, v6
    v_sub_f32 v95, v95, v5
    v_cvt_pk_bf16_f32 v95, v95, v95
    v_lshlrev_b32 v95, 16, v95
    v_mul_f32 v6, v95, v8
    v_fma_f32 v9, -v6, v7, v95
    v_fma_f32 v95, v9, v8, v6
    v_sub_f32 v96, v96, v5
    v_cvt_pk_bf16_f32 v96, v96, v96
    v_lshlrev_b32 v96, 16, v96
    v_mul_f32 v6, v96, v8
    v_fma_f32 v9, -v6, v7, v96
    v_fma_f32 v96, v9, v8, v6
    v_sub_f32 v97, v97, v5
    v_cvt_pk_bf16_f32 v97, v97, v97
    v_lshlrev_b32 v97, 16, v97
    v_mul_f32 v6, v97, v8
    v_fma_f32 v9, -v6, v7, v97
    v_fma_f32 v97, v9, v8, v6
    v_sub_f32 v98, v98, v5
    v_cvt_pk_bf16_f32 v98, v98, v98
    v_lshlrev_b32 v98, 16, v98
    v_mul_f32 v6, v98, v8
    v_fma_f32 v9, -v6, v7, v98
    v_fma_f32 v98, v9, v8, v6
    v_sub_f32 v99, v99, v5
    v_cvt_pk_bf16_f32 v99, v99, v99
    v_lshlrev_b32 v99, 16, v99
    v_mul_f32 v6, v99, v8
    v_fma_f32 v9, -v6, v7, v99
    v_fma_f32 v99, v9, v8, v6
    v_sub_f32 v100, v100, v5
    v_cvt_pk_bf16_f32 v100, v100, v100
    v_lshlrev_b32 v100, 16, v100
    v_mul_f32 v6, v100, v8
    v_fma_f32 v9, -v6, v7, v100
    v_fma_f32 v100, v9, v8, v6
    v_sub_f32 v101, v101, v5
    v_cvt_pk_bf16_f32 v101, v101, v101
    v_lshlrev_b32 v101, 16, v101
    v_mul_f32 v6, v101, v8
    v_fma_f32 v9, -v6, v7, v101
    v_fma_f32 v101, v9, v8, v6
    v_sub_f32 v102, v102, v5
    v_cvt_pk_bf16_f32 v102, v102, v102
    v_lshlrev_b32 v102, 16, v102
    v_mul_f32 v6, v102, v8
    v_fma_f32 v9, -v6, v7, v102
    v_fma_f32 v102, v9, v8, v6
    v_sub_f32 v103, v103, v5
    v_cvt_pk_bf16_f32 v103, v103, v103
    v_lshlrev_b32 v103, 16, v103
    v_mul_f32 v6, v103, v8
    v_fma_f32 v9, -v6, v7, v103
    v_fma_f32 v103, v9, v8, v6
    v_sub_f32 v104, v104, v5
    v_cvt_pk_bf16_f32 v104, v104, v104
    v_lshlrev_b32 v104, 16, v104
    v_mul_f32 v6, v104, v8
    v_fma_f32 v9, -v6, v7, v104
    v_fma_f32 v104, v9, v8, v6
    v_sub_f32 v105, v105, v5
    v_cvt_pk_bf16_f32 v105, v105, v105
    v_lshlrev_b32 v105, 16, v105
    v_mul_f32 v6, v105, v8
    v_fma_f32 v9, -v6, v7, v105
    v_fma_f32 v105, v9, v8, v6
    v_sub_f32 v106, v106, v5
    v_cvt_pk_bf16_f32 v106, v106, v106
    v_lshlrev_b32 v106, 16, v106
    v_mul_f32 v6, v106, v8
    v_fma_f32 v9, -v6, v7, v106
    v_fma_f32 v106, v9, v8, v6
    v_sub_f32 v107, v107, v5
    v_cvt_pk_bf16_f32 v107, v107, v107
    v_lshlrev_b32 v107, 16, v107
    v_mul_f32 v6, v107, v8
    v_fma_f32 v9, -v6, v7, v107
    v_fma_f32 v107, v9, v8, v6
    v_sub_f32 v108, v108, v5
    v_cvt_pk_bf16_f32 v108, v108, v108
    v_lshlrev_b32 v108, 16, v108
    v_mul_f32 v6, v108, v8
    v_fma_f32 v9, -v6, v7, v108
    v_fma_f32 v108, v9, v8, v6
    v_sub_f32 v109, v109, v5
    v_cvt_pk_bf16_f32 v109, v109, v109
    v_lshlrev_b32 v109, 16, v109
    v_mul_f32 v6, v109, v8
    v_fma_f32 v9, -v6, v7, v109
    v_fma_f32 v109, v9, v8, v6
    v_sub_f32 v110, v110, v5
    v_cvt_pk_bf16_f32 v110, v110, v110
    v_lshlrev_b32 v110, 16, v110
    v_mul_f32 v6, v110, v8
    v_fma_f32 v9, -v6, v7, v110
    v_fma_f32 v110, v9, v8, v6
    v_sub_f32 v111, v111, v5
    v_cvt_pk_bf16_f32 v111, v111, v111
    v_lshlrev_b32 v111, 16, v111
    v_mul_f32 v6, v111, v8
    v_fma_f32 v9, -v6, v7, v111
    v_fma_f32 v111, v9, v8, v6
    v_sub_f32 v112, v112, v5
    v_cvt_pk_bf16_f32 v112, v112, v112
    v_lshlrev_b32 v112, 16, v112
    v_mul_f32 v6, v112, v8
    v_fma_f32 v9, -v6, v7, v112
    v_fma_f32 v112, v9, v8, v6
    v_sub_f32 v113, v113, v5
    v_cvt_pk_bf16_f32 v113, v113, v113
    v_lshlrev_b32 v113, 16, v113
    v_mul_f32 v6, v113, v8
    v_fma_f32 v9, -v6, v7, v113
    v_fma_f32 v113, v9, v8, v6
    v_sub_f32 v114, v114, v5
    v_cvt_pk_bf16_f32 v114, v114, v114
    v_lshlrev_b32 v114, 16, v114
    v_mul_f32 v6, v114, v8
    v_fma_f32 v9, -v6, v7, v114
    v_fma_f32 v114, v9, v8, v6
    v_sub_f32 v115, v115, v5
    v_cvt_pk_bf16_f32 v115, v115, v115
    v_lshlrev_b32 v115, 16, v115
    v_mul_f32 v6, v115, v8
    v_fma_f32 v9, -v6, v7, v115
    v_fma_f32 v115, v9, v8, v6
    v_sub_f32 v116, v116, v5
    v_cvt_pk_bf16_f32 v116, v116, v116
    v_lshlrev_b32 v116, 16, v116
    v_mul_f32 v6, v116, v8
    v_fma_f32 v9, -v6, v7, v116
    v_fma_f32 v116, v9, v8, v6
    v_sub_f32 v117, v117, v5
    v_cvt_pk_bf16_f32 v117, v117, v117
    v_lshlrev_b32 v117, 16, v117
    v_mul_f32 v6, v117, v8
    v_fma_f32 v9, -v6, v7, v117
    v_fma_f32 v117, v9, v8, v6
    v_sub_f32 v118, v118, v5
    v_cvt_pk_bf16_f32 v118, v118, v118
    v_lshlrev_b32 v118, 16, v118
    v_mul_f32 v6, v118, v8
    v_fma_f32 v9, -v6, v7, v118
    v_fma_f32 v118, v9, v8, v6
    v_sub_f32 v119, v119, v5
    v_cvt_pk_bf16_f32 v119, v119, v119
    v_lshlrev_b32 v119, 16, v119
    v_mul_f32 v6, v119, v8
    v_fma_f32 v9, -v6, v7, v119
    v_fma_f32 v119, v9, v8, v6
    v_sub_f32 v120, v120, v5
    v_cvt_pk_bf16_f32 v120, v120, v120
    v_lshlrev_b32 v120, 16, v120
    v_mul_f32 v6, v120, v8
    v_fma_f32 v9, -v6, v7, v120
    v_fma_f32 v120, v9, v8, v6
    v_sub_f32 v121, v121, v5
    v_cvt_pk_bf16_f32 v121, v121, v121
    v_lshlrev_b32 v121, 16, v121
    v_mul_f32 v6, v121, v8
    v_fma_f32 v9, -v6, v7, v121
    v_fma_f32 v121, v9, v8, v6
    v_sub_f32 v122, v122, v5
    v_cvt_pk_bf16_f32 v122, v122, v122
    v_lshlrev_b32 v122, 16, v122
    v_mul_f32 v6, v122, v8
    v_fma_f32 v9, -v6, v7, v122
    v_fma_f32 v122, v9, v8, v6
    v_sub_f32 v123, v123, v5
    v_cvt_pk_bf16_f32 v123, v123, v123
    v_lshlrev_b32 v123, 16, v123
    v_mul_f32 v6, v123, v8
    v_fma_f32 v9, -v6, v7, v123
    v_fma_f32 v123, v9, v8, v6
    v_sub_f32 v124, v124, v5
    v_cvt_pk_bf16_f32 v124, v124, v124
    v_lshlrev_b32 v124, 16, v124
    v_mul_f32 v6, v124, v8
    v_fma_f32 v9, -v6, v7, v124
    v_fma_f32 v124, v9, v8, v6
    v_sub_f32 v125, v125, v5
    v_cvt_pk_bf16_f32 v125, v125, v125
    v_lshlrev_b32 v125, 16, v125
    v_mul_f32 v6, v125, v8
    v_fma_f32 v9, -v6, v7, v125
    v_fma_f32 v125, v9, v8, v6
    v_sub_f32 v126, v126, v5
    v_cvt_pk_bf16_f32 v126, v126, v126
    v_lshlrev_b32 v126, 16, v126
    v_mul_f32 v6, v126, v8
    v_fma_f32 v9, -v6, v7, v126
    v_fma_f32 v126, v9, v8, v6
    v_sub_f32 v127, v127, v5
    v_cvt_pk_bf16_f32 v127, v127, v127
    v_lshlrev_b32 v127, 16, v127
    v_mul_f32 v6, v127, v8
    v_fma_f32 v9, -v6, v7, v127
    v_fma_f32 v127, v9, v8, v6
    v_sub_f32 v128, v128, v5
    v_cvt_pk_bf16_f32 v128, v128, v128
    v_lshlrev_b32 v128, 16, v128
    v_mul_f32 v6, v128, v8
    v_fma_f32 v9, -v6, v7, v128
    v_fma_f32 v128, v9, v8, v6
    v_sub_f32 v129, v129, v5
    v_cvt_pk_bf16_f32 v129, v129, v129
    v_lshlrev_b32 v129, 16, v129
    v_mul_f32 v6, v129, v8
    v_fma_f32 v9, -v6, v7, v129
    v_fma_f32 v129, v9, v8, v6
    v_sub_f32 v130, v130, v5
    v_cvt_pk_bf16_f32 v130, v130, v130
    v_lshlrev_b32 v130, 16, v130
    v_mul_f32 v6, v130, v8
    v_fma_f32 v9, -v6, v7, v130
    v_fma_f32 v130, v9, v8, v6
    v_sub_f32 v131, v131, v5
    v_cvt_pk_bf16_f32 v131, v131, v131
    v_lshlrev_b32 v131, 16, v131
    v_mul_f32 v6, v131, v8
    v_fma_f32 v9, -v6, v7, v131
    v_fma_f32 v131, v9, v8, v6
    v_sub_f32 v132, v132, v5
    v_cvt_pk_bf16_f32 v132, v132, v132
    v_lshlrev_b32 v132, 16, v132
    v_mul_f32 v6, v132, v8
    v_fma_f32 v9, -v6, v7, v132
    v_fma_f32 v132, v9, v8, v6
    v_sub_f32 v133, v133, v5
    v_cvt_pk_bf16_f32 v133, v133, v133
    v_lshlrev_b32 v133, 16, v133
    v_mul_f32 v6, v133, v8
    v_fma_f32 v9, -v6, v7, v133
    v_fma_f32 v133, v9, v8, v6
    v_sub_f32 v134, v134, v5
    v_cvt_pk_bf16_f32 v134, v134, v134
    v_lshlrev_b32 v134, 16, v134
    v_mul_f32 v6, v134, v8
    v_fma_f32 v9, -v6, v7, v134
    v_fma_f32 v134, v9, v8, v6
    v_sub_f32 v135, v135, v5
    v_cvt_pk_bf16_f32 v135, v135, v135
    v_lshlrev_b32 v135, 16, v135
    v_mul_f32 v6, v135, v8
    v_fma_f32 v9, -v6, v7, v135
    v_fma_f32 v135, v9, v8, v6
    v_sub_f32 v136, v136, v5
    v_cvt_pk_bf16_f32 v136, v136, v136
    v_lshlrev_b32 v136, 16, v136
    v_mul_f32 v6, v136, v8
    v_fma_f32 v9, -v6, v7, v136
    v_fma_f32 v136, v9, v8, v6
    v_sub_f32 v137, v137, v5
    v_cvt_pk_bf16_f32 v137, v137, v137
    v_lshlrev_b32 v137, 16, v137
    v_mul_f32 v6, v137, v8
    v_fma_f32 v9, -v6, v7, v137
    v_fma_f32 v137, v9, v8, v6
    v_sub_f32 v138, v138, v5
    v_cvt_pk_bf16_f32 v138, v138, v138
    v_lshlrev_b32 v138, 16, v138
    v_mul_f32 v6, v138, v8
    v_fma_f32 v9, -v6, v7, v138
    v_fma_f32 v138, v9, v8, v6
    v_sub_f32 v139, v139, v5
    v_cvt_pk_bf16_f32 v139, v139, v139
    v_lshlrev_b32 v139, 16, v139
    v_mul_f32 v6, v139, v8
    v_fma_f32 v9, -v6, v7, v139
    v_fma_f32 v139, v9, v8, v6
    v_sub_f32 v140, v140, v5
    v_cvt_pk_bf16_f32 v140, v140, v140
    v_lshlrev_b32 v140, 16, v140
    v_mul_f32 v6, v140, v8
    v_fma_f32 v9, -v6, v7, v140
    v_fma_f32 v140, v9, v8, v6
    v_sub_f32 v141, v141, v5
    v_cvt_pk_bf16_f32 v141, v141, v141
    v_lshlrev_b32 v141, 16, v141
    v_mul_f32 v6, v141, v8
    v_fma_f32 v9, -v6, v7, v141
    v_fma_f32 v141, v9, v8, v6
    v_sub_f32 v142, v142, v5
    v_cvt_pk_bf16_f32 v142, v142, v142
    v_lshlrev_b32 v142, 16, v142
    v_mul_f32 v6, v142, v8
    v_fma_f32 v9, -v6, v7, v142
    v_fma_f32 v142, v9, v8, v6
    v_sub_f32 v143, v143, v5
    v_cvt_pk_bf16_f32 v143, v143, v143
    v_lshlrev_b32 v143, 16, v143
    v_mul_f32 v6, v143, v8
    v_fma_f32 v9, -v6, v7, v143
    v_fma_f32 v143, v9, v8, v6
    v_sub_f32 v144, v144, v5
    v_cvt_pk_bf16_f32 v144, v144, v144
    v_lshlrev_b32 v144, 16, v144
    v_mul_f32 v6, v144, v8
    v_fma_f32 v9, -v6, v7, v144
    v_fma_f32 v144, v9, v8, v6
    v_sub_f32 v145, v145, v5
    v_cvt_pk_bf16_f32 v145, v145, v145
    v_lshlrev_b32 v145, 16, v145
    v_mul_f32 v6, v145, v8
    v_fma_f32 v9, -v6, v7, v145
    v_fma_f32 v145, v9, v8, v6
    v_sub_f32 v146, v146, v5
    v_cvt_pk_bf16_f32 v146, v146, v146
    v_lshlrev_b32 v146, 16, v146
    v_mul_f32 v6, v146, v8
    v_fma_f32 v9, -v6, v7, v146
    v_fma_f32 v146, v9, v8, v6
    v_sub_f32 v147, v147, v5
    v_cvt_pk_bf16_f32 v147, v147, v147
    v_lshlrev_b32 v147, 16, v147
    v_mul_f32 v6, v147, v8
    v_fma_f32 v9, -v6, v7, v147
    v_fma_f32 v147, v9, v8, v6
    v_sub_f32 v148, v148, v5
    v_cvt_pk_bf16_f32 v148, v148, v148
    v_lshlrev_b32 v148, 16, v148
    v_mul_f32 v6, v148, v8
    v_fma_f32 v9, -v6, v7, v148
    v_fma_f32 v148, v9, v8, v6
    v_sub_f32 v149, v149, v5
    v_cvt_pk_bf16_f32 v149, v149, v149
    v_lshlrev_b32 v149, 16, v149
    v_mul_f32 v6, v149, v8
    v_fma_f32 v9, -v6, v7, v149
    v_fma_f32 v149, v9, v8, v6
    v_sub_f32 v150, v150, v5
    v_cvt_pk_bf16_f32 v150, v150, v150
    v_lshlrev_b32 v150, 16, v150
    v_mul_f32 v6, v150, v8
    v_fma_f32 v9, -v6, v7, v150
    v_fma_f32 v150, v9, v8, v6
    v_sub_f32 v151, v151, v5
    v_cvt_pk_bf16_f32 v151, v151, v151
    v_lshlrev_b32 v151, 16, v151
    v_mul_f32 v6, v151, v8
    v_fma_f32 v9, -v6, v7, v151
    v_fma_f32 v151, v9, v8, v6
    v_sub_f32 v152, v152, v5
    v_cvt_pk_bf16_f32 v152, v152, v152
    v_lshlrev_b32 v152, 16, v152
    v_mul_f32 v6, v152, v8
    v_fma_f32 v9, -v6, v7, v152
    v_fma_f32 v152, v9, v8, v6
    v_sub_f32 v153, v153, v5
    v_cvt_pk_bf16_f32 v153, v153, v153
    v_lshlrev_b32 v153, 16, v153
    v_mul_f32 v6, v153, v8
    v_fma_f32 v9, -v6, v7, v153
    v_fma_f32 v153, v9, v8, v6
    v_sub_f32 v154, v154, v5
    v_cvt_pk_bf16_f32 v154, v154, v154
    v_lshlrev_b32 v154, 16, v154
    v_mul_f32 v6, v154, v8
    v_fma_f32 v9, -v6, v7, v154
    v_fma_f32 v154, v9, v8, v6
    v_sub_f32 v155, v155, v5
    v_cvt_pk_bf16_f32 v155, v155, v155
    v_lshlrev_b32 v155, 16, v155
    v_mul_f32 v6, v155, v8
    v_fma_f32 v9, -v6, v7, v155
    v_fma_f32 v155, v9, v8, v6
    v_sub_f32 v156, v156, v5
    v_cvt_pk_bf16_f32 v156, v156, v156
    v_lshlrev_b32 v156, 16, v156
    v_mul_f32 v6, v156, v8
    v_fma_f32 v9, -v6, v7, v156
    v_fma_f32 v156, v9, v8, v6
    v_sub_f32 v157, v157, v5
    v_cvt_pk_bf16_f32 v157, v157, v157
    v_lshlrev_b32 v157, 16, v157
    v_mul_f32 v6, v157, v8
    v_fma_f32 v9, -v6, v7, v157
    v_fma_f32 v157, v9, v8, v6
    v_sub_f32 v158, v158, v5
    v_cvt_pk_bf16_f32 v158, v158, v158
    v_lshlrev_b32 v158, 16, v158
    v_mul_f32 v6, v158, v8
    v_fma_f32 v9, -v6, v7, v158
    v_fma_f32 v158, v9, v8, v6
    v_sub_f32 v159, v159, v5
    v_cvt_pk_bf16_f32 v159, v159, v159
    v_lshlrev_b32 v159, 16, v159
    v_mul_f32 v6, v159, v8
    v_fma_f32 v9, -v6, v7, v159
    v_fma_f32 v159, v9, v8, v6
    v_sub_f32 v160, v160, v5
    v_cvt_pk_bf16_f32 v160, v160, v160
    v_lshlrev_b32 v160, 16, v160
    v_mul_f32 v6, v160, v8
    v_fma_f32 v9, -v6, v7, v160
    v_fma_f32 v160, v9, v8, v6
    v_sub_f32 v161, v161, v5
    v_cvt_pk_bf16_f32 v161, v161, v161
    v_lshlrev_b32 v161, 16, v161
    v_mul_f32 v6, v161, v8
    v_fma_f32 v9, -v6, v7, v161
    v_fma_f32 v161, v9, v8, v6
    v_sub_f32 v162, v162, v5
    v_cvt_pk_bf16_f32 v162, v162, v162
    v_lshlrev_b32 v162, 16, v162
    v_mul_f32 v6, v162, v8
    v_fma_f32 v9, -v6, v7, v162
    v_fma_f32 v162, v9, v8, v6
    v_sub_f32 v163, v163, v5
    v_cvt_pk_bf16_f32 v163, v163, v163
    v_lshlrev_b32 v163, 16, v163
    v_mul_f32 v6, v163, v8
    v_fma_f32 v9, -v6, v7, v163
    v_fma_f32 v163, v9, v8, v6
    v_sub_f32 v164, v164, v5
    v_cvt_pk_bf16_f32 v164, v164, v164
    v_lshlrev_b32 v164, 16, v164
    v_mul_f32 v6, v164, v8
    v_fma_f32 v9, -v6, v7, v164
    v_fma_f32 v164, v9, v8, v6
    v_sub_f32 v165, v165, v5
    v_cvt_pk_bf16_f32 v165, v165, v165
    v_lshlrev_b32 v165, 16, v165
    v_mul_f32 v6, v165, v8
    v_fma_f32 v9, -v6, v7, v165
    v_fma_f32 v165, v9, v8, v6
    v_sub_f32 v166, v166, v5
    v_cvt_pk_bf16_f32 v166, v166, v166
    v_lshlrev_b32 v166, 16, v166
    v_mul_f32 v6, v166, v8
    v_fma_f32 v9, -v6, v7, v166
    v_fma_f32 v166, v9, v8, v6
    v_sub_f32 v167, v167, v5
    v_cvt_pk_bf16_f32 v167, v167, v167
    v_lshlrev_b32 v167, 16, v167
    v_mul_f32 v6, v167, v8
    v_fma_f32 v9, -v6, v7, v167
    v_fma_f32 v167, v9, v8, v6
    v_sub_f32 v168, v168, v5
    v_cvt_pk_bf16_f32 v168, v168, v168
    v_lshlrev_b32 v168, 16, v168
    v_mul_f32 v6, v168, v8
    v_fma_f32 v9, -v6, v7, v168
    v_fma_f32 v168, v9, v8, v6
    v_sub_f32 v169, v169, v5
    v_cvt_pk_bf16_f32 v169, v169, v169
    v_lshlrev_b32 v169, 16, v169
    v_mul_f32 v6, v169, v8
    v_fma_f32 v9, -v6, v7, v169
    v_fma_f32 v169, v9, v8, v6
    v_sub_f32 v170, v170, v5
    v_cvt_pk_bf16_f32 v170, v170, v170
    v_lshlrev_b32 v170, 16, v170
    v_mul_f32 v6, v170, v8
    v_fma_f32 v9, -v6, v7, v170
    v_fma_f32 v170, v9, v8, v6
    v_sub_f32 v171, v171, v5
    v_cvt_pk_bf16_f32 v171, v171, v171
    v_lshlrev_b32 v171, 16, v171
    v_mul_f32 v6, v171, v8
    v_fma_f32 v9, -v6, v7, v171
    v_fma_f32 v171, v9, v8, v6
    v_sub_f32 v172, v172, v5
    v_cvt_pk_bf16_f32 v172, v172, v172
    v_lshlrev_b32 v172, 16, v172
    v_mul_f32 v6, v172, v8
    v_fma_f32 v9, -v6, v7, v172
    v_fma_f32 v172, v9, v8, v6
    v_sub_f32 v173, v173, v5
    v_cvt_pk_bf16_f32 v173, v173, v173
    v_lshlrev_b32 v173, 16, v173
    v_mul_f32 v6, v173, v8
    v_fma_f32 v9, -v6, v7, v173
    v_fma_f32 v173, v9, v8, v6
    v_sub_f32 v174, v174, v5
    v_cvt_pk_bf16_f32 v174, v174, v174
    v_lshlrev_b32 v174, 16, v174
    v_mul_f32 v6, v174, v8
    v_fma_f32 v9, -v6, v7, v174
    v_fma_f32 v174, v9, v8, v6
    v_sub_f32 v175, v175, v5
    v_cvt_pk_bf16_f32 v175, v175, v175
    v_lshlrev_b32 v175, 16, v175
    v_mul_f32 v6, v175, v8
    v_fma_f32 v9, -v6, v7, v175
    v_fma_f32 v175, v9, v8, v6
    v_sub_f32 v176, v176, v5
    v_cvt_pk_bf16_f32 v176, v176, v176
    v_lshlrev_b32 v176, 16, v176
    v_mul_f32 v6, v176, v8
    v_fma_f32 v9, -v6, v7, v176
    v_fma_f32 v176, v9, v8, v6
    v_sub_f32 v177, v177, v5
    v_cvt_pk_bf16_f32 v177, v177, v177
    v_lshlrev_b32 v177, 16, v177
    v_mul_f32 v6, v177, v8
    v_fma_f32 v9, -v6, v7, v177
    v_fma_f32 v177, v9, v8, v6
    v_sub_f32 v178, v178, v5
    v_cvt_pk_bf16_f32 v178, v178, v178
    v_lshlrev_b32 v178, 16, v178
    v_mul_f32 v6, v178, v8
    v_fma_f32 v9, -v6, v7, v178
    v_fma_f32 v178, v9, v8, v6
    v_sub_f32 v179, v179, v5
    v_cvt_pk_bf16_f32 v179, v179, v179
    v_lshlrev_b32 v179, 16, v179
    v_mul_f32 v6, v179, v8
    v_fma_f32 v9, -v6, v7, v179
    v_fma_f32 v179, v9, v8, v6
    v_sub_f32 v180, v180, v5
    v_cvt_pk_bf16_f32 v180, v180, v180
    v_lshlrev_b32 v180, 16, v180
    v_mul_f32 v6, v180, v8
    v_fma_f32 v9, -v6, v7, v180
    v_fma_f32 v180, v9, v8, v6
    v_sub_f32 v181, v181, v5
    v_cvt_pk_bf16_f32 v181, v181, v181
    v_lshlrev_b32 v181, 16, v181
    v_mul_f32 v6, v181, v8
    v_fma_f32 v9, -v6, v7, v181
    v_fma_f32 v181, v9, v8, v6
    v_cvt_pk_bf16_f32 v10, v70, v71
    v_cvt_pk_bf16_f32 v11, v72, v73
    v_cvt_pk_bf16_f32 v12, v74, v75
    v_cvt_pk_bf16_f32 v13, v76, v77
    v_cvt_pk_bf16_f32 v14, v78, v79
    v_cvt_pk_bf16_f32 v15, v80, v81
    v_cvt_pk_bf16_f32 v16, v82, v83
    v_cvt_pk_bf16_f32 v17, v84, v85
    v_cvt_pk_bf16_f32 v18, v86, v87
    v_cvt_pk_bf16_f32 v19, v88, v89
    v_cvt_pk_bf16_f32 v20, v90, v91
    v_cvt_pk_bf16_f32 v21, v92, v93
    v_cvt_pk_bf16_f32 v22, v94, v95
    v_cvt_pk_bf16_f32 v23, v96, v97
    v_cvt_pk_bf16_f32 v24, v98, v99
    v_cvt_pk_bf16_f32 v25, v100, v101
    v_cvt_pk_bf16_f32 v26, v102, v103
    v_cvt_pk_bf16_f32 v27, v104, v105
    v_cvt_pk_bf16_f32 v28, v106, v107
    v_cvt_pk_bf16_f32 v29, v108, v109
    v_cvt_pk_bf16_f32 v30, v110, v111
    v_cvt_pk_bf16_f32 v31, v112, v113
    v_cvt_pk_bf16_f32 v32, v114, v115
    v_cvt_pk_bf16_f32 v33, v116, v117
    v_cvt_pk_bf16_f32 v34, v118, v119
    v_cvt_pk_bf16_f32 v35, v120, v121
    v_cvt_pk_bf16_f32 v36, v122, v123
    v_cvt_pk_bf16_f32 v37, v124, v125
    v_cvt_pk_bf16_f32 v38, v126, v127
    v_cvt_pk_bf16_f32 v39, v128, v129
    v_cvt_pk_bf16_f32 v40, v130, v131
    v_cvt_pk_bf16_f32 v41, v132, v133
    v_cvt_pk_bf16_f32 v42, v134, v135
    v_cvt_pk_bf16_f32 v43, v136, v137
    v_cvt_pk_bf16_f32 v44, v138, v139
    v_cvt_pk_bf16_f32 v45, v140, v141
    v_cvt_pk_bf16_f32 v46, v142, v143
    v_cvt_pk_bf16_f32 v47, v144, v145
    v_cvt_pk_bf16_f32 v48, v146, v147
    v_cvt_pk_bf16_f32 v49, v148, v149
    v_cvt_pk_bf16_f32 v50, v150, v151
    v_cvt_pk_bf16_f32 v51, v152, v153
    v_cvt_pk_bf16_f32 v52, v154, v155
    v_cvt_pk_bf16_f32 v53, v156, v157
    v_cvt_pk_bf16_f32 v54, v158, v159
    v_cvt_pk_bf16_f32 v55, v160, v161
    v_cvt_pk_bf16_f32 v56, v162, v163
    v_cvt_pk_bf16_f32 v57, v164, v165
    v_cvt_pk_bf16_f32 v58, v166, v167
    v_cvt_pk_bf16_f32 v59, v168, v169
    v_cvt_pk_bf16_f32 v60, v170, v171
    v_cvt_pk_bf16_f32 v61, v172, v173
    v_cvt_pk_bf16_f32 v62, v174, v175
    v_cvt_pk_bf16_f32 v63, v176, v177
    v_cvt_pk_bf16_f32 v64, v178, v179
    v_cvt_pk_bf16_f32 v65, v180, v181
    s_mul_i32 s20, s19, 14336
    s_add_u32 s20, s20, 0x1000
    s_add_u32 s22, s16, s20
    s_addc_u32 s23, s17, 0
    v_lshlrev_b32 v4, 4, v1
    global_store_dwordx4 v4, v[10:13], s[22:23] offset:0
    global_store_dwordx4 v4, v[14:17], s[22:23] offset:1024
    global_store_dwordx4 v4, v[18:21], s[22:23] offset:2048
    global_store_dwordx4 v4, v[22:25], s[22:23] offset:3072
    s_add_u32 s22, s22, 4096
    s_addc_u32 s23, s23, 0
    global_store_dwordx4 v4, v[26:29], s[22:23] offset:0
    global_store_dwordx4 v4, v[30:33], s[22:23] offset:1024
    global_store_dwordx4 v4, v[34:37], s[22:23] offset:2048
    global_store_dwordx4 v4, v[38:41], s[22:23] offset:3072
    s_add_u32 s22, s22, 4096
    s_addc_u32 s23, s23, 0
    global_store_dwordx4 v4, v[42:45], s[22:23] offset:0
    global_store_dwordx4 v4, v[46:49], s[22:23] offset:1024
    global_store_dwordx4 v4, v[50:53], s[22:23] offset:2048
    global_store_dwordx4 v4, v[54:57], s[22:23] offset:3072
    s_add_u32 s22, s22, 4096
    s_addc_u32 s23, s23, 0
    global_store_dwordx4 v4, v[58:61], s[22:23] offset:0
    global_store_dwordx4 v4, v[62:65], s[22:23] offset:1024
    s_branch .prep_kernel_end1
.prep_kernel_wot6:
    s_sub_u32 s30, s2, 32
    s_mul_i32 s31, s30, 0x2493
    s_lshr_b32 s31, s31, 16
    s_mul_i32 s32, s31, 7
    s_sub_u32 s32, s30, s32
    s_lshl_b32 s32, s32, 2
    s_add_u32 s32, s32, s18
    s_mul_i32 s33, s31, 229376
    s_add_u32 s20, s8, s33
    s_addc_u32 s21, s9, 0
    s_movk_i32 s22, 896
    s_mov_b32 s23, 0
    s_lshl_b32 s24, s32, 4
    s_mov_b32 s25, 0
    s_mul_i32 s33, s31, 28
    s_add_u32 s33, s33, s32
    s_lshl_b32 s33, s33, 13
    s_add_u32 s33, s33, 0x1c1000
    s_mov_b32 s28, 8
    s_add_u32 s26, s16, s33
    s_addc_u32 s27, s17, 0
    s_branch .prep_kernel_tr3
.prep_kernel_wg7:
    s_sub_u32 s30, s2, 144
    s_lshl_b32 s30, s30, 1
    s_lshr_b32 s31, s18, 1
    s_add_u32 s30, s30, s31
    s_and_b32 s31, s18, 1
    s_mul_i32 s31, s31, 7
    s_mov_b32 s20, s12
    s_mov_b32 s21, s13
    s_movk_i32 s22, 3584
    s_lshl_b32 s23, s31, 5
    s_lshl_b32 s24, s30, 4
    s_mov_b32 s25, 1
    s_mul_i32 s33, s30, 14
    s_add_u32 s33, s33, s31
    s_lshl_b32 s33, s33, 10
    s_add_u32 s33, s33, 0xfc1000
    s_mov_b32 s28, 7
    s_add_u32 s26, s16, s33
    s_addc_u32 s27, s17, 0
    s_branch .prep_kernel_tr3
.prep_kernel_wu8:
    s_sub_u32 s30, s2, 200
    s_lshl_b32 s30, s30, 1
    s_lshr_b32 s31, s18, 1
    s_add_u32 s30, s30, s31
    s_and_b32 s31, s18, 1
    s_mul_i32 s31, s31, 7
    s_mov_b32 s20, s14
    s_mov_b32 s21, s15
    s_movk_i32 s22, 3584
    s_lshl_b32 s23, s31, 5
    s_lshl_b32 s24, s30, 4
    s_mov_b32 s25, 1
    s_mul_i32 s33, s30, 14
    s_add_u32 s33, s33, s31
    s_lshl_b32 s33, s33, 10
    s_add_u32 s33, s33, 0x1149000
    s_mov_b32 s28, 7
    s_add_u32 s26, s16, s33
    s_addc_u32 s27, s17, 0
    s_branch .prep_kernel_tr3
.prep_kernel_wd9:
    s_sub_u32 s30, s2, 256
    s_lshr_b32 s32, s30, 1
    s_and_b32 s31, s30, 1
    s_mul_i32 s31, s31, 28
    s_mul_i32 s33, s18, 7
    s_add_u32 s31, s31, s33
    s_mov_b32 s20, s10
    s_mov_b32 s21, s11
    s_movk_i32 s22, 896
    s_lshl_b32 s23, s31, 5
    s_lshl_b32 s24, s32, 4
    s_mov_b32 s25, 1
    s_mul_i32 s33, s32, 56
    s_add_u32 s33, s33, s31
    s_lshl_b32 s33, s33, 10
    s_add_u32 s33, s33, 0x12d1000
    s_mov_b32 s28, 7
    s_add_u32 s26, s16, s33
    s_addc_u32 s27, s17, 0
.prep_kernel_tr3:
    s_cmp_eq_u32 s25, 1
    s_cselect_b32 s30, 4, 8
    s_cselect_b32 s31, 12, 0
    s_mul_i32 s31, s31, s22
    v_mul_lo_u32 v10, v2, s30
    v_add_u32 v10, s23, v10
    v_mul_lo_u32 v10, v10, s22
    v_add_u32 v11, s24, v3
    v_lshl_add_u32 v11, v11, 1, v10
    v_add_u32 v12, s22, v11
    v_add_u32 v13, s22, v12
    v_add_u32 v14, s22, v13
    v_add_u32 v15, s22, v14
    v_add_u32 v15, s31, v15
    v_add_u32 v16, s22, v15
    v_add_u32 v17, s22, v16
    v_add_u32 v18, s22, v17
    v_lshlrev_b32 v4, 4, v1
    s_lshl_b32 s32, s22, 5
    global_load_ushort v32, v11, s[20:21]
    global_load_ushort v33, v12, s[20:21]
    global_load_ushort v34, v13, s[20:21]
    global_load_ushort v35, v14, s[20:21]
    global_load_ushort v36, v15, s[20:21]
    global_load_ushort v37, v16, s[20:21]
    global_load_ushort v38, v17, s[20:21]
    global_load_ushort v39, v18, s[20:21]
    s_add_u32 s20, s20, s32
    s_addc_u32 s21, s21, 0
    global_load_ushort v40, v11, s[20:21]
    global_load_ushort v41, v12, s[20:21]
    global_load_ushort v42, v13, s[20:21]
    global_load_ushort v43, v14, s[20:21]
    global_load_ushort v44, v15, s[20:21]
    global_load_ushort v45, v16, s[20:21]
    global_load_ushort v46, v17, s[20:21]
    global_load_ushort v47, v18, s[20:21]
    s_add_u32 s20, s20, s32
    s_addc_u32 s21, s21, 0
    global_load_ushort v48, v11, s[20:21]
    global_load_ushort v49, v12, s[20:21]
    global_load_ushort v50, v13, s[20:21]
    global_load_ushort v51, v14, s[20:21]
    global_load_ushort v52, v15, s[20:21]
    global_load_ushort v53, v16, s[20:21]
    global_load_ushort v54, v17, s[20:21]
    global_load_ushort v55, v18, s[20:21]
    s_add_u32 s20, s20, s32
    s_addc_u32 s21, s21, 0
    global_load_ushort v56, v11, s[20:21]
    global_load_ushort v57, v12, s[20:21]
    global_load_ushort v58, v13, s[20:21]
    global_load_ushort v59, v14, s[20:21]
    global_load_ushort v60, v15, s[20:21]
    global_load_ushort v61, v16, s[20:21]
    global_load_ushort v62, v17, s[20:21]
    global_load_ushort v63, v18, s[20:21]
    s_add_u32 s20, s20, s32
    s_addc_u32 s21, s21, 0
    global_load_ushort v64, v11, s[20:21]
    global_load_ushort v65, v12, s[20:21]
    global_load_ushort v66, v13, s[20:21]
    global_load_ushort v67, v14, s[20:21]
    global_load_ushort v68, v15, s[20:21]
    global_load_ushort v69, v16, s[20:21]
    global_load_ushort v70, v17, s[20:21]
    global_load_ushort v71, v18, s[20:21]
    s_add_u32 s20, s20, s32
    s_addc_u32 s21, s21, 0
    global_load_ushort v72, v11, s[20:21]
    global_load_ushort v73, v12, s[20:21]
    global_load_ushort v74, v13, s[20:21]
    global_load_ushort v75, v14, s[20:21]
    global_load_ushort v76, v15, s[20:21]
    global_load_ushort v77, v16, s[20:21]
    global_load_ushort v78, v17, s[20:21]
    global_load_ushort v79, v18, s[20:21]
    s_add_u32 s20, s20, s32
    s_addc_u32 s21, s21, 0
    global_load_ushort v80, v11, s[20:21]
    global_load_ushort v81, v12, s[20:21]
    global_load_ushort v82, v13, s[20:21]
    global_load_ushort v83, v14, s[20:21]
    global_load_ushort v84, v15, s[20:21]
    global_load_ushort v85, v16, s[20:21]
    global_load_ushort v86, v17, s[20:21]
    global_load_ushort v87, v18, s[20:21]
    s_add_u32 s20, s20, s32
    s_addc_u32 s21, s21, 0
    s_cmp_eq_u32 s28, 7
    s_cbranch_scc1 .prep_kernel_tr710
    global_load_ushort v88, v11, s[20:21]
    global_load_ushort v89, v12, s[20:21]
    global_load_ushort v90, v13, s[20:21]
    global_load_ushort v91, v14, s[20:21]
    global_load_ushort v92, v15, s[20:21]
    global_load_ushort v93, v16, s[20:21]
    global_load_ushort v94, v17, s[20:21]
    global_load_ushort v95, v18, s[20:21]
    s_add_u32 s20, s20, s32
    s_addc_u32 s21, s21, 0
.prep_kernel_tr710:
    s_waitcnt vmcnt(0)
    v_lshl_or_b32 v96, v33, 16, v32
    v_lshl_or_b32 v97, v35, 16, v34
    v_lshl_or_b32 v98, v37, 16, v36
    v_lshl_or_b32 v99, v39, 16, v38
    global_store_dwordx4 v4, v[96:99], s[26:27] offset:0
    v_lshl_or_b32 v100, v41, 16, v40
    v_lshl_or_b32 v101, v43, 16, v42
    v_lshl_or_b32 v102, v45, 16, v44
    v_lshl_or_b32 v103, v47, 16, v46
    global_store_dwordx4 v4, v[100:103], s[26:27] offset:1024
    v_lshl_or_b32 v104, v49, 16, v48
    v_lshl_or_b32 v105, v51, 16, v50
    v_lshl_or_b32 v106, v53, 16, v52
    v_lshl_or_b32 v107, v55, 16, v54
    global_store_dwordx4 v4, v[104:107], s[26:27] offset:2048
    v_lshl_or_b32 v108, v57, 16, v56
    v_lshl_or_b32 v109, v59, 16, v58
    v_lshl_or_b32 v110, v61, 16, v60
    v_lshl_or_b32 v111, v63, 16, v62
    global_store_dwordx4 v4, v[108:111], s[26:27] offset:3072
    s_add_u32 s26, s26, 4096
    s_addc_u32 s27, s27, 0
    v_lshl_or_b32 v112, v65, 16, v64
    v_lshl_or_b32 v113, v67, 16, v66
    v_lshl_or_b32 v114, v69, 16, v68
    v_lshl_or_b32 v115, v71, 16, v70
    global_store_dwordx4 v4, v[112:115], s[26:27] offset:0
    v_lshl_or_b32 v116, v73, 16, v72
    v_lshl_or_b32 v117, v75, 16, v74
    v_lshl_or_b32 v118, v77, 16, v76
    v_lshl_or_b32 v119, v79, 16, v78
    global_store_dwordx4 v4, v[116:119], s[26:27] offset:1024
    v_lshl_or_b32 v120, v81, 16, v80
    v_lshl_or_b32 v121, v83, 16, v82
    v_lshl_or_b32 v122, v85, 16, v84
    v_lshl_or_b32 v123, v87, 16, v86
    global_store_dwordx4 v4, v[120:123], s[26:27] offset:2048
    s_cmp_eq_u32 s28, 7
    s_cbranch_scc1 .prep_kernel_end1
    v_lshl_or_b32 v124, v89, 16, v88
    v_lshl_or_b32 v125, v91, 16, v90
    v_lshl_or_b32 v126, v93, 16, v92
    v_lshl_or_b32 v127, v95, 16, v94
    global_store_dwordx4 v4, v[124:127], s[26:27] offset:3072
    s_branch .prep_kernel_end1
.prep_kernel_fill4:
    s_sub_u32 s30, s2, 312
    s_lshl_b32 s30, s30, 16
    s_lshl_b32 s31, s18, 14
    s_add_u32 s30, s30, s31
    s_add_u32 s30, s30, 0x42bac00
    s_add_u32 s26, s16, s30
    s_addc_u32 s27, s17, 0
    v_lshlrev_b32 v4, 4, v1
    v_mov_b32 v20, -1
    v_mov_b32 v21, -1
    v_mov_b32 v22, -1
    v_mov_b32 v23, -1
    global_store_dwordx4 v4, v[20:23], s[26:27] offset:0
    global_store_dwordx4 v4, v[20:23], s[26:27] offset:1024
    global_store_dwordx4 v4, v[20:23], s[26:27] offset:2048
    global_store_dwordx4 v4, v[20:23], s[26:27] offset:3072
    s_add_u32 s26, s26, 4096
    s_addc_u32 s27, s27, 0
    global_store_dwordx4 v4, v[20:23], s[26:27] offset:0
    global_store_dwordx4 v4, v[20:23], s[26:27] offset:1024
    global_store_dwordx4 v4, v[20:23], s[26:27] offset:2048
    global_store_dwordx4 v4, v[20:23], s[26:27] offset:3072
    s_add_u32 s26, s26, 4096
    s_addc_u32 s27, s27, 0
    global_store_dwordx4 v4, v[20:23], s[26:27] offset:0
    global_store_dwordx4 v4, v[20:23], s[26:27] offset:1024
    global_store_dwordx4 v4, v[20:23], s[26:27] offset:2048
    global_store_dwordx4 v4, v[20:23], s[26:27] offset:3072
    s_add_u32 s26, s26, 4096
    s_addc_u32 s27, s27, 0
    global_store_dwordx4 v4, v[20:23], s[26:27] offset:0
    global_store_dwordx4 v4, v[20:23], s[26:27] offset:1024
    global_store_dwordx4 v4, v[20:23], s[26:27] offset:2048
    global_store_dwordx4 v4, v[20:23], s[26:27] offset:3072
    s_branch .prep_kernel_end1
.prep_kernel_misc5:
    s_cmp_eq_u32 s18, 1
    s_cbranch_scc1 .prep_kernel_ctl11
    s_cmp_lg_u32 s18, 0
    s_cbranch_scc1 .prep_kernel_end1
    v_mul_u32_u24 v4, 896, v3
    v_lshl_add_u32 v4, v2, 3, v4
    v_lshl_add_u32 v5, v2, 3, v3
    v_lshlrev_b32 v5, 4, v5
    v_cmp_gt_u32 vcc, 8, v3
    s_and_saveexec_b64 s[30:31], vcc
    s_add_u32 s26, s16, 0x42b9000
    s_addc_u32 s27, s17, 0
    global_load_dwordx2 v[10:11], v4, s[6:7] offset:0
    global_load_dwordx2 v[12:13], v4, s[6:7] offset:32
    global_load_dwordx2 v[14:15], v4, s[6:7] offset:64
    global_load_dwordx2 v[16:17], v4, s[6:7] offset:96
    global_load_dwordx2 v[18:19], v4, s[6:7] offset:128
    global_load_dwordx2 v[20:21], v4, s[6:7] offset:160
    global_load_dwordx2 v[22:23], v4, s[6:7] offset:192
    global_load_dwordx2 v[24:25], v4, s[6:7] offset:224
    global_load_dwordx2 v[26:27], v4, s[6:7] offset:256
    global_load_dwordx2 v[28:29], v4, s[6:7] offset:288
    global_load_dwordx2 v[30:31], v4, s[6:7] offset:320
    global_load_dwordx2 v[32:33], v4, s[6:7] offset:352
    global_load_dwordx2 v[34:35], v4, s[6:7] offset:384
    global_load_dwordx2 v[36:37], v4, s[6:7] offset:416
    global_load_dwordx2 v[38:39], v4, s[6:7] offset:448
    global_load_dwordx2 v[40:41], v4, s[6:7] offset:480
    global_load_dwordx2 v[42:43], v4, s[6:7] offset:512
    global_load_dwordx2 v[44:45], v4, s[6:7] offset:544
    global_load_dwordx2 v[46:47], v4, s[6:7] offset:576
    global_load_dwordx2 v[48:49], v4, s[6:7] offset:608
    global_load_dwordx2 v[50:51], v4, s[6:7] offset:640
    global_load_dwordx2 v[52:53], v4, s[6:7] offset:672
    global_load_dwordx2 v[54:55], v4, s[6:7] offset:704
    global_load_dwordx2 v[56:57], v4, s[6:7] offset:736
    global_load_dwordx2 v[58:59], v4, s[6:7] offset:768
    global_load_dwordx2 v[60:61], v4, s[6:7] offset:800
    global_load_dwordx2 v[62:63], v4, s[6:7] offset:832
    global_load_dwordx2 v[64:65], v4, s[6:7] offset:864
    s_waitcnt vmcnt(0)
    global_store_dwordx4 v5, v[10:13], s[26:27] offset:0
    global_store_dwordx4 v5, v[14:17], s[26:27] offset:512
    global_store_dwordx4 v5, v[18:21], s[26:27] offset:1024
    global_store_dwordx4 v5, v[22:25], s[26:27] offset:1536
    global_store_dwordx4 v5, v[26:29], s[26:27] offset:2048
    global_store_dwordx4 v5, v[30:33], s[26:27] offset:2560
    global_store_dwordx4 v5, v[34:37], s[26:27] offset:3072
    global_store_dwordx4 v5, v[38:41], s[26:27] offset:3584
    s_add_u32 s26, s26, 4096
    s_addc_u32 s27, s27, 0
    global_store_dwordx4 v5, v[42:45], s[26:27] offset:0
    global_store_dwordx4 v5, v[46:49], s[26:27] offset:512
    global_store_dwordx4 v5, v[50:53], s[26:27] offset:1024
    global_store_dwordx4 v5, v[54:57], s[26:27] offset:1536
    global_store_dwordx4 v5, v[58:61], s[26:27] offset:2048
    global_store_dwordx4 v5, v[62:65], s[26:27] offset:2560
    s_add_u32 s26, s16, 0x472b000
    s_addc_u32 s27, s17, 0
    global_store_dwordx4 v5, v[10:13], s[26:27] offset:0
    global_store_dwordx4 v5, v[14:17], s[26:27] offset:512
    global_store_dwordx4 v5, v[18:21], s[26:27] offset:1024
    global_store_dwordx4 v5, v[22:25], s[26:27] offset:1536
    global_store_dwordx4 v5, v[26:29], s[26:27] offset:2048
    global_store_dwordx4 v5, v[30:33], s[26:27] offset:2560
    global_store_dwordx4 v5, v[34:37], s[26:27] offset:3072
    global_store_dwordx4 v5, v[38:41], s[26:27] offset:3584
    s_add_u32 s26, s26, 4096
    s_addc_u32 s27, s27, 0
    global_store_dwordx4 v5, v[42:45], s[26:27] offset:0
    global_store_dwordx4 v5, v[46:49], s[26:27] offset:512
    global_store_dwordx4 v5, v[50:53], s[26:27] offset:1024
    global_store_dwordx4 v5, v[54:57], s[26:27] offset:1536
    global_store_dwordx4 v5, v[58:61], s[26:27] offset:2048
    global_store_dwordx4 v5, v[62:65], s[26:27] offset:2560
    s_mov_b64 exec, s[30:31]
    s_branch .prep_kernel_end1
.prep_kernel_ctl11:
    s_add_u32 s26, s16, 0x0
    s_addc_u32 s27, s17, 0
    v_lshlrev_b32 v4, 4, v1
    v_mov_b32 v8, 0
    v_mov_b32 v9, 0
    v_mov_b32 v10, 0
    v_mov_b32 v11, 0
    global_store_dwordx4 v4, v[8:11], s[26:27]
    global_store_dwordx4 v4, v[8:11], s[26:27] offset:1024
.prep_kernel_end1:
    s_endpgm
.globl fold_kernel
.p2align 8
.type fold_kernel,@function
fold_kernel:
    s_cmp_ge_u32 s2, 336
    s_cbranch_scc1 .fold_kernel_end1
    s_load_dwordx4 s[4:7], s[0:1], 16
    s_load_dwordx2 s[8:9], s[0:1], 32
    s_load_dwordx2 s[16:17], s[0:1], 104
    v_lshrrev_b32 v2, 6, v0
    v_and_b32 v1, 63, v0
    s_nop 0
    v_readfirstlane_b32 s18, v2
    v_lshrrev_b32 v2, 4, v1
    v_and_b32 v3, 15, v1
    s_mul_i32 s21, s2, 0x556
    s_lshr_b32 s21, s21, 16
    s_mul_i32 s20, s21, 48
    s_sub_u32 s20, s2, s20
    s_lshr_b32 s22, s20, 4
    s_and_b32 s23, s20, 15
    s_lshl_b32 s21, s21, 1
    s_lshr_b32 s24, s18, 1
    s_add_u32 s21, s21, s24
    s_and_b32 s24, s18, 1
    s_waitcnt lgkmcnt(0)
    s_mul_i32 s25, s22, 3670016
    s_add_u32 s25, s25, 0x541000
    s_mul_i32 s28, s23, 28
    s_lshl_b32 s29, s21, 1
    s_add_u32 s29, s29, s28
    s_lshl_b32 s29, s29, 13
    s_add_u32 s25, s25, s29
    s_add_u32 s26, s16, s25
    s_addc_u32 s27, s17, 0
    v_lshlrev_b32 v4, 4, v1
    global_load_dwordx4 v[16:19], v4, s[26:27] offset:0
    global_load_dwordx4 v[20:23], v4, s[26:27] offset:1024
    global_load_dwordx4 v[24:27], v4, s[26:27] offset:2048
    global_load_dwordx4 v[28:31], v4, s[26:27] offset:3072
    s_add_u32 s26, s26, 4096
    s_addc_u32 s27, s27, 0
    global_load_dwordx4 v[32:35], v4, s[26:27] offset:0
    global_load_dwordx4 v[36:39], v4, s[26:27] offset:1024
    global_load_dwordx4 v[40:43], v4, s[26:27] offset:2048
    global_load_dwordx4 v[44:47], v4, s[26:27] offset:3072
    s_add_u32 s26, s26, 4096
    s_addc_u32 s27, s27, 0
    global_load_dwordx4 v[48:51], v4, s[26:27] offset:0
    global_load_dwordx4 v[52:55], v4, s[26:27] offset:1024
    global_load_dwordx4 v[56:59], v4, s[26:27] offset:2048
    global_load_dwordx4 v[60:63], v4, s[26:27] offset:3072
    s_add_u32 s26, s26, 4096
    s_addc_u32 s27, s27, 0
    global_load_dwordx4 v[64:67], v4, s[26:27] offset:0
    global_load_dwordx4 v[68:71], v4, s[26:27] offset:1024
    global_load_dwordx4 v[72:75], v4, s[26:27] offset:2048
    global_load_dwordx4 v[76:79], v4, s[26:27] offset:3072
    s_mov_b32 s25, 0x8c1000
    s_cmp_eq_u32 s22, 1
    s_cselect_b32 s25, 0x541000, s25
    s_cmp_eq_u32 s22, 2
    s_cselect_b32 s25, 0x1c1000, s25
    s_mul_i32 s29, s24, 14
    s_add_u32 s29, s29, s28
    s_lshl_b32 s29, s29, 13
    s_add_u32 s25, s25, s29
    s_movk_i32 s32, 8192
    s_add_u32 s30, s16, s25
    s_addc_u32 s31, s17, 0
    v_add_u32 v8, 0, v4
    v_add_u32 v9, 1024, v4
    v_add_u32 v10, 2048, v4
    v_add_u32 v11, 3072, v4
    v_add_u32 v12, 4096, v4
    v_add_u32 v13, 5120, v4
    v_add_u32 v14, 6144, v4
    v_add_u32 v15, 7168, v4
    s_mul_i32 s25, s22, 6422528
    s_add_u32 s25, s25, 0x1459000
    s_mul_i32 s29, s23, 28
    s_mul_i32 s33, s24, 14
    s_add_u32 s29, s29, s33
    s_mul_i32 s29, s29, 14
    s_add_u32 s29, s29, s21
    s_lshl_b32 s29, s29, 10
    s_add_u32 s25, s25, s29
    s_add_u32 s34, s16, s25
    s_addc_u32 s35, s17, 0
    v_lshlrev_b32 v5, 4, v1
    global_load_dwordx4 v[80:83], v8, s[30:31]
    global_load_dwordx4 v[84:87], v9, s[30:31]
    global_load_dwordx4 v[88:91], v10, s[30:31]
    global_load_dwordx4 v[92:95], v11, s[30:31]
    global_load_dwordx4 v[96:99], v12, s[30:31]
    global_load_dwordx4 v[100:103], v13, s[30:31]
    global_load_dwordx4 v[104:107], v14, s[30:31]
    global_load_dwordx4 v[108:111], v15, s[30:31]
    s_add_u32 s30, s30, s32
    s_addc_u32 s31, s31, 0
    global_load_dwordx4 v[112:115], v8, s[30:31]
    global_load_dwordx4 v[116:119], v9, s[30:31]
    global_load_dwordx4 v[120:123], v10, s[30:31]
    global_load_dwordx4 v[124:127], v11, s[30:31]
    global_load_dwordx4 v[128:131], v12, s[30:31]
    global_load_dwordx4 v[132:135], v13, s[30:31]
    global_load_dwordx4 v[136:139], v14, s[30:31]
    global_load_dwordx4 v[140:143], v15, s[30:31]
    s_add_u32 s30, s30, s32
    s_addc_u32 s31, s31, 0
    global_load_dwordx4 v[144:147], v8, s[30:31]
    global_load_dwordx4 v[148:151], v9, s[30:31]
    global_load_dwordx4 v[152:155], v10, s[30:31]
    global_load_dwordx4 v[156:159], v11, s[30:31]
    global_load_dwordx4 v[160:163], v12, s[30:31]
    global_load_dwordx4 v[164:167], v13, s[30:31]
    global_load_dwordx4 v[168:171], v14, s[30:31]
    global_load_dwordx4 v[172:175], v15, s[30:31]
    s_add_u32 s30, s30, s32
    s_addc_u32 s31, s31, 0
    s_waitcnt vmcnt(16)
    v_mfma_f32_16x16x32_bf16 v[176:179], v[16:19], v[80:83], 0
    v_mfma_f32_16x16x32_bf16 v[180:183], v[48:51], v[80:83], 0
    v_mfma_f32_16x16x32_bf16 v[176:179], v[20:23], v[84:87], v[176:179]
    v_mfma_f32_16x16x32_bf16 v[180:183], v[52:55], v[84:87], v[180:183]
    v_mfma_f32_16x16x32_bf16 v[176:179], v[24:27], v[88:91], v[176:179]
    v_mfma_f32_16x16x32_bf16 v[180:183], v[56:59], v[88:91], v[180:183]
    v_mfma_f32_16x16x32_bf16 v[176:179], v[28:31], v[92:95], v[176:179]
    v_mfma_f32_16x16x32_bf16 v[180:183], v[60:63], v[92:95], v[180:183]
    v_mfma_f32_16x16x32_bf16 v[176:179], v[32:35], v[96:99], v[176:179]
    v_mfma_f32_16x16x32_bf16 v[180:183], v[64:67], v[96:99], v[180:183]
    v_mfma_f32_16x16x32_bf16 v[176:179], v[36:39], v[100:103], v[176:179]
    v_mfma_f32_16x16x32_bf16 v[180:183], v[68:71], v[100:103], v[180:183]
    v_mfma_f32_16x16x32_bf16 v[176:179], v[40:43], v[104:107], v[176:179]
    v_mfma_f32_16x16x32_bf16 v[180:183], v[72:75], v[104:107], v[180:183]
    v_mfma_f32_16x16x32_bf16 v[176:179], v[44:47], v[108:111], v[176:179]
    v_mfma_f32_16x16x32_bf16 v[180:183], v[76:79], v[108:111], v[180:183]
    s_nop 7
    v_cvt_pk_bf16_f32 v184, v176, v177
    v_cvt_pk_bf16_f32 v185, v178, v179
    v_cvt_pk_bf16_f32 v186, v180, v181
    v_cvt_pk_bf16_f32 v187, v182, v183
    global_store_dwordx4 v5, v[184:187], s[34:35]
    s_add_u32 s34, s34, 14336
    s_addc_u32 s35, s35, 0
    global_load_dwordx4 v[80:83], v8, s[30:31]
    global_load_dwordx4 v[84:87], v9, s[30:31]
    global_load_dwordx4 v[88:91], v10, s[30:31]
    global_load_dwordx4 v[92:95], v11, s[30:31]
    global_load_dwordx4 v[96:99], v12, s[30:31]
    global_load_dwordx4 v[100:103], v13, s[30:31]
    global_load_dwordx4 v[104:107], v14, s[30:31]
    global_load_dwordx4 v[108:111], v15, s[30:31]
    s_add_u32 s30, s30, s32
    s_addc_u32 s31, s31, 0
    s_waitcnt vmcnt(17)
    v_mfma_f32_16x16x32_bf16 v[176:179], v[16:19], v[112:115], 0
    v_mfma_f32_16x16x32_bf16 v[180:183], v[48:51], v[112:115], 0
    v_mfma_f32_16x16x32_bf16 v[176:179], v[20:23], v[116:119], v[176:179]
    v_mfma_f32_16x16x32_bf16 v[180:183], v[52:55], v[116:119], v[180:183]
    v_mfma_f32_16x16x32_bf16 v[176:179], v[24:27], v[120:123], v[176:179]
    v_mfma_f32_16x16x32_bf16 v[180:183], v[56:59], v[120:123], v[180:183]
    v_mfma_f32_16x16x32_bf16 v[176:179], v[28:31], v[124:127], v[176:179]
    v_mfma_f32_16x16x32_bf16 v[180:183], v[60:63], v[124:127], v[180:183]
    v_mfma_f32_16x16x32_bf16 v[176:179], v[32:35], v[128:131], v[176:179]
    v_mfma_f32_16x16x32_bf16 v[180:183], v[64:67], v[128:131], v[180:183]
    v_mfma_f32_16x16x32_bf16 v[176:179], v[36:39], v[132:135], v[176:179]
    v_mfma_f32_16x16x32_bf16 v[180:183], v[68:71], v[132:135], v[180:183]
    v_mfma_f32_16x16x32_bf16 v[176:179], v[40:43], v[136:139], v[176:179]
    v_mfma_f32_16x16x32_bf16 v[180:183], v[72:75], v[136:139], v[180:183]
    v_mfma_f32_16x16x32_bf16 v[176:179], v[44:47], v[140:143], v[176:179]
    v_mfma_f32_16x16x32_bf16 v[180:183], v[76:79], v[140:143], v[180:183]
    s_nop 7
    v_cvt_pk_bf16_f32 v188, v176, v177
    v_cvt_pk_bf16_f32 v189, v178, v179
    v_cvt_pk_bf16_f32 v190, v180, v181
    v_cvt_pk_bf16_f32 v191, v182, v183
    global_store_dwordx4 v5, v[188:191], s[34:35]
    s_add_u32 s34, s34, 14336
    s_addc_u32 s35, s35, 0
    global_load_dwordx4 v[112:115], v8, s[30:31]
    global_load_dwordx4 v[116:119], v9, s[30:31]
    global_load_dwordx4 v[120:123], v10, s[30:31]
    global_load_dwordx4 v[124:127], v11, s[30:31]
    global_load_dwordx4 v[128:131], v12, s[30:31]
    global_load_dwordx4 v[132:135], v13, s[30:31]
    global_load_dwordx4 v[136:139], v14, s[30:31]
    global_load_dwordx4 v[140:143], v15, s[30:31]
    s_add_u32 s30, s30, s32
    s_addc_u32 s31, s31, 0
    s_waitcnt vmcnt(18)
    v_mfma_f32_16x16x32_bf16 v[176:179], v[16:19], v[144:147], 0
    v_mfma_f32_16x16x32_bf16 v[180:183], v[48:51], v[144:147], 0
    v_mfma_f32_16x16x32_bf16 v[176:179], v[20:23], v[148:151], v[176:179]
    v_mfma_f32_16x16x32_bf16 v[180:183], v[52:55], v[148:151], v[180:183]
    v_mfma_f32_16x16x32_bf16 v[176:179], v[24:27], v[152:155], v[176:179]
    v_mfma_f32_16x16x32_bf16 v[180:183], v[56:59], v[152:155], v[180:183]
    v_mfma_f32_16x16x32_bf16 v[176:179], v[28:31], v[156:159], v[176:179]
    v_mfma_f32_16x16x32_bf16 v[180:183], v[60:63], v[156:159], v[180:183]
    v_mfma_f32_16x16x32_bf16 v[176:179], v[32:35], v[160:163], v[176:179]
    v_mfma_f32_16x16x32_bf16 v[180:183], v[64:67], v[160:163], v[180:183]
    v_mfma_f32_16x16x32_bf16 v[176:179], v[36:39], v[164:167], v[176:179]
    v_mfma_f32_16x16x32_bf16 v[180:183], v[68:71], v[164:167], v[180:183]
    v_mfma_f32_16x16x32_bf16 v[176:179], v[40:43], v[168:171], v[176:179]
    v_mfma_f32_16x16x32_bf16 v[180:183], v[72:75], v[168:171], v[180:183]
    v_mfma_f32_16x16x32_bf16 v[176:179], v[44:47], v[172:175], v[176:179]
    v_mfma_f32_16x16x32_bf16 v[180:183], v[76:79], v[172:175], v[180:183]
    s_nop 7
    v_cvt_pk_bf16_f32 v184, v176, v177
    v_cvt_pk_bf16_f32 v185, v178, v179
    v_cvt_pk_bf16_f32 v186, v180, v181
    v_cvt_pk_bf16_f32 v187, v182, v183
    global_store_dwordx4 v5, v[184:187], s[34:35]
    s_add_u32 s34, s34, 14336
    s_addc_u32 s35, s35, 0
    global_load_dwordx4 v[144:147], v8, s[30:31]
    global_load_dwordx4 v[148:151], v9, s[30:31]
    global_load_dwordx4 v[152:155], v10, s[30:31]
    global_load_dwordx4 v[156:159], v11, s[30:31]
    global_load_dwordx4 v[160:163], v12, s[30:31]
    global_load_dwordx4 v[164:167], v13, s[30:31]
    global_load_dwordx4 v[168:171], v14, s[30:31]
    global_load_dwordx4 v[172:175], v15, s[30:31]
    s_add_u32 s30, s30, s32
    s_addc_u32 s31, s31, 0
    s_waitcnt vmcnt(18)
    v_mfma_f32_16x16x32_bf16 v[176:179], v[16:19], v[80:83], 0
    v_mfma_f32_16x16x32_bf16 v[180:183], v[48:51], v[80:83], 0
    v_mfma_f32_16x16x32_bf16 v[176:179], v[20:23], v[84:87], v[176:179]
    v_mfma_f32_16x16x32_bf16 v[180:183], v[52:55], v[84:87], v[180:183]
    v_mfma_f32_16x16x32_bf16 v[176:179], v[24:27], v[88:91], v[176:179]
    v_mfma_f32_16x16x32_bf16 v[180:183], v[56:59], v[88:91], v[180:183]
    v_mfma_f32_16x16x32_bf16 v[176:179], v[28:31], v[92:95], v[176:179]
    v_mfma_f32_16x16x32_bf16 v[180:183], v[60:63], v[92:95], v[180:183]
    v_mfma_f32_16x16x32_bf16 v[176:179], v[32:35], v[96:99], v[176:179]
    v_mfma_f32_16x16x32_bf16 v[180:183], v[64:67], v[96:99], v[180:183]
    v_mfma_f32_16x16x32_bf16 v[176:179], v[36:39], v[100:103], v[176:179]
    v_mfma_f32_16x16x32_bf16 v[180:183], v[68:71], v[100:103], v[180:183]
    v_mfma_f32_16x16x32_bf16 v[176:179], v[40:43], v[104:107], v[176:179]
    v_mfma_f32_16x16x32_bf16 v[180:183], v[72:75], v[104:107], v[180:183]
    v_mfma_f32_16x16x32_bf16 v[176:179], v[44:47], v[108:111], v[176:179]
    v_mfma_f32_16x16x32_bf16 v[180:183], v[76:79], v[108:111], v[180:183]
    s_nop 7
    v_cvt_pk_bf16_f32 v188, v176, v177
    v_cvt_pk_bf16_f32 v189, v178, v179
    v_cvt_pk_bf16_f32 v190, v180, v181
    v_cvt_pk_bf16_f32 v191, v182, v183
    global_store_dwordx4 v5, v[188:191], s[34:35]
    s_add_u32 s34, s34, 14336
    s_addc_u32 s35, s35, 0
    global_load_dwordx4 v[80:83], v8, s[30:31]
    global_load_dwordx4 v[84:87], v9, s[30:31]
    global_load_dwordx4 v[88:91], v10, s[30:31]
    global_load_dwordx4 v[92:95], v11, s[30:31]
    global_load_dwordx4 v[96:99], v12, s[30:31]
    global_load_dwordx4 v[100:103], v13, s[30:31]
    global_load_dwordx4 v[104:107], v14, s[30:31]
    global_load_dwordx4 v[108:111], v15, s[30:31]
    s_add_u32 s30, s30, s32
    s_addc_u32 s31, s31, 0
    s_waitcnt vmcnt(18)
    v_mfma_f32_16x16x32_bf16 v[176:179], v[16:19], v[112:115], 0
    v_mfma_f32_16x16x32_bf16 v[180:183], v[48:51], v[112:115], 0
    v_mfma_f32_16x16x32_bf16 v[176:179], v[20:23], v[116:119], v[176:179]
    v_mfma_f32_16x16x32_bf16 v[180:183], v[52:55], v[116:119], v[180:183]
    v_mfma_f32_16x16x32_bf16 v[176:179], v[24:27], v[120:123], v[176:179]
    v_mfma_f32_16x16x32_bf16 v[180:183], v[56:59], v[120:123], v[180:183]
    v_mfma_f32_16x16x32_bf16 v[176:179], v[28:31], v[124:127], v[176:179]
    v_mfma_f32_16x16x32_bf16 v[180:183], v[60:63], v[124:127], v[180:183]
    v_mfma_f32_16x16x32_bf16 v[176:179], v[32:35], v[128:131], v[176:179]
    v_mfma_f32_16x16x32_bf16 v[180:183], v[64:67], v[128:131], v[180:183]
    v_mfma_f32_16x16x32_bf16 v[176:179], v[36:39], v[132:135], v[176:179]
    v_mfma_f32_16x16x32_bf16 v[180:183], v[68:71], v[132:135], v[180:183]
    v_mfma_f32_16x16x32_bf16 v[176:179], v[40:43], v[136:139], v[176:179]
    v_mfma_f32_16x16x32_bf16 v[180:183], v[72:75], v[136:139], v[180:183]
    v_mfma_f32_16x16x32_bf16 v[176:179], v[44:47], v[140:143], v[176:179]
    v_mfma_f32_16x16x32_bf16 v[180:183], v[76:79], v[140:143], v[180:183]
    s_nop 7
    v_cvt_pk_bf16_f32 v184, v176, v177
    v_cvt_pk_bf16_f32 v185, v178, v179
    v_cvt_pk_bf16_f32 v186, v180, v181
    v_cvt_pk_bf16_f32 v187, v182, v183
    global_store_dwordx4 v5, v[184:187], s[34:35]
    s_add_u32 s34, s34, 14336
    s_addc_u32 s35, s35, 0
    global_load_dwordx4 v[112:115], v8, s[30:31]
    global_load_dwordx4 v[116:119], v9, s[30:31]
    global_load_dwordx4 v[120:123], v10, s[30:31]
    global_load_dwordx4 v[124:127], v11, s[30:31]
    global_load_dwordx4 v[128:131], v12, s[30:31]
    global_load_dwordx4 v[132:135], v13, s[30:31]
    global_load_dwordx4 v[136:139], v14, s[30:31]
    global_load_dwordx4 v[140:143], v15, s[30:31]
    s_add_u32 s30, s30, s32
    s_addc_u32 s31, s31, 0
    s_waitcnt vmcnt(18)
    v_mfma_f32_16x16x32_bf16 v[176:179], v[16:19], v[144:147], 0
    v_mfma_f32_16x16x32_bf16 v[180:183], v[48:51], v[144:147], 0
    v_mfma_f32_16x16x32_bf16 v[176:179], v[20:23], v[148:151], v[176:179]
    v_mfma_f32_16x16x32_bf16 v[180:183], v[52:55], v[148:151], v[180:183]
    v_mfma_f32_16x16x32_bf16 v[176:179], v[24:27], v[152:155], v[176:179]
    v_mfma_f32_16x16x32_bf16 v[180:183], v[56:59], v[152:155], v[180:183]
    v_mfma_f32_16x16x32_bf16 v[176:179], v[28:31], v[156:159], v[176:179]
    v_mfma_f32_16x16x32_bf16 v[180:183], v[60:63], v[156:159], v[180:183]
    v_mfma_f32_16x16x32_bf16 v[176:179], v[32:35], v[160:163], v[176:179]
    v_mfma_f32_16x16x32_bf16 v[180:183], v[64:67], v[160:163], v[180:183]
    v_mfma_f32_16x16x32_bf16 v[176:179], v[36:39], v[164:167], v[176:179]
    v_mfma_f32_16x16x32_bf16 v[180:183], v[68:71], v[164:167], v[180:183]
    v_mfma_f32_16x16x32_bf16 v[176:179], v[40:43], v[168:171], v[176:179]
    v_mfma_f32_16x16x32_bf16 v[180:183], v[72:75], v[168:171], v[180:183]
    v_mfma_f32_16x16x32_bf16 v[176:179], v[44:47], v[172:175], v[176:179]
    v_mfma_f32_16x16x32_bf16 v[180:183], v[76:79], v[172:175], v[180:183]
    s_nop 7
    v_cvt_pk_bf16_f32 v188, v176, v177
    v_cvt_pk_bf16_f32 v189, v178, v179
    v_cvt_pk_bf16_f32 v190, v180, v181
    v_cvt_pk_bf16_f32 v191, v182, v183
    global_store_dwordx4 v5, v[188:191], s[34:35]
    s_add_u32 s34, s34, 14336
    s_addc_u32 s35, s35, 0
    global_load_dwordx4 v[144:147], v8, s[30:31]
    global_load_dwordx4 v[148:151], v9, s[30:31]
    global_load_dwordx4 v[152:155], v10, s[30:31]
    global_load_dwordx4 v[156:159], v11, s[30:31]
    global_load_dwordx4 v[160:163], v12, s[30:31]
    global_load_dwordx4 v[164:167], v13, s[30:31]
    global_load_dwordx4 v[168:171], v14, s[30:31]
    global_load_dwordx4 v[172:175], v15, s[30:31]
    s_add_u32 s30, s30, s32
    s_addc_u32 s31, s31, 0
    s_waitcnt vmcnt(18)
    v_mfma_f32_16x16x32_bf16 v[176:179], v[16:19], v[80:83], 0
    v_mfma_f32_16x16x32_bf16 v[180:183], v[48:51], v[80:83], 0
    v_mfma_f32_16x16x32_bf16 v[176:179], v[20:23], v[84:87], v[176:179]
    v_mfma_f32_16x16x32_bf16 v[180:183], v[52:55], v[84:87], v[180:183]
    v_mfma_f32_16x16x32_bf16 v[176:179], v[24:27], v[88:91], v[176:179]
    v_mfma_f32_16x16x32_bf16 v[180:183], v[56:59], v[88:91], v[180:183]
    v_mfma_f32_16x16x32_bf16 v[176:179], v[28:31], v[92:95], v[176:179]
    v_mfma_f32_16x16x32_bf16 v[180:183], v[60:63], v[92:95], v[180:183]
    v_mfma_f32_16x16x32_bf16 v[176:179], v[32:35], v[96:99], v[176:179]
    v_mfma_f32_16x16x32_bf16 v[180:183], v[64:67], v[96:99], v[180:183]
    v_mfma_f32_16x16x32_bf16 v[176:179], v[36:39], v[100:103], v[176:179]
    v_mfma_f32_16x16x32_bf16 v[180:183], v[68:71], v[100:103], v[180:183]
    v_mfma_f32_16x16x32_bf16 v[176:179], v[40:43], v[104:107], v[176:179]
    v_mfma_f32_16x16x32_bf16 v[180:183], v[72:75], v[104:107], v[180:183]
    v_mfma_f32_16x16x32_bf16 v[176:179], v[44:47], v[108:111], v[176:179]
    v_mfma_f32_16x16x32_bf16 v[180:183], v[76:79], v[108:111], v[180:183]
    s_nop 7
    v_cvt_pk_bf16_f32 v184, v176, v177
    v_cvt_pk_bf16_f32 v185, v178, v179
    v_cvt_pk_bf16_f32 v186, v180, v181
    v_cvt_pk_bf16_f32 v187, v182, v183
    global_store_dwordx4 v5, v[184:187], s[34:35]
    s_add_u32 s34, s34, 14336
    s_addc_u32 s35, s35, 0
    global_load_dwordx4 v[80:83], v8, s[30:31]
    global_load_dwordx4 v[84:87], v9, s[30:31]
    global_load_dwordx4 v[88:91], v10, s[30:31]
    global_load_dwordx4 v[92:95], v11, s[30:31]
    global_load_dwordx4 v[96:99], v12, s[30:31]
    global_load_dwordx4 v[100:103], v13, s[30:31]
    global_load_dwordx4 v[104:107], v14, s[30:31]
    global_load_dwordx4 v[108:111], v15, s[30:31]
    s_add_u32 s30, s30, s32
    s_addc_u32 s31, s31, 0
    s_waitcnt vmcnt(18)
    v_mfma_f32_16x16x32_bf16 v[176:179], v[16:19], v[112:115], 0
    v_mfma_f32_16x16x32_bf16 v[180:183], v[48:51], v[112:115], 0
    v_mfma_f32_16x16x32_bf16 v[176:179], v[20:23], v[116:119], v[176:179]
    v_mfma_f32_16x16x32_bf16 v[180:183], v[52:55], v[116:119], v[180:183]
    v_mfma_f32_16x16x32_bf16 v[176:179], v[24:27], v[120:123], v[176:179]
    v_mfma_f32_16x16x32_bf16 v[180:183], v[56:59], v[120:123], v[180:183]
    v_mfma_f32_16x16x32_bf16 v[176:179], v[28:31], v[124:127], v[176:179]
    v_mfma_f32_16x16x32_bf16 v[180:183], v[60:63], v[124:127], v[180:183]
    v_mfma_f32_16x16x32_bf16 v[176:179], v[32:35], v[128:131], v[176:179]
    v_mfma_f32_16x16x32_bf16 v[180:183], v[64:67], v[128:131], v[180:183]
    v_mfma_f32_16x16x32_bf16 v[176:179], v[36:39], v[132:135], v[176:179]
    v_mfma_f32_16x16x32_bf16 v[180:183], v[68:71], v[132:135], v[180:183]
    v_mfma_f32_16x16x32_bf16 v[176:179], v[40:43], v[136:139], v[176:179]
    v_mfma_f32_16x16x32_bf16 v[180:183], v[72:75], v[136:139], v[180:183]
    v_mfma_f32_16x16x32_bf16 v[176:179], v[44:47], v[140:143], v[176:179]
    v_mfma_f32_16x16x32_bf16 v[180:183], v[76:79], v[140:143], v[180:183]
    s_nop 7
    v_cvt_pk_bf16_f32 v188, v176, v177
    v_cvt_pk_bf16_f32 v189, v178, v179
    v_cvt_pk_bf16_f32 v190, v180, v181
    v_cvt_pk_bf16_f32 v191, v182, v183
    global_store_dwordx4 v5, v[188:191], s[34:35]
    s_add_u32 s34, s34, 14336
    s_addc_u32 s35, s35, 0
    global_load_dwordx4 v[112:115], v8, s[30:31]
    global_load_dwordx4 v[116:119], v9, s[30:31]
    global_load_dwordx4 v[120:123], v10, s[30:31]
    global_load_dwordx4 v[124:127], v11, s[30:31]
    global_load_dwordx4 v[128:131], v12, s[30:31]
    global_load_dwordx4 v[132:135], v13, s[30:31]
    global_load_dwordx4 v[136:139], v14, s[30:31]
    global_load_dwordx4 v[140:143], v15, s[30:31]
    s_add_u32 s30, s30, s32
    s_addc_u32 s31, s31, 0
    s_waitcnt vmcnt(18)
    v_mfma_f32_16x16x32_bf16 v[176:179], v[16:19], v[144:147], 0
    v_mfma_f32_16x16x32_bf16 v[180:183], v[48:51], v[144:147], 0
    v_mfma_f32_16x16x32_bf16 v[176:179], v[20:23], v[148:151], v[176:179]
    v_mfma_f32_16x16x32_bf16 v[180:183], v[52:55], v[148:151], v[180:183]
    v_mfma_f32_16x16x32_bf16 v[176:179], v[24:27], v[152:155], v[176:179]
    v_mfma_f32_16x16x32_bf16 v[180:183], v[56:59], v[152:155], v[180:183]
    v_mfma_f32_16x16x32_bf16 v[176:179], v[28:31], v[156:159], v[176:179]
    v_mfma_f32_16x16x32_bf16 v[180:183], v[60:63], v[156:159], v[180:183]
    v_mfma_f32_16x16x32_bf16 v[176:179], v[32:35], v[160:163], v[176:179]
    v_mfma_f32_16x16x32_bf16 v[180:183], v[64:67], v[160:163], v[180:183]
    v_mfma_f32_16x16x32_bf16 v[176:179], v[36:39], v[164:167], v[176:179]
    v_mfma_f32_16x16x32_bf16 v[180:183], v[68:71], v[164:167], v[180:183]
    v_mfma_f32_16x16x32_bf16 v[176:179], v[40:43], v[168:171], v[176:179]
    v_mfma_f32_16x16x32_bf16 v[180:183], v[72:75], v[168:171], v[180:183]
    v_mfma_f32_16x16x32_bf16 v[176:179], v[44:47], v[172:175], v[176:179]
    v_mfma_f32_16x16x32_bf16 v[180:183], v[76:79], v[172:175], v[180:183]
    s_nop 7
    v_cvt_pk_bf16_f32 v184, v176, v177
    v_cvt_pk_bf16_f32 v185, v178, v179
    v_cvt_pk_bf16_f32 v186, v180, v181
    v_cvt_pk_bf16_f32 v187, v182, v183
    global_store_dwordx4 v5, v[184:187], s[34:35]
    s_add_u32 s34, s34, 14336
    s_addc_u32 s35, s35, 0
    global_load_dwordx4 v[144:147], v8, s[30:31]
    global_load_dwordx4 v[148:151], v9, s[30:31]
    global_load_dwordx4 v[152:155], v10, s[30:31]
    global_load_dwordx4 v[156:159], v11, s[30:31]
    global_load_dwordx4 v[160:163], v12, s[30:31]
    global_load_dwordx4 v[164:167], v13, s[30:31]
    global_load_dwordx4 v[168:171], v14, s[30:31]
    global_load_dwordx4 v[172:175], v15, s[30:31]
    s_add_u32 s30, s30, s32
    s_addc_u32 s31, s31, 0
    s_waitcnt vmcnt(18)
    v_mfma_f32_16x16x32_bf16 v[176:179], v[16:19], v[80:83], 0
    v_mfma_f32_16x16x32_bf16 v[180:183], v[48:51], v[80:83], 0
    v_mfma_f32_16x16x32_bf16 v[176:179], v[20:23], v[84:87], v[176:179]
    v_mfma_f32_16x16x32_bf16 v[180:183], v[52:55], v[84:87], v[180:183]
    v_mfma_f32_16x16x32_bf16 v[176:179], v[24:27], v[88:91], v[176:179]
    v_mfma_f32_16x16x32_bf16 v[180:183], v[56:59], v[88:91], v[180:183]
    v_mfma_f32_16x16x32_bf16 v[176:179], v[28:31], v[92:95], v[176:179]
    v_mfma_f32_16x16x32_bf16 v[180:183], v[60:63], v[92:95], v[180:183]
    v_mfma_f32_16x16x32_bf16 v[176:179], v[32:35], v[96:99], v[176:179]
    v_mfma_f32_16x16x32_bf16 v[180:183], v[64:67], v[96:99], v[180:183]
    v_mfma_f32_16x16x32_bf16 v[176:179], v[36:39], v[100:103], v[176:179]
    v_mfma_f32_16x16x32_bf16 v[180:183], v[68:71], v[100:103], v[180:183]
    v_mfma_f32_16x16x32_bf16 v[176:179], v[40:43], v[104:107], v[176:179]
    v_mfma_f32_16x16x32_bf16 v[180:183], v[72:75], v[104:107], v[180:183]
    v_mfma_f32_16x16x32_bf16 v[176:179], v[44:47], v[108:111], v[176:179]
    v_mfma_f32_16x16x32_bf16 v[180:183], v[76:79], v[108:111], v[180:183]
    s_nop 7
    v_cvt_pk_bf16_f32 v188, v176, v177
    v_cvt_pk_bf16_f32 v189, v178, v179
    v_cvt_pk_bf16_f32 v190, v180, v181
    v_cvt_pk_bf16_f32 v191, v182, v183
    global_store_dwordx4 v5, v[188:191], s[34:35]
    s_add_u32 s34, s34, 14336
    s_addc_u32 s35, s35, 0
    global_load_dwordx4 v[80:83], v8, s[30:31]
    global_load_dwordx4 v[84:87], v9, s[30:31]
    global_load_dwordx4 v[88:91], v10, s[30:31]
    global_load_dwordx4 v[92:95], v11, s[30:31]
    global_load_dwordx4 v[96:99], v12, s[30:31]
    global_load_dwordx4 v[100:103], v13, s[30:31]
    global_load_dwordx4 v[104:107], v14, s[30:31]
    global_load_dwordx4 v[108:111], v15, s[30:31]
    s_add_u32 s30, s30, s32
    s_addc_u32 s31, s31, 0
    s_waitcnt vmcnt(18)
    v_mfma_f32_16x16x32_bf16 v[176:179], v[16:19], v[112:115], 0
    v_mfma_f32_16x16x32_bf16 v[180:183], v[48:51], v[112:115], 0
    v_mfma_f32_16x16x32_bf16 v[176:179], v[20:23], v[116:119], v[176:179]
    v_mfma_f32_16x16x32_bf16 v[180:183], v[52:55], v[116:119], v[180:183]
    v_mfma_f32_16x16x32_bf16 v[176:179], v[24:27], v[120:123], v[176:179]
    v_mfma_f32_16x16x32_bf16 v[180:183], v[56:59], v[120:123], v[180:183]
    v_mfma_f32_16x16x32_bf16 v[176:179], v[28:31], v[124:127], v[176:179]
    v_mfma_f32_16x16x32_bf16 v[180:183], v[60:63], v[124:127], v[180:183]
    v_mfma_f32_16x16x32_bf16 v[176:179], v[32:35], v[128:131], v[176:179]
    v_mfma_f32_16x16x32_bf16 v[180:183], v[64:67], v[128:131], v[180:183]
    v_mfma_f32_16x16x32_bf16 v[176:179], v[36:39], v[132:135], v[176:179]
    v_mfma_f32_16x16x32_bf16 v[180:183], v[68:71], v[132:135], v[180:183]
    v_mfma_f32_16x16x32_bf16 v[176:179], v[40:43], v[136:139], v[176:179]
    v_mfma_f32_16x16x32_bf16 v[180:183], v[72:75], v[136:139], v[180:183]
    v_mfma_f32_16x16x32_bf16 v[176:179], v[44:47], v[140:143], v[176:179]
    v_mfma_f32_16x16x32_bf16 v[180:183], v[76:79], v[140:143], v[180:183]
    s_nop 7
    v_cvt_pk_bf16_f32 v184, v176, v177
    v_cvt_pk_bf16_f32 v185, v178, v179
    v_cvt_pk_bf16_f32 v186, v180, v181
    v_cvt_pk_bf16_f32 v187, v182, v183
    global_store_dwordx4 v5, v[184:187], s[34:35]
    s_add_u32 s34, s34, 14336
    s_addc_u32 s35, s35, 0
    global_load_dwordx4 v[112:115], v8, s[30:31]
    global_load_dwordx4 v[116:119], v9, s[30:31]
    global_load_dwordx4 v[120:123], v10, s[30:31]
    global_load_dwordx4 v[124:127], v11, s[30:31]
    global_load_dwordx4 v[128:131], v12, s[30:31]
    global_load_dwordx4 v[132:135], v13, s[30:31]
    global_load_dwordx4 v[136:139], v14, s[30:31]
    global_load_dwordx4 v[140:143], v15, s[30:31]
    s_add_u32 s30, s30, s32
    s_addc_u32 s31, s31, 0
    s_waitcnt vmcnt(18)
    v_mfma_f32_16x16x32_bf16 v[176:179], v[16:19], v[144:147], 0
    v_mfma_f32_16x16x32_bf16 v[180:183], v[48:51], v[144:147], 0
    v_mfma_f32_16x16x32_bf16 v[176:179], v[20:23], v[148:151], v[176:179]
    v_mfma_f32_16x16x32_bf16 v[180:183], v[52:55], v[148:151], v[180:183]
    v_mfma_f32_16x16x32_bf16 v[176:179], v[24:27], v[152:155], v[176:179]
    v_mfma_f32_16x16x32_bf16 v[180:183], v[56:59], v[152:155], v[180:183]
    v_mfma_f32_16x16x32_bf16 v[176:179], v[28:31], v[156:159], v[176:179]
    v_mfma_f32_16x16x32_bf16 v[180:183], v[60:63], v[156:159], v[180:183]
    v_mfma_f32_16x16x32_bf16 v[176:179], v[32:35], v[160:163], v[176:179]
    v_mfma_f32_16x16x32_bf16 v[180:183], v[64:67], v[160:163], v[180:183]
    v_mfma_f32_16x16x32_bf16 v[176:179], v[36:39], v[164:167], v[176:179]
    v_mfma_f32_16x16x32_bf16 v[180:183], v[68:71], v[164:167], v[180:183]
    v_mfma_f32_16x16x32_bf16 v[176:179], v[40:43], v[168:171], v[176:179]
    v_mfma_f32_16x16x32_bf16 v[180:183], v[72:75], v[168:171], v[180:183]
    v_mfma_f32_16x16x32_bf16 v[176:179], v[44:47], v[172:175], v[176:179]
    v_mfma_f32_16x16x32_bf16 v[180:183], v[76:79], v[172:175], v[180:183]
    s_nop 7
    v_cvt_pk_bf16_f32 v188, v176, v177
    v_cvt_pk_bf16_f32 v189, v178, v179
    v_cvt_pk_bf16_f32 v190, v180, v181
    v_cvt_pk_bf16_f32 v191, v182, v183
    global_store_dwordx4 v5, v[188:191], s[34:35]
    s_add_u32 s34, s34, 14336
    s_addc_u32 s35, s35, 0
    s_waitcnt vmcnt(10)
    v_mfma_f32_16x16x32_bf16 v[176:179], v[16:19], v[80:83], 0
    v_mfma_f32_16x16x32_bf16 v[180:183], v[48:51], v[80:83], 0
    v_mfma_f32_16x16x32_bf16 v[176:179], v[20:23], v[84:87], v[176:179]
    v_mfma_f32_16x16x32_bf16 v[180:183], v[52:55], v[84:87], v[180:183]
    v_mfma_f32_16x16x32_bf16 v[176:179], v[24:27], v[88:91], v[176:179]
    v_mfma_f32_16x16x32_bf16 v[180:183], v[56:59], v[88:91], v[180:183]
    v_mfma_f32_16x16x32_bf16 v[176:179], v[28:31], v[92:95], v[176:179]
    v_mfma_f32_16x16x32_bf16 v[180:183], v[60:63], v[92:95], v[180:183]
    v_mfma_f32_16x16x32_bf16 v[176:179], v[32:35], v[96:99], v[176:179]
    v_mfma_f32_16x16x32_bf16 v[180:183], v[64:67], v[96:99], v[180:183]
    v_mfma_f32_16x16x32_bf16 v[176:179], v[36:39], v[100:103], v[176:179]
    v_mfma_f32_16x16x32_bf16 v[180:183], v[68:71], v[100:103], v[180:183]
    v_mfma_f32_16x16x32_bf16 v[176:179], v[40:43], v[104:107], v[176:179]
    v_mfma_f32_16x16x32_bf16 v[180:183], v[72:75], v[104:107], v[180:183]
    v_mfma_f32_16x16x32_bf16 v[176:179], v[44:47], v[108:111], v[176:179]
    v_mfma_f32_16x16x32_bf16 v[180:183], v[76:79], v[108:111], v[180:183]
    s_nop 7
    v_cvt_pk_bf16_f32 v184, v176, v177
    v_cvt_pk_bf16_f32 v185, v178, v179
    v_cvt_pk_bf16_f32 v186, v180, v181
    v_cvt_pk_bf16_f32 v187, v182, v183
    global_store_dwordx4 v5, v[184:187], s[34:35]
    s_add_u32 s34, s34, 14336
    s_addc_u32 s35, s35, 0
    s_waitcnt vmcnt(2)
    v_mfma_f32_16x16x32_bf16 v[176:179], v[16:19], v[112:115], 0
    v_mfma_f32_16x16x32_bf16 v[180:183], v[48:51], v[112:115], 0
    v_mfma_f32_16x16x32_bf16 v[176:179], v[20:23], v[116:119], v[176:179]
    v_mfma_f32_16x16x32_bf16 v[180:183], v[52:55], v[116:119], v[180:183]
    v_mfma_f32_16x16x32_bf16 v[176:179], v[24:27], v[120:123], v[176:179]
    v_mfma_f32_16x16x32_bf16 v[180:183], v[56:59], v[120:123], v[180:183]
    v_mfma_f32_16x16x32_bf16 v[176:179], v[28:31], v[124:127], v[176:179]
    v_mfma_f32_16x16x32_bf16 v[180:183], v[60:63], v[124:127], v[180:183]
    v_mfma_f32_16x16x32_bf16 v[176:179], v[32:35], v[128:131], v[176:179]
    v_mfma_f32_16x16x32_bf16 v[180:183], v[64:67], v[128:131], v[180:183]
    v_mfma_f32_16x16x32_bf16 v[176:179], v[36:39], v[132:135], v[176:179]
    v_mfma_f32_16x16x32_bf16 v[180:183], v[68:71], v[132:135], v[180:183]
    v_mfma_f32_16x16x32_bf16 v[176:179], v[40:43], v[136:139], v[176:179]
    v_mfma_f32_16x16x32_bf16 v[180:183], v[72:75], v[136:139], v[180:183]
    v_mfma_f32_16x16x32_bf16 v[176:179], v[44:47], v[140:143], v[176:179]
    v_mfma_f32_16x16x32_bf16 v[180:183], v[76:79], v[140:143], v[180:183]
    s_nop 7
    v_cvt_pk_bf16_f32 v188, v176, v177
    v_cvt_pk_bf16_f32 v189, v178, v179
    v_cvt_pk_bf16_f32 v190, v180, v181
    v_cvt_pk_bf16_f32 v191, v182, v183
    global_store_dwordx4 v5, v[188:191], s[34:35]
    s_add_u32 s34, s34, 14336
    s_addc_u32 s35, s35, 0
.fold_kernel_end1:
    s_endpgm
.globl chain_kernel
.p2align 8
.type chain_kernel,@function
chain_kernel:
    s_cmp_ge_u32 s2, 256
    s_cbranch_scc1 .chain_kernel_end22
    s_mov_b32 s93, s2
    s_load_dwordx2 s[16:17], s[0:1], 104
    v_lshrrev_b32 v2, 6, v0
    v_and_b32 v1, 63, v0
    s_nop 0
    v_readfirstlane_b32 s18, v2
    v_lshrrev_b32 v2, 4, v1
    v_and_b32 v3, 15, v1
    s_getreg_b32 s19, hwreg(HW_REG_XCC_ID)
    s_and_b32 s19, s19, 15
    v_lshlrev_b32 v4, 4, v1
    v_and_b32 v5, 7, v3
    v_lshl_add_u32 v5, v2, 3, v5
    v_lshlrev_b32 v5, 4, v5
    v_lshrrev_b32 v6, 3, v3
    v_lshlrev_b32 v6, 10, v6
    v_lshrrev_b32 v2, 1, v5
    v_add_u32 v2, v2, v6
    v_add_u32 v6, v6, v5
    s_mov_b32 s40, 0x00ff00ff
    s_mov_b32 s41, 0x00ff00ff
    s_mov_b32 s42, -1
    s_mov_b32 s43, 0
    s_mov_b32 s89, 0
    s_waitcnt lgkmcnt(0)
    s_add_u32 s46, s16, 0x0
    s_addc_u32 s47, s17, 0
    s_cmp_lg_u32 s18, 0
    s_cbranch_scc1 .chain_kernel_nw03
    s_mov_b64 exec, 1
    v_mov_b32 v10, s19
    v_lshlrev_b32 v10, 2, v10
    v_mov_b32 v11, 1
    global_atomic_add v12, v10, v11, s[46:47] sc0 sc1
    v_mov_b32 v13, 143360
    s_waitcnt vmcnt(0)
    ds_write_b32 v13, v12
    s_waitcnt lgkmcnt(0)
    s_mov_b64 exec, -1
.chain_kernel_nw03:
    s_barrier
    v_mov_b32 v13, 143360
    ds_read_b32 v12, v13
    s_waitcnt lgkmcnt(0)
    v_readfirstlane_b32 s20, v12
    s_nop 3
    s_cmp_ge_u32 s20, 32
    s_cbranch_scc1 .chain_kernel_end1
    s_add_u32 s44, s19, 1
    s_cmp_lg_u32 s20, 31
    s_cbranch_scc1 .chain_kernel_ncas4
    s_cmp_lg_u32 s18, 0
    s_cbranch_scc1 .chain_kernel_ncas4
    s_mov_b64 exec, 1
    v_mov_b32 v10, s44
    v_mov_b32 v11, 0
    v_mov_b32 v12, 64
    global_atomic_cmpswap v12, v[10:11], s[46:47] sc1
    s_waitcnt vmcnt(0)
    s_mov_b64 exec, -1
.chain_kernel_ncas4:
    v_mov_b32 v12, 64
    s_mov_b32 s45, 0
.chain_kernel_pw5:
    global_load_dword v10, v12, s[46:47] sc1
    s_waitcnt vmcnt(0)
    v_readfirstlane_b32 s38, v10
    s_nop 3
    s_cmp_lg_u32 s38, 0
    s_cbranch_scc1 .chain_kernel_pwd6
    s_add_u32 s45, s45, 1
    s_cmp_lt_u32 s45, 1048576
    s_cbranch_scc1 .chain_kernel_pw5
    s_branch .chain_kernel_end1
.chain_kernel_pwd6:
    s_cmp_lg_u32 s38, s44
    s_cbranch_scc1 .chain_kernel_work7
    s_lshr_b32 s21, s20, 1
    s_and_b32 s22, s20, 1
    s_mul_i32 s38, s21, 28
    s_mul_i32 s39, s22, 14
    s_add_u32 s38, s38, s39
    s_lshl_b32 s39, s18, 2
    s_add_u32 s38, s38, s39
    s_mul_i32 s38, s38, 14336
    s_add_u32 s38, s38, 0x1459000
    s_add_u32 s24, s16, s38
    s_addc_u32 s25, s17, 0
    global_load_dwordx4 a[0:3], v4, s[24:25] offset:0
    global_load_dwordx4 a[4:7], v4, s[24:25] offset:1024
    global_load_dwordx4 a[8:11], v4, s[24:25] offset:2048
    global_load_dwordx4 a[12:15], v4, s[24:25] offset:3072
    s_add_u32 s24, s24, 4096
    s_addc_u32 s25, s25, 0
    global_load_dwordx4 a[16:19], v4, s[24:25] offset:0
    global_load_dwordx4 a[20:23], v4, s[24:25] offset:1024
    global_load_dwordx4 a[24:27], v4, s[24:25] offset:2048
    global_load_dwordx4 a[28:31], v4, s[24:25] offset:3072
    s_add_u32 s24, s24, 4096
    s_addc_u32 s25, s25, 0
    global_load_dwordx4 a[32:35], v4, s[24:25] offset:0
    global_load_dwordx4 a[36:39], v4, s[24:25] offset:1024
    global_load_dwordx4 a[40:43], v4, s[24:25] offset:2048
    global_load_dwordx4 a[44:47], v4, s[24:25] offset:3072
    s_add_u32 s24, s24, 4096
    s_addc_u32 s25, s25, 0
    global_load_dwordx4 a[48:51], v4, s[24:25] offset:0
    global_load_dwordx4 a[52:55], v4, s[24:25] offset:1024
    global_load_dwordx4 a[56:59], v4, s[24:25] offset:2048
    global_load_dwordx4 a[60:63], v4, s[24:25] offset:3072
    s_add_u32 s24, s24, 4096
    s_addc_u32 s25, s25, 0
    global_load_dwordx4 a[64:67], v4, s[24:25] offset:0
    global_load_dwordx4 a[68:71], v4, s[24:25] offset:1024
    global_load_dwordx4 a[72:75], v4, s[24:25] offset:2048
    global_load_dwordx4 a[76:79], v4, s[24:25] offset:3072
    s_add_u32 s24, s24, 4096
    s_addc_u32 s25, s25, 0
    global_load_dwordx4 a[80:83], v4, s[24:25] offset:0
    global_load_dwordx4 a[84:87], v4, s[24:25] offset:1024
    global_load_dwordx4 a[88:91], v4, s[24:25] offset:2048
    global_load_dwordx4 a[92:95], v4, s[24:25] offset:3072
    s_add_u32 s24, s24, 4096
    s_addc_u32 s25, s25, 0
    global_load_dwordx4 a[96:99], v4, s[24:25] offset:0
    global_load_dwordx4 a[100:103], v4, s[24:25] offset:1024
    global_load_dwordx4 a[104:107], v4, s[24:25] offset:2048
    global_load_dwordx4 a[108:111], v4, s[24:25] offset:3072
    s_cmp_eq_u32 s18, 3
    s_cbranch_scc1 .chain_kernel_af28
    s_add_u32 s24, s24, 4096
    s_addc_u32 s25, s25, 0
    global_load_dwordx4 a[112:115], v4, s[24:25] offset:0
    global_load_dwordx4 a[116:119], v4, s[24:25] offset:1024
    global_load_dwordx4 a[120:123], v4, s[24:25] offset:2048
    global_load_dwordx4 a[124:127], v4, s[24:25] offset:3072
    s_add_u32 s24, s24, 4096
    s_addc_u32 s25, s25, 0
    global_load_dwordx4 a[128:131], v4, s[24:25] offset:0
    global_load_dwordx4 a[132:135], v4, s[24:25] offset:1024
    global_load_dwordx4 a[136:139], v4, s[24:25] offset:2048
    global_load_dwordx4 a[140:143], v4, s[24:25] offset:3072
    s_add_u32 s24, s24, 4096
    s_addc_u32 s25, s25, 0
    global_load_dwordx4 a[144:147], v4, s[24:25] offset:0
    global_load_dwordx4 a[148:151], v4, s[24:25] offset:1024
    global_load_dwordx4 a[152:155], v4, s[24:25] offset:2048
    global_load_dwordx4 a[156:159], v4, s[24:25] offset:3072
    s_add_u32 s24, s24, 4096
    s_addc_u32 s25, s25, 0
    global_load_dwordx4 a[160:163], v4, s[24:25] offset:0
    global_load_dwordx4 a[164:167], v4, s[24:25] offset:1024
    global_load_dwordx4 a[168:171], v4, s[24:25] offset:2048
    global_load_dwordx4 a[172:175], v4, s[24:25] offset:3072
    s_add_u32 s24, s24, 4096
    s_addc_u32 s25, s25, 0
    global_load_dwordx4 a[176:179], v4, s[24:25] offset:0
    global_load_dwordx4 a[180:183], v4, s[24:25] offset:1024
    global_load_dwordx4 a[184:187], v4, s[24:25] offset:2048
    global_load_dwordx4 a[188:191], v4, s[24:25] offset:3072
    s_add_u32 s24, s24, 4096
    s_addc_u32 s25, s25, 0
    global_load_dwordx4 a[192:195], v4, s[24:25] offset:0
    global_load_dwordx4 a[196:199], v4, s[24:25] offset:1024
    global_load_dwordx4 a[200:203], v4, s[24:25] offset:2048
    global_load_dwordx4 a[204:207], v4, s[24:25] offset:3072
    s_add_u32 s24, s24, 4096
    s_addc_u32 s25, s25, 0
    global_load_dwordx4 a[208:211], v4, s[24:25] offset:0
    global_load_dwordx4 a[212:215], v4, s[24:25] offset:1024
    global_load_dwordx4 a[216:219], v4, s[24:25] offset:2048
    global_load_dwordx4 a[220:223], v4, s[24:25] offset:3072
.chain_kernel_af28:
    s_mul_i32 s39, s18, 28672
    v_add_u32 v19, s39, v4
    s_cmp_ge_u32 s20, 28
    s_cbranch_scc1 .chain_kernel_nob9
    s_lshl_b32 s38, s18, 2
    s_mul_i32 s38, s38, 28
    s_add_u32 s38, s38, s20
    s_mul_i32 s38, s38, 14336
    s_add_u32 s38, s38, 0x2099000
    s_add_u32 s24, s16, s38
    s_addc_u32 s25, s17, 0
    global_load_dwordx4 a[224:227], v4, s[24:25] offset:0
    global_load_dwordx4 a[228:231], v4, s[24:25] offset:1024
    global_load_dwordx4 a[232:235], v4, s[24:25] offset:2048
    global_load_dwordx4 a[236:239], v4, s[24:25] offset:3072
    s_add_u32 s24, s24, 4096
    s_addc_u32 s25, s25, 0
    global_load_dwordx4 a[240:243], v4, s[24:25] offset:0
    global_load_dwordx4 a[244:247], v4, s[24:25] offset:1024
    global_load_dwordx4 a[248:251], v4, s[24:25] offset:2048
    global_load_dwordx4 a[252:255], v4, s[24:25] offset:3072
    s_add_u32 s24, s24, 4096
    s_addc_u32 s25, s25, 0
    global_load_dwordx4 v[176:179], v4, s[24:25] offset:0
    global_load_dwordx4 v[180:183], v4, s[24:25] offset:1024
    global_load_dwordx4 v[184:187], v4, s[24:25] offset:2048
    global_load_dwordx4 v[188:191], v4, s[24:25] offset:3072
    s_add_u32 s24, s24, 4096
    s_addc_u32 s25, s25, 0
    global_load_dwordx4 v[192:195], v4, s[24:25] offset:0
    global_load_dwordx4 v[196:199], v4, s[24:25] offset:1024
    s_add_u32 s38, s38, 401408
    s_add_u32 s24, s16, s38
    s_addc_u32 s25, s17, 0
    global_load_dwordx4 v[200:203], v4, s[24:25] offset:0
    global_load_dwordx4 v[204:207], v4, s[24:25] offset:1024
    global_load_dwordx4 v[208:211], v4, s[24:25] offset:2048
    global_load_dwordx4 v[212:215], v4, s[24:25] offset:3072
    s_add_u32 s24, s24, 4096
    s_addc_u32 s25, s25, 0
    global_load_dwordx4 v[216:219], v4, s[24:25] offset:0
    global_load_dwordx4 v[220:223], v4, s[24:25] offset:1024
    global_load_dwordx4 v[224:227], v4, s[24:25] offset:2048
    global_load_dwordx4 v[228:231], v4, s[24:25] offset:3072
    s_add_u32 s24, s24, 4096
    s_addc_u32 s25, s25, 0
    global_load_dwordx4 v[232:235], v4, s[24:25] offset:0
    global_load_dwordx4 v[236:239], v4, s[24:25] offset:1024
    global_load_dwordx4 v[240:243], v4, s[24:25] offset:2048
    global_load_dwordx4 v[244:247], v4, s[24:25] offset:3072
    s_add_u32 s24, s24, 4096
    s_addc_u32 s25, s25, 0
    global_load_dwordx4 v[248:251], v4, s[24:25] offset:0
    global_load_dwordx4 v[252:255], v4, s[24:25] offset:1024
    s_add_u32 s38, s38, 401408
    s_add_u32 s24, s16, s38
    s_addc_u32 s25, s17, 0
    global_load_dwordx4 v[20:23], v4, s[24:25] offset:0
    global_load_dwordx4 v[24:27], v4, s[24:25] offset:1024
    global_load_dwordx4 v[28:31], v4, s[24:25] offset:2048
    global_load_dwordx4 v[32:35], v4, s[24:25] offset:3072
    s_add_u32 s24, s24, 4096
    s_addc_u32 s25, s25, 0
    global_load_dwordx4 v[36:39], v4, s[24:25] offset:0
    global_load_dwordx4 v[40:43], v4, s[24:25] offset:1024
    global_load_dwordx4 v[44:47], v4, s[24:25] offset:2048
    global_load_dwordx4 v[48:51], v4, s[24:25] offset:3072
    s_add_u32 s24, s24, 4096
    s_addc_u32 s25, s25, 0
    global_load_dwordx4 v[52:55], v4, s[24:25] offset:0
    global_load_dwordx4 v[56:59], v4, s[24:25] offset:1024
    global_load_dwordx4 v[60:63], v4, s[24:25] offset:2048
    global_load_dwordx4 v[64:67], v4, s[24:25] offset:3072
    s_add_u32 s24, s24, 4096
    s_addc_u32 s25, s25, 0
    global_load_dwordx4 v[68:71], v4, s[24:25] offset:0
    global_load_dwordx4 v[72:75], v4, s[24:25] offset:1024
    s_waitcnt vmcnt(0)
    ds_write_b128 v19, v[20:23] offset:0
    ds_write_b128 v19, v[24:27] offset:1024
    ds_write_b128 v19, v[28:31] offset:2048
    ds_write_b128 v19, v[32:35] offset:3072
    ds_write_b128 v19, v[36:39] offset:4096
    ds_write_b128 v19, v[40:43] offset:5120
    ds_write_b128 v19, v[44:47] offset:6144
    ds_write_b128 v19, v[48:51] offset:7168
    ds_write_b128 v19, v[52:55] offset:8192
    ds_write_b128 v19, v[56:59] offset:9216
    ds_write_b128 v19, v[60:63] offset:10240
    ds_write_b128 v19, v[64:67] offset:11264
    ds_write_b128 v19, v[68:71] offset:12288
    ds_write_b128 v19, v[72:75] offset:13312
    s_waitcnt lgkmcnt(0)
    s_add_u32 s38, s38, 401408
    s_add_u32 s24, s16, s38
    s_addc_u32 s25, s17, 0
    global_load_dwordx4 v[20:23], v4, s[24:25] offset:0
    global_load_dwordx4 v[24:27], v4, s[24:25] offset:1024
    global_load_dwordx4 v[28:31], v4, s[24:25] offset:2048
    global_load_dwordx4 v[32:35], v4, s[24:25] offset:3072
    s_add_u32 s24, s24, 4096
    s_addc_u32 s25, s25, 0
    global_load_dwordx4 v[36:39], v4, s[24:25] offset:0
    global_load_dwordx4 v[40:43], v4, s[24:25] offset:1024
    global_load_dwordx4 v[44:47], v4, s[24:25] offset:2048
    global_load_dwordx4 v[48:51], v4, s[24:25] offset:3072
    s_add_u32 s24, s24, 4096
    s_addc_u32 s25, s25, 0
    global_load_dwordx4 v[52:55], v4, s[24:25] offset:0
    global_load_dwordx4 v[56:59], v4, s[24:25] offset:1024
    global_load_dwordx4 v[60:63], v4, s[24:25] offset:2048
    global_load_dwordx4 v[64:67], v4, s[24:25] offset:3072
    s_add_u32 s24, s24, 4096
    s_addc_u32 s25, s25, 0
    global_load_dwordx4 v[68:71], v4, s[24:25] offset:0
    global_load_dwordx4 v[72:75], v4, s[24:25] offset:1024
    s_waitcnt vmcnt(0)
    ds_write_b128 v19, v[20:23] offset:14336
    ds_write_b128 v19, v[24:27] offset:15360
    ds_write_b128 v19, v[28:31] offset:16384
    ds_write_b128 v19, v[32:35] offset:17408
    ds_write_b128 v19, v[36:39] offset:18432
    ds_write_b128 v19, v[40:43] offset:19456
    ds_write_b128 v19, v[44:47] offset:20480
    ds_write_b128 v19, v[48:51] offset:21504
    ds_write_b128 v19, v[52:55] offset:22528
    ds_write_b128 v19, v[56:59] offset:23552
    ds_write_b128 v19, v[60:63] offset:24576
    ds_write_b128 v19, v[64:67] offset:25600
    ds_write_b128 v19, v[68:71] offset:26624
    ds_write_b128 v19, v[72:75] offset:27648
    s_waitcnt lgkmcnt(0)
    s_add_u32 s38, s38, 401408
.chain_kernel_nob9:
    v_mov_b32 v20, 0
    v_mov_b32 v21, 0
    v_mov_b32 v22, 0
    v_mov_b32 v23, 0
    v_mov_b32 v24, 0
    v_mov_b32 v25, 0
    v_mov_b32 v26, 0
    v_mov_b32 v27, 0
    v_mov_b32 v28, 0
    v_mov_b32 v29, 0
    v_mov_b32 v30, 0
    v_mov_b32 v31, 0
    v_mov_b32 v32, 0
    v_mov_b32 v33, 0
    v_mov_b32 v34, 0
    v_mov_b32 v35, 0
    v_mov_b32 v36, 0
    v_mov_b32 v37, 0
    v_mov_b32 v38, 0
    v_mov_b32 v39, 0
    v_mov_b32 v40, 0
    v_mov_b32 v41, 0
    v_mov_b32 v42, 0
    v_mov_b32 v43, 0
    v_mov_b32 v44, 0
    v_mov_b32 v45, 0
    v_mov_b32 v46, 0
    v_mov_b32 v47, 0
    v_mov_b32 v48, 0
    v_mov_b32 v49, 0
    v_mov_b32 v50, 0
    v_mov_b32 v51, 0
    v_mov_b32 v52, 0
    v_mov_b32 v53, 0
    v_mov_b32 v54, 0
    v_mov_b32 v55, 0
    v_mov_b32 v56, 0
    v_mov_b32 v57, 0
    v_mov_b32 v58, 0
    v_mov_b32 v59, 0
    v_mov_b32 v60, 0
    v_mov_b32 v61, 0
    v_mov_b32 v62, 0
    v_mov_b32 v63, 0
    v_mov_b32 v64, 0
    v_mov_b32 v65, 0
    v_mov_b32 v66, 0
    v_mov_b32 v67, 0
    v_mov_b32 v68, 0
    v_mov_b32 v69, 0
    v_mov_b32 v70, 0
    v_mov_b32 v71, 0
    v_mov_b32 v72, 0
    v_mov_b32 v73, 0
    v_mov_b32 v74, 0
    v_mov_b32 v75, 0
    v_mov_b32 v160, 0
    v_mov_b32 v161, 0
    v_mov_b32 v162, 0
    v_mov_b32 v163, 0
    v_mov_b32 v164, 0
    v_mov_b32 v165, 0
    v_mov_b32 v166, 0
    v_mov_b32 v167, 0
    s_add_u32 s24, s16, 0x42b9000
    s_addc_u32 s25, s17, 0
    s_mul_i32 s38, s21, 3072
    s_lshl_b32 s39, s22, 9
    s_add_u32 s38, s38, s39
    s_add_u32 s38, s38, 0x432ac00
    s_add_u32 s26, s16, s38
    s_addc_u32 s27, s17, 0
    s_lshl_b32 s38, s18, 12
    s_add_u32 s38, s38, 0x462ac00
    s_add_u32 s28, s16, s38
    s_addc_u32 s29, s17, 0
    s_sub_u32 s38, s20, 28
    s_lshl_b32 s38, s38, 2
    s_add_u32 s38, s38, s18
    s_and_b32 s38, s38, 15
    s_mul_i32 s39, s38, 3072
    s_add_u32 s39, s39, 0x432ac00
    s_lshl_b32 s38, s38, 10
    s_add_u32 s38, s38, 0x462ac00
    s_add_u32 s72, s16, s38
    s_addc_u32 s73, s17, 0
    s_add_u32 s74, s16, s39
    s_addc_u32 s75, s17, 0
    s_mul_i32 s38, s22, 7
    s_lshl_b32 s39, s18, 1
    s_add_u32 s38, s38, s39
    s_lshl_b32 s39, s38, 9
    s_add_u32 s39, s39, 135168
    v_add_u32 v18, s39, v5
    s_lshl_b32 s38, s38, 10
    s_add_u32 s38, s38, 0x1000
    s_add_u32 s30, s16, s38
    s_addc_u32 s31, s17, 0
    s_lshl_b32 s38, s18, 2
    s_mul_i32 s38, s38, 28
    s_add_u32 s38, s38, s20
    s_lshl_b32 s38, s38, 10
    s_add_u32 s38, s38, 0x26b9000
    s_add_u32 s32, s16, s38
    s_addc_u32 s33, s17, 0
    s_mul_i32 s38, s18, 28
    s_add_u32 s38, s38, s20
    s_lshl_b32 s38, s38, 10
    s_add_u32 s38, s38, 0x479d000
    s_add_u32 s34, s16, s38
    s_addc_u32 s35, s17, 0
    s_lshr_b32 s38, s20, 1
    s_lshl_b32 s38, s38, 9
    s_and_b32 s39, s20, 1
    s_lshl_b32 s39, s39, 3
    s_add_u32 s38, s38, s39
    s_add_u32 s38, s38, 0x42bac00
    s_add_u32 s36, s16, s38
    s_addc_u32 s37, s17, 0
    s_add_u32 s82, s16, 0x472b000
    s_addc_u32 s83, s17, 0
    v_add_u32 v7, 14336, v4
    s_mul_i32 s38, s18, 3072
    s_add_u32 s38, s38, 114688
    v_add_u32 v8, s38, v4
    s_lshl_b32 s38, s18, 10
    v_add_u32 v9, s38, v5
    s_add_u32 s38, s38, 114688
    v_add_u32 v0, s38, v4
    s_lshl_b32 s38, s18, 11
    s_add_u32 s38, s38, 126976
    v_add_u32 v11, s38, v4
    v_add_u32 v12, 126976, v4
    s_lshl_b32 s38, s18, 11
    s_add_u32 s39, s38, 1024
    s_cmp_eq_u32 s18, 3
    s_cselect_b32 s39, s38, s39
    v_add_u32 v13, s38, v4
    v_add_u32 v14, s39, v4
    v_add_u32 v15, 135168, v13
    v_add_u32 v16, 135168, v14
    v_add_u32 v17, 135168, v5
    v_mov_b32 v3, 0xff800000
    v_lshlrev_b32 v174, 3, v4
    s_lshl_b32 s38, s18, 11
    s_add_u32 s38, s38, 7168
    v_add_u32 v175, s38, v174
    s_mov_b32 s23, 0
    s_mov_b32 s48, 0x3db8aa3b
    s_mov_b32 s49, 0x3db8aa3b
    s_waitcnt vmcnt(0)
    global_load_dwordx4 v[100:103], v4, s[30:31]
    global_load_dwordx4 v[108:111], v7, s[30:31]
    s_cmp_eq_u32 s18, 3
    s_cbranch_scc1 .chain_kernel_x210
    global_load_dwordx4 v[104:107], v4, s[30:31] offset:1024
    global_load_dwordx4 v[112:115], v7, s[30:31] offset:1024
.chain_kernel_x210:
    s_add_u32 s30, s30, 28672
    s_addc_u32 s31, s31, 0
    s_mov_b32 s76, 0
    s_lshl_b32 s38, s76, 2
    s_add_u32 s38, s38, 256
    v_mov_b32 v172, s38
    s_mov_b32 s45, 0
.chain_kernel_fl11:
    global_load_dword v173, v172, s[46:47] sc1
    s_waitcnt vmcnt(0)
    v_readfirstlane_b32 s38, v173
    s_nop 3
    s_cmp_ge_u32 s38, 64
    s_cbranch_scc1 .chain_kernel_fld12
    s_add_u32 s45, s45, 1
    s_cmp_lt_u32 s45, 1048576
    s_cbranch_scc1 .chain_kernel_fl11
    s_branch .chain_kernel_end1
.chain_kernel_fld12:
.chain_kernel_loop13:
    s_mov_b32 s45, 0
.chain_kernel_pl14:
    global_load_dwordx4 v[136:139], v13, s[24:25] sc1
    global_load_dwordx4 v[140:143], v14, s[24:25] sc1
    s_waitcnt vmcnt(0)
    v_max3_u32 v10, v136, v137, v138
    v_max3_u32 v10, v10, v139, v140
    v_max3_u32 v10, v10, v141, v142
    v_max_u32 v10, v10, v143
    v_cmp_eq_u32 vcc, -1, v10
    s_add_u32 s45, s45, 1
    s_cbranch_vccz .chain_kernel_pld15
    s_cmp_lt_u32 s45, 1048576
    s_cbranch_scc1 .chain_kernel_pl14
    s_branch .chain_kernel_end1
.chain_kernel_pld15:
    ds_write_b128 v15, v[136:139]
    ds_write_b128 v16, v[140:143]
    s_waitcnt vmcnt(0) lgkmcnt(0)
    s_barrier
    s_cmp_ge_u32 s20, 28
    s_cbranch_scc1 .chain_kernel_nuf16
    s_cmp_eq_u32 s23, 0
    s_cbranch_scc1 .chain_kernel_nuf217
    s_mov_b64 exec, s[42:43]
    global_store_dwordx2 v4, v[76:77], s[34:35] sc1
    global_store_dwordx2 v4, v[80:81], s[34:35] offset:8 sc1
    global_store_dwordx2 v4, v[78:79], s[34:35] offset:512 sc1
    global_store_dwordx2 v4, v[82:83], s[34:35] offset:520 sc1
    s_mov_b64 exec, -1
    s_add_u32 s34, s34, 114688
    s_addc_u32 s35, s35, 0
    s_branch .chain_kernel_nuf217
.chain_kernel_nuf16:
    s_cmp_lg_u32 s20, 28
    s_cbranch_scc1 .chain_kernel_nuf217
    global_store_dwordx4 v13, v[136:139], s[82:83] sc1
    global_store_dwordx4 v14, v[140:143], s[82:83] sc1
.chain_kernel_nuf217:
    s_cmp_lg_u32 s18, 1
    s_cbranch_scc1 .chain_kernel_nsg18
    s_cmp_ge_u32 s20, 29
    s_cbranch_scc1 .chain_kernel_nsg18
    s_and_b32 s38, s23, 7
    s_cmp_lg_u32 s38, 1
    s_cbranch_scc1 .chain_kernel_nsg18
    s_cmp_eq_u32 s23, 1
    s_cbranch_scc1 .chain_kernel_nsg18
    s_lshr_b32 s38, s23, 3
    s_sub_u32 s38, s38, 1
    s_lshl_b32 s38, s38, 2
    s_add_u32 s38, s38, 448
    s_mov_b64 exec, 1
    v_mov_b32 v10, s38
    v_mov_b32 v1, 1
    global_atomic_add v10, v1, s[46:47] sc1
    s_mov_b64 exec, -1
.chain_kernel_nsg18:
    s_mov_b64 exec, s[40:41]
    ds_read_b128 v[20:23], v17 offset:0
    ds_read_b128 v[24:27], v17 offset:512
    ds_read_b128 v[28:31], v17 offset:1024
    ds_read_b128 v[32:35], v17 offset:1536
    ds_read_b128 v[36:39], v17 offset:2048
    ds_read_b128 v[40:43], v17 offset:2560
    ds_read_b128 v[44:47], v17 offset:3072
    ds_read_b128 v[48:51], v17 offset:3584
    ds_read_b128 v[52:55], v17 offset:4096
    ds_read_b128 v[56:59], v17 offset:4608
    ds_read_b128 v[60:63], v17 offset:5120
    ds_read_b128 v[64:67], v17 offset:5632
    ds_read_b128 v[68:71], v17 offset:6144
    ds_read_b128 v[72:75], v17 offset:6656
    ds_read_b128 v[160:163], v18
    ds_read_b128 v[164:167], v18 offset:512
    s_mov_b64 exec, -1
    s_cmp_eq_u32 s18, 3
    s_cbranch_scc1 .chain_kernel_t219
    s_waitcnt lgkmcnt(15)
    v_mfma_f32_16x16x32_bf16 v[76:79], a[0:3], v[20:23], 0
    v_mfma_f32_16x16x32_bf16 v[80:83], a[56:59], v[20:23], 0
    v_mfma_f32_16x16x32_bf16 v[84:87], a[112:115], v[20:23], 0
    v_mfma_f32_16x16x32_bf16 v[88:91], a[168:171], v[20:23], 0
    s_waitcnt lgkmcnt(14)
    v_mfma_f32_16x16x32_bf16 v[76:79], a[4:7], v[24:27], v[76:79]
    v_mfma_f32_16x16x32_bf16 v[80:83], a[60:63], v[24:27], v[80:83]
    v_mfma_f32_16x16x32_bf16 v[84:87], a[116:119], v[24:27], v[84:87]
    v_mfma_f32_16x16x32_bf16 v[88:91], a[172:175], v[24:27], v[88:91]
    s_waitcnt lgkmcnt(13)
    v_mfma_f32_16x16x32_bf16 v[76:79], a[8:11], v[28:31], v[76:79]
    v_mfma_f32_16x16x32_bf16 v[80:83], a[64:67], v[28:31], v[80:83]
    v_mfma_f32_16x16x32_bf16 v[84:87], a[120:123], v[28:31], v[84:87]
    v_mfma_f32_16x16x32_bf16 v[88:91], a[176:179], v[28:31], v[88:91]
    s_waitcnt lgkmcnt(12)
    v_mfma_f32_16x16x32_bf16 v[76:79], a[12:15], v[32:35], v[76:79]
    v_mfma_f32_16x16x32_bf16 v[80:83], a[68:71], v[32:35], v[80:83]
    v_mfma_f32_16x16x32_bf16 v[84:87], a[124:127], v[32:35], v[84:87]
    v_mfma_f32_16x16x32_bf16 v[88:91], a[180:183], v[32:35], v[88:91]
    s_cmp_lt_u32 s20, 28
    s_cbranch_scc1 .chain_kernel_nsx21
    global_load_dwordx4 v[176:179], v4, s[30:31]
    global_load_dwordx4 v[184:187], v7, s[30:31]
    s_cmp_eq_u32 s18, 3
    s_cbranch_scc1 .chain_kernel_x222
    global_load_dwordx4 v[180:183], v4, s[30:31] offset:1024
    global_load_dwordx4 v[188:191], v7, s[30:31] offset:1024
.chain_kernel_x222:
    s_add_u32 s30, s30, 28672
    s_addc_u32 s31, s31, 0
.chain_kernel_nsx21:
    s_and_b32 s38, s23, 3
    s_cmp_lg_u32 s38, 0
    s_cbranch_scc1 .chain_kernel_f123
    s_cmp_eq_u32 s23, 0
    s_cbranch_scc1 .chain_kernel_f123
    v_readfirstlane_b32 s38, v173
    s_nop 3
    s_cmp_ge_u32 s38, 16
    s_cbranch_scc1 .chain_kernel_f123
    s_lshr_b32 s76, s23, 2
    s_lshl_b32 s38, s76, 2
    s_add_u32 s38, s38, 256
    v_mov_b32 v172, s38
    s_mov_b32 s45, 0
.chain_kernel_fl25:
    global_load_dword v173, v172, s[46:47] sc1
    s_waitcnt vmcnt(0)
    v_readfirstlane_b32 s38, v173
    s_nop 3
    s_cmp_ge_u32 s38, 16
    s_cbranch_scc1 .chain_kernel_fld26
    s_add_u32 s45, s45, 1
    s_cmp_lt_u32 s45, 1048576
    s_cbranch_scc1 .chain_kernel_fl25
    s_branch .chain_kernel_end1
.chain_kernel_fld26:
.chain_kernel_f123:
    s_and_b32 s38, s23, 3
    s_cmp_lg_u32 s38, 2
    s_cbranch_scc1 .chain_kernel_f224
    s_lshr_b32 s38, s23, 2
    s_lshl_b32 s38, s38, 2
    s_add_u32 s38, s38, 260
    v_mov_b32 v172, s38
    global_load_dword v173, v172, s[46:47] sc1
.chain_kernel_f224:
    s_cmp_ge_u32 s20, 28
    s_cbranch_scc1 .chain_kernel_nd27
    s_add_u32 s54, s32, 0x7000
    s_addc_u32 s55, s33, 0
    s_add_u32 s56, s32, 0xe000
    s_addc_u32 s57, s33, 0
    s_add_u32 s58, s32, 0x15000
    s_addc_u32 s59, s33, 0
    global_load_dwordx4 v[144:147], v4, s[32:33]
    global_load_dwordx4 v[148:151], v4, s[54:55]
    global_load_dwordx4 v[152:155], v4, s[56:57]
    global_load_dwordx4 v[156:159], v4, s[58:59]
.chain_kernel_nd27:
    s_add_u32 s32, s32, 458752
    s_addc_u32 s33, s33, 0
    s_cmp_ge_u32 s20, 28
    s_cselect_b32 s38, s74, s28
    s_cselect_b32 s39, s75, s29
    s_mov_b64 exec, s[42:43]
    global_load_dword v10, v174, s[38:39]
    global_load_dword v1, v175, s[24:25]
    s_mov_b64 exec, -1
    s_waitcnt lgkmcnt(11)
    v_mfma_f32_16x16x32_bf16 v[76:79], a[16:19], v[36:39], v[76:79]
    v_mfma_f32_16x16x32_bf16 v[80:83], a[72:75], v[36:39], v[80:83]
    v_mfma_f32_16x16x32_bf16 v[84:87], a[128:131], v[36:39], v[84:87]
    v_mfma_f32_16x16x32_bf16 v[88:91], a[184:187], v[36:39], v[88:91]
    s_waitcnt lgkmcnt(10)
    v_mfma_f32_16x16x32_bf16 v[76:79], a[20:23], v[40:43], v[76:79]
    v_mfma_f32_16x16x32_bf16 v[80:83], a[76:79], v[40:43], v[80:83]
    v_mfma_f32_16x16x32_bf16 v[84:87], a[132:135], v[40:43], v[84:87]
    v_mfma_f32_16x16x32_bf16 v[88:91], a[188:191], v[40:43], v[88:91]
    s_waitcnt lgkmcnt(9)
    v_mfma_f32_16x16x32_bf16 v[76:79], a[24:27], v[44:47], v[76:79]
    v_mfma_f32_16x16x32_bf16 v[80:83], a[80:83], v[44:47], v[80:83]
    v_mfma_f32_16x16x32_bf16 v[84:87], a[136:139], v[44:47], v[84:87]
    v_mfma_f32_16x16x32_bf16 v[88:91], a[192:195], v[44:47], v[88:91]
    s_waitcnt lgkmcnt(8)
    v_mfma_f32_16x16x32_bf16 v[76:79], a[28:31], v[48:51], v[76:79]
    v_mfma_f32_16x16x32_bf16 v[80:83], a[84:87], v[48:51], v[80:83]
    v_mfma_f32_16x16x32_bf16 v[84:87], a[140:143], v[48:51], v[84:87]
    v_mfma_f32_16x16x32_bf16 v[88:91], a[196:199], v[48:51], v[88:91]
    s_waitcnt lgkmcnt(7)
    v_mfma_f32_16x16x32_bf16 v[76:79], a[32:35], v[52:55], v[76:79]
    v_mfma_f32_16x16x32_bf16 v[80:83], a[88:91], v[52:55], v[80:83]
    v_mfma_f32_16x16x32_bf16 v[84:87], a[144:147], v[52:55], v[84:87]
    v_mfma_f32_16x16x32_bf16 v[88:91], a[200:203], v[52:55], v[88:91]
    s_waitcnt lgkmcnt(6)
    v_mfma_f32_16x16x32_bf16 v[76:79], a[36:39], v[56:59], v[76:79]
    v_mfma_f32_16x16x32_bf16 v[80:83], a[92:95], v[56:59], v[80:83]
    v_mfma_f32_16x16x32_bf16 v[84:87], a[148:151], v[56:59], v[84:87]
    v_mfma_f32_16x16x32_bf16 v[88:91], a[204:207], v[56:59], v[88:91]
    s_waitcnt lgkmcnt(5)
    v_mfma_f32_16x16x32_bf16 v[76:79], a[40:43], v[60:63], v[76:79]
    v_mfma_f32_16x16x32_bf16 v[80:83], a[96:99], v[60:63], v[80:83]
    v_mfma_f32_16x16x32_bf16 v[84:87], a[152:155], v[60:63], v[84:87]
    v_mfma_f32_16x16x32_bf16 v[88:91], a[208:211], v[60:63], v[88:91]
    s_waitcnt lgkmcnt(4)
    v_mfma_f32_16x16x32_bf16 v[76:79], a[44:47], v[64:67], v[76:79]
    v_mfma_f32_16x16x32_bf16 v[80:83], a[100:103], v[64:67], v[80:83]
    v_mfma_f32_16x16x32_bf16 v[84:87], a[156:159], v[64:67], v[84:87]
    v_mfma_f32_16x16x32_bf16 v[88:91], a[212:215], v[64:67], v[88:91]
    s_waitcnt lgkmcnt(3)
    v_mfma_f32_16x16x32_bf16 v[76:79], a[48:51], v[68:71], v[76:79]
    v_mfma_f32_16x16x32_bf16 v[80:83], a[104:107], v[68:71], v[80:83]
    v_mfma_f32_16x16x32_bf16 v[84:87], a[160:163], v[68:71], v[84:87]
    v_mfma_f32_16x16x32_bf16 v[88:91], a[216:219], v[68:71], v[88:91]
    s_waitcnt lgkmcnt(2)
    v_mfma_f32_16x16x32_bf16 v[76:79], a[52:55], v[72:75], v[76:79]
    v_mfma_f32_16x16x32_bf16 v[80:83], a[108:111], v[72:75], v[80:83]
    v_mfma_f32_16x16x32_bf16 v[84:87], a[164:167], v[72:75], v[84:87]
    v_mfma_f32_16x16x32_bf16 v[88:91], a[220:223], v[72:75], v[88:91]
    s_waitcnt lgkmcnt(0)
    s_nop 6
    v_cvt_pk_bf16_f32 v92, v76, v77
    v_cvt_pk_bf16_f32 v93, v78, v79
    v_cvt_pk_bf16_f32 v94, v80, v81
    v_cvt_pk_bf16_f32 v95, v82, v83
    v_cvt_pk_bf16_f32 v96, v84, v85
    v_cvt_pk_bf16_f32 v97, v86, v87
    v_cvt_pk_bf16_f32 v98, v88, v89
    v_cvt_pk_bf16_f32 v99, v90, v91
    s_nop 0
    v_mfma_f32_16x16x32_bf16 v[116:119], v[100:103], v[92:95], 0
    v_mfma_f32_16x16x32_bf16 v[120:123], v[108:111], v[92:95], 0
    v_mfma_f32_16x16x32_bf16 v[124:127], v[160:163], v[92:95], 0
    v_mfma_f32_16x16x32_bf16 v[116:119], v[104:107], v[96:99], v[116:119]
    v_mfma_f32_16x16x32_bf16 v[120:123], v[112:115], v[96:99], v[120:123]
    v_mfma_f32_16x16x32_bf16 v[124:127], v[164:167], v[96:99], v[124:127]
    s_branch .chain_kernel_td20
.chain_kernel_t219:
    s_waitcnt lgkmcnt(15)
    v_mfma_f32_16x16x32_bf16 v[76:79], a[0:3], v[20:23], 0
    v_mfma_f32_16x16x32_bf16 v[80:83], a[56:59], v[20:23], 0
    s_waitcnt lgkmcnt(14)
    v_mfma_f32_16x16x32_bf16 v[76:79], a[4:7], v[24:27], v[76:79]
    v_mfma_f32_16x16x32_bf16 v[80:83], a[60:63], v[24:27], v[80:83]
    s_waitcnt lgkmcnt(13)
    v_mfma_f32_16x16x32_bf16 v[76:79], a[8:11], v[28:31], v[76:79]
    v_mfma_f32_16x16x32_bf16 v[80:83], a[64:67], v[28:31], v[80:83]
    s_waitcnt lgkmcnt(12)
    v_mfma_f32_16x16x32_bf16 v[76:79], a[12:15], v[32:35], v[76:79]
    v_mfma_f32_16x16x32_bf16 v[80:83], a[68:71], v[32:35], v[80:83]
    s_cmp_lt_u32 s20, 28
    s_cbranch_scc1 .chain_kernel_nsx28
    global_load_dwordx4 v[176:179], v4, s[30:31]
    global_load_dwordx4 v[184:187], v7, s[30:31]
    s_cmp_eq_u32 s18, 3
    s_cbranch_scc1 .chain_kernel_x229
    global_load_dwordx4 v[180:183], v4, s[30:31] offset:1024
    global_load_dwordx4 v[188:191], v7, s[30:31] offset:1024
.chain_kernel_x229:
    s_add_u32 s30, s30, 28672
    s_addc_u32 s31, s31, 0
.chain_kernel_nsx28:
    s_and_b32 s38, s23, 3
    s_cmp_lg_u32 s38, 0
    s_cbranch_scc1 .chain_kernel_f130
    s_cmp_eq_u32 s23, 0
    s_cbranch_scc1 .chain_kernel_f130
    v_readfirstlane_b32 s38, v173
    s_nop 3
    s_cmp_ge_u32 s38, 16
    s_cbranch_scc1 .chain_kernel_f130
    s_lshr_b32 s76, s23, 2
    s_lshl_b32 s38, s76, 2
    s_add_u32 s38, s38, 256
    v_mov_b32 v172, s38
    s_mov_b32 s45, 0
.chain_kernel_fl32:
    global_load_dword v173, v172, s[46:47] sc1
    s_waitcnt vmcnt(0)
    v_readfirstlane_b32 s38, v173
    s_nop 3
    s_cmp_ge_u32 s38, 16
    s_cbranch_scc1 .chain_kernel_fld33
    s_add_u32 s45, s45, 1
    s_cmp_lt_u32 s45, 1048576
    s_cbranch_scc1 .chain_kernel_fl32
    s_branch .chain_kernel_end1
.chain_kernel_fld33:
.chain_kernel_f130:
    s_and_b32 s38, s23, 3
    s_cmp_lg_u32 s38, 2
    s_cbranch_scc1 .chain_kernel_f231
    s_lshr_b32 s38, s23, 2
    s_lshl_b32 s38, s38, 2
    s_add_u32 s38, s38, 260
    v_mov_b32 v172, s38
    global_load_dword v173, v172, s[46:47] sc1
.chain_kernel_f231:
    s_cmp_ge_u32 s20, 28
    s_cbranch_scc1 .chain_kernel_nd34
    s_add_u32 s54, s32, 0x7000
    s_addc_u32 s55, s33, 0
    s_add_u32 s56, s32, 0xe000
    s_addc_u32 s57, s33, 0
    s_add_u32 s58, s32, 0x15000
    s_addc_u32 s59, s33, 0
    global_load_dwordx4 v[144:147], v4, s[32:33]
    global_load_dwordx4 v[148:151], v4, s[54:55]
    global_load_dwordx4 v[152:155], v4, s[56:57]
    global_load_dwordx4 v[156:159], v4, s[58:59]
.chain_kernel_nd34:
    s_add_u32 s32, s32, 458752
    s_addc_u32 s33, s33, 0
    s_cmp_ge_u32 s20, 28
    s_cselect_b32 s38, s74, s28
    s_cselect_b32 s39, s75, s29
    s_mov_b64 exec, s[42:43]
    global_load_dword v10, v174, s[38:39]
    global_load_dword v1, v175, s[24:25]
    s_mov_b64 exec, -1
    s_waitcnt lgkmcnt(11)
    v_mfma_f32_16x16x32_bf16 v[76:79], a[16:19], v[36:39], v[76:79]
    v_mfma_f32_16x16x32_bf16 v[80:83], a[72:75], v[36:39], v[80:83]
    s_waitcnt lgkmcnt(10)
    v_mfma_f32_16x16x32_bf16 v[76:79], a[20:23], v[40:43], v[76:79]
    v_mfma_f32_16x16x32_bf16 v[80:83], a[76:79], v[40:43], v[80:83]
    s_waitcnt lgkmcnt(9)
    v_mfma_f32_16x16x32_bf16 v[76:79], a[24:27], v[44:47], v[76:79]
    v_mfma_f32_16x16x32_bf16 v[80:83], a[80:83], v[44:47], v[80:83]
    s_waitcnt lgkmcnt(8)
    v_mfma_f32_16x16x32_bf16 v[76:79], a[28:31], v[48:51], v[76:79]
    v_mfma_f32_16x16x32_bf16 v[80:83], a[84:87], v[48:51], v[80:83]
    s_waitcnt lgkmcnt(7)
    v_mfma_f32_16x16x32_bf16 v[76:79], a[32:35], v[52:55], v[76:79]
    v_mfma_f32_16x16x32_bf16 v[80:83], a[88:91], v[52:55], v[80:83]
    s_waitcnt lgkmcnt(6)
    v_mfma_f32_16x16x32_bf16 v[76:79], a[36:39], v[56:59], v[76:79]
    v_mfma_f32_16x16x32_bf16 v[80:83], a[92:95], v[56:59], v[80:83]
    s_waitcnt lgkmcnt(5)
    v_mfma_f32_16x16x32_bf16 v[76:79], a[40:43], v[60:63], v[76:79]
    v_mfma_f32_16x16x32_bf16 v[80:83], a[96:99], v[60:63], v[80:83]
    s_waitcnt lgkmcnt(4)
    v_mfma_f32_16x16x32_bf16 v[76:79], a[44:47], v[64:67], v[76:79]
    v_mfma_f32_16x16x32_bf16 v[80:83], a[100:103], v[64:67], v[80:83]
    s_waitcnt lgkmcnt(3)
    v_mfma_f32_16x16x32_bf16 v[76:79], a[48:51], v[68:71], v[76:79]
    v_mfma_f32_16x16x32_bf16 v[80:83], a[104:107], v[68:71], v[80:83]
    s_waitcnt lgkmcnt(2)
    v_mfma_f32_16x16x32_bf16 v[76:79], a[52:55], v[72:75], v[76:79]
    v_mfma_f32_16x16x32_bf16 v[80:83], a[108:111], v[72:75], v[80:83]
    s_waitcnt lgkmcnt(0)
    s_nop 6
    v_cvt_pk_bf16_f32 v92, v76, v77
    v_cvt_pk_bf16_f32 v93, v78, v79
    v_cvt_pk_bf16_f32 v94, v80, v81
    v_cvt_pk_bf16_f32 v95, v82, v83
    s_nop 0
    v_mfma_f32_16x16x32_bf16 v[116:119], v[100:103], v[92:95], 0
    v_mfma_f32_16x16x32_bf16 v[120:123], v[108:111], v[92:95], 0
    v_mfma_f32_16x16x32_bf16 v[124:127], v[160:163], v[92:95], 0
.chain_kernel_td20:
    s_nop 7
    ds_write_b128 v8, v[116:119] offset:0
    ds_write_b128 v8, v[120:123] offset:1024
    ds_write_b128 v8, v[124:127] offset:2048
    s_waitcnt lgkmcnt(0)
    s_barrier
    s_cmp_eq_u32 s18, 3
    s_cbranch_scc1 .chain_kernel_h1d36
    ds_read_b128 v[128:131], v0 offset:0
    ds_read_b128 v[132:135], v0 offset:3072
    ds_read_b128 v[136:139], v0 offset:6144
    ds_read_b128 v[140:143], v0 offset:9216
    s_waitcnt lgkmcnt(0)
    v_pk_add_f32 v[128:129], v[128:129], v[132:133]
    v_pk_add_f32 v[130:131], v[130:131], v[134:135]
    v_pk_add_f32 v[136:137], v[136:137], v[140:141]
    v_pk_add_f32 v[138:139], v[138:139], v[142:143]
    v_pk_add_f32 v[128:129], v[128:129], v[136:137]
    v_pk_add_f32 v[130:131], v[130:131], v[138:139]
    v_min_u32 v128, -2, v128
    v_min_u32 v129, -2, v129
    v_min_u32 v130, -2, v130
    v_min_u32 v131, -2, v131
    s_mov_b64 exec, s[40:41]
    global_store_dwordx4 v9, v[128:131], s[26:27]
    s_mov_b64 exec, -1
    s_nop 1
.chain_kernel_h1d36:
    s_cmp_ge_u32 s20, 28
    s_cbranch_scc1 .chain_kernel_srv37
    global_load_dwordx4 v[100:103], v4, s[30:31]
    global_load_dwordx4 v[108:111], v7, s[30:31]
    s_cmp_eq_u32 s18, 3
    s_cbranch_scc1 .chain_kernel_x238
    global_load_dwordx4 v[104:107], v4, s[30:31] offset:1024
    global_load_dwordx4 v[112:115], v7, s[30:31] offset:1024
.chain_kernel_x238:
    s_add_u32 s30, s30, 28672
    s_addc_u32 s31, s31, 0
.chain_kernel_srv37:
    s_cmp_lt_u32 s20, 28
    s_cbranch_scc1 .chain_kernel_nsm39
    v_mov_b32 v76, 0
    v_mov_b32 v77, 0
    v_mov_b32 v78, 0
    v_mov_b32 v79, 0
    v_mov_b32 v80, 0
    v_mov_b32 v81, 0
    v_mov_b32 v82, 0
    v_mov_b32 v83, 0
    v_mov_b32 v84, 0
    v_mov_b32 v85, 0
    v_mov_b32 v86, 0
    v_mov_b32 v87, 0
    v_mov_b32 v88, 0
    v_mov_b32 v89, 0
    v_mov_b32 v90, 0
    v_mov_b32 v91, 0
    v_mov_b32 v92, 0
    v_mov_b32 v93, 0
    v_mov_b32 v94, 0
    v_mov_b32 v95, 0
    v_mov_b32 v96, 0
    v_mov_b32 v97, 0
    v_mov_b32 v98, 0
    v_mov_b32 v99, 0
    s_mov_b32 s45, 0
.chain_kernel_pl40:
    s_mov_b64 exec, s[40:41]
    global_load_dwordx4 v[76:79], v5, s[74:75] offset:0 sc1
    global_load_dwordx4 v[80:83], v5, s[74:75] offset:512 sc1
    global_load_dwordx4 v[84:87], v5, s[74:75] offset:1024 sc1
    global_load_dwordx4 v[88:91], v5, s[74:75] offset:1536 sc1
    global_load_dwordx4 v[92:95], v5, s[74:75] offset:2048 sc1
    global_load_dwordx4 v[96:99], v5, s[74:75] offset:2560 sc1
    s_mov_b64 exec, -1
    s_waitcnt vmcnt(0)
    v_max3_u32 v10, v76, v77, v78
    v_max3_u32 v10, v10, v79, v80
    v_max3_u32 v10, v10, v81, v82
    v_max3_u32 v10, v10, v83, v84
    v_max3_u32 v10, v10, v85, v86
    v_max3_u32 v10, v10, v87, v88
    v_max3_u32 v10, v10, v89, v90
    v_max3_u32 v10, v10, v91, v92
    v_max3_u32 v10, v10, v93, v94
    v_max3_u32 v10, v10, v95, v96
    v_max3_u32 v10, v10, v97, v98
    v_max_u32 v10, v10, v99
    v_cmp_eq_u32 vcc, -1, v10
    s_add_u32 s45, s45, 1
    s_cbranch_vccz .chain_kernel_pld41
    s_cmp_lt_u32 s45, 1048576
    s_cbranch_scc1 .chain_kernel_pl40
    s_branch .chain_kernel_end1
.chain_kernel_pld41:
    v_pk_add_f32 v[76:77], v[76:77], v[80:81]
    v_pk_add_f32 v[78:79], v[78:79], v[82:83]
    v_pk_add_f32 v[84:85], v[84:85], v[88:89]
    v_pk_add_f32 v[86:87], v[86:87], v[90:91]
    v_pk_add_f32 v[92:93], v[92:93], v[96:97]
    v_pk_add_f32 v[94:95], v[94:95], v[98:99]
    v_cndmask_b32 v92, v3, v92, s[42:43]
    v_cndmask_b32 v93, v3, v93, s[42:43]
    v_cndmask_b32 v94, v3, v94, s[42:43]
    v_cndmask_b32 v95, v3, v95, s[42:43]
    v_max3_f32 v80, v76, v77, v78
    v_max3_f32 v80, v80, v79, v84
    v_max3_f32 v80, v80, v85, v86
    v_max3_f32 v80, v80, v87, v92
    v_max3_f32 v80, v80, v93, v94
    v_max_f32 v80, v80, v95
    v_mov_b32 v81, v80
    s_nop 1
    v_permlane32_swap_b32 v80, v81
    v_max_f32 v80, v80, v81
    v_mov_b32 v81, v80
    s_nop 1
    v_permlane16_swap_b32 v80, v81
    v_max_f32 v80, v80, v81
    v_mul_f32 v80, s48, v80
    v_pk_fma_f32 v[76:77], v[76:77], s[48:49], v[80:81] op_sel_hi:[1,1,0] neg_lo:[0,0,1] neg_hi:[0,0,1]
    v_pk_fma_f32 v[78:79], v[78:79], s[48:49], v[80:81] op_sel_hi:[1,1,0] neg_lo:[0,0,1] neg_hi:[0,0,1]
    v_pk_fma_f32 v[84:85], v[84:85], s[48:49], v[80:81] op_sel_hi:[1,1,0] neg_lo:[0,0,1] neg_hi:[0,0,1]
    v_pk_fma_f32 v[86:87], v[86:87], s[48:49], v[80:81] op_sel_hi:[1,1,0] neg_lo:[0,0,1] neg_hi:[0,0,1]
    v_pk_fma_f32 v[92:93], v[92:93], s[48:49], v[80:81] op_sel_hi:[1,1,0] neg_lo:[0,0,1] neg_hi:[0,0,1]
    v_pk_fma_f32 v[94:95], v[94:95], s[48:49], v[80:81] op_sel_hi:[1,1,0] neg_lo:[0,0,1] neg_hi:[0,0,1]
    v_exp_f32 v76, v76
    v_exp_f32 v77, v77
    v_exp_f32 v78, v78
    v_exp_f32 v79, v79
    v_exp_f32 v84, v84
    v_exp_f32 v85, v85
    v_exp_f32 v86, v86
    v_exp_f32 v87, v87
    v_exp_f32 v92, v92
    v_exp_f32 v93, v93
    v_exp_f32 v94, v94
    v_exp_f32 v95, v95
    s_nop 0
    v_pk_add_f32 v[82:83], v[76:77], v[78:79]
    v_pk_add_f32 v[82:83], v[82:83], v[84:85]
    v_pk_add_f32 v[82:83], v[82:83], v[86:87]
    v_pk_add_f32 v[82:83], v[82:83], v[92:93]
    v_pk_add_f32 v[82:83], v[82:83], v[94:95]
    v_add_f32 v82, v82, v83
    v_mov_b32 v81, v82
    s_nop 1
    v_permlane32_swap_b32 v82, v81
    v_add_f32 v82, v82, v81
    v_mov_b32 v81, v82
    s_nop 1
    v_permlane16_swap_b32 v82, v81
    v_add_f32 v82, v82, v81
    v_rcp_f32 v82, v82
    s_nop 0
    v_pk_mul_f32 v[76:77], v[76:77], v[82:83] op_sel_hi:[1,0]
    v_pk_mul_f32 v[78:79], v[78:79], v[82:83] op_sel_hi:[1,0]
    v_pk_mul_f32 v[84:85], v[84:85], v[82:83] op_sel_hi:[1,0]
    v_pk_mul_f32 v[86:87], v[86:87], v[82:83] op_sel_hi:[1,0]
    v_pk_mul_f32 v[92:93], v[92:93], v[82:83] op_sel_hi:[1,0]
    v_pk_mul_f32 v[94:95], v[94:95], v[82:83] op_sel_hi:[1,0]
    v_cvt_pk_bf16_f32 v116, v76, v77
    v_cvt_pk_bf16_f32 v117, v78, v79
    v_cvt_pk_bf16_f32 v118, v84, v85
    v_cvt_pk_bf16_f32 v119, v86, v87
    v_cvt_pk_bf16_f32 v120, v92, v93
    v_cvt_pk_bf16_f32 v121, v94, v95
    v_min_u32 v116, -2, v116
    v_min_u32 v117, -2, v117
    v_min_u32 v118, -2, v118
    v_min_u32 v119, -2, v119
    v_min_u32 v120, -2, v120
    v_min_u32 v121, -2, v121
    v_lshrrev_b32 v10, 1, v5
    s_mov_b64 exec, s[40:41]
    global_store_dwordx4 v5, v[116:119], s[72:73]
    global_store_dwordx2 v10, v[120:121], s[72:73] offset:512
    s_mov_b64 exec, -1
    s_nop 1
    v_mov_b32 v100, v176
    v_mov_b32 v101, v177
    v_mov_b32 v102, v178
    v_mov_b32 v103, v179
    v_mov_b32 v104, v180
    v_mov_b32 v105, v181
    v_mov_b32 v106, v182
    v_mov_b32 v107, v183
    v_mov_b32 v108, v184
    v_mov_b32 v109, v185
    v_mov_b32 v110, v186
    v_mov_b32 v111, v187
    v_mov_b32 v112, v188
    v_mov_b32 v113, v189
    v_mov_b32 v114, v190
    v_mov_b32 v115, v191
.chain_kernel_nsm39:
    s_cmp_ge_u32 s20, 28
    s_cbranch_scc1 .chain_kernel_nu142
    ds_read_b128 v[76:79], v19 offset:0
    ds_read_b128 v[80:83], v19 offset:14336
    ds_read_b128 v[84:87], v19 offset:1024
    ds_read_b128 v[88:91], v19 offset:15360
    ds_read_b128 v[92:95], v19 offset:2048
    ds_read_b128 v[96:99], v19 offset:16384
    ds_read_b128 v[116:119], v19 offset:3072
    ds_read_b128 v[120:123], v19 offset:17408
    s_waitcnt lgkmcnt(6)
    v_mfma_f32_16x16x32_bf16 v[136:139], v[20:23], v[76:79], 0
    v_mfma_f32_16x16x32_bf16 v[140:143], v[20:23], v[80:83], 0
    ds_read_b128 v[76:79], v19 offset:4096
    ds_read_b128 v[80:83], v19 offset:18432
    s_waitcnt lgkmcnt(6)
    v_mfma_f32_16x16x32_bf16 v[136:139], v[24:27], v[84:87], v[136:139]
    v_mfma_f32_16x16x32_bf16 v[140:143], v[24:27], v[88:91], v[140:143]
    ds_read_b128 v[84:87], v19 offset:5120
    ds_read_b128 v[88:91], v19 offset:19456
    s_waitcnt lgkmcnt(6)
    v_mfma_f32_16x16x32_bf16 v[136:139], v[28:31], v[92:95], v[136:139]
    v_mfma_f32_16x16x32_bf16 v[140:143], v[28:31], v[96:99], v[140:143]
    ds_read_b128 v[92:95], v19 offset:6144
    ds_read_b128 v[96:99], v19 offset:20480
    s_waitcnt lgkmcnt(6)
    v_mfma_f32_16x16x32_bf16 v[136:139], v[32:35], v[116:119], v[136:139]
    v_mfma_f32_16x16x32_bf16 v[140:143], v[32:35], v[120:123], v[140:143]
    ds_read_b128 v[116:119], v19 offset:7168
    ds_read_b128 v[120:123], v19 offset:21504
    s_waitcnt lgkmcnt(6)
    v_mfma_f32_16x16x32_bf16 v[136:139], v[36:39], v[76:79], v[136:139]
    v_mfma_f32_16x16x32_bf16 v[140:143], v[36:39], v[80:83], v[140:143]
    ds_read_b128 v[76:79], v19 offset:8192
    ds_read_b128 v[80:83], v19 offset:22528
    s_waitcnt lgkmcnt(6)
    v_mfma_f32_16x16x32_bf16 v[136:139], v[40:43], v[84:87], v[136:139]
    v_mfma_f32_16x16x32_bf16 v[140:143], v[40:43], v[88:91], v[140:143]
    ds_read_b128 v[84:87], v19 offset:9216
    ds_read_b128 v[88:91], v19 offset:23552
    s_waitcnt lgkmcnt(6)
    v_mfma_f32_16x16x32_bf16 v[136:139], v[44:47], v[92:95], v[136:139]
    v_mfma_f32_16x16x32_bf16 v[140:143], v[44:47], v[96:99], v[140:143]
    ds_read_b128 v[92:95], v19 offset:10240
    ds_read_b128 v[96:99], v19 offset:24576
    s_waitcnt lgkmcnt(6)
    v_mfma_f32_16x16x32_bf16 v[136:139], v[48:51], v[116:119], v[136:139]
    v_mfma_f32_16x16x32_bf16 v[140:143], v[48:51], v[120:123], v[140:143]
    ds_read_b128 v[116:119], v19 offset:11264
    ds_read_b128 v[120:123], v19 offset:25600
    s_waitcnt lgkmcnt(6)
    v_mfma_f32_16x16x32_bf16 v[136:139], v[52:55], v[76:79], v[136:139]
    v_mfma_f32_16x16x32_bf16 v[140:143], v[52:55], v[80:83], v[140:143]
    ds_read_b128 v[76:79], v19 offset:12288
    ds_read_b128 v[80:83], v19 offset:26624
    s_waitcnt lgkmcnt(6)
    v_mfma_f32_16x16x32_bf16 v[136:139], v[56:59], v[84:87], v[136:139]
    v_mfma_f32_16x16x32_bf16 v[140:143], v[56:59], v[88:91], v[140:143]
    ds_read_b128 v[84:87], v19 offset:13312
    ds_read_b128 v[88:91], v19 offset:27648
    s_waitcnt lgkmcnt(6)
    v_mfma_f32_16x16x32_bf16 v[136:139], v[60:63], v[92:95], v[136:139]
    v_mfma_f32_16x16x32_bf16 v[140:143], v[60:63], v[96:99], v[140:143]
    s_waitcnt lgkmcnt(4)
    v_mfma_f32_16x16x32_bf16 v[136:139], v[64:67], v[116:119], v[136:139]
    v_mfma_f32_16x16x32_bf16 v[140:143], v[64:67], v[120:123], v[140:143]
    s_waitcnt lgkmcnt(2)
    v_mfma_f32_16x16x32_bf16 v[136:139], v[68:71], v[76:79], v[136:139]
    v_mfma_f32_16x16x32_bf16 v[140:143], v[68:71], v[80:83], v[140:143]
    s_waitcnt lgkmcnt(0)
    v_mfma_f32_16x16x32_bf16 v[136:139], v[72:75], v[84:87], v[136:139]
    v_mfma_f32_16x16x32_bf16 v[140:143], v[72:75], v[88:91], v[140:143]
.chain_kernel_nu142:
    s_cmp_ge_u32 s20, 28
    s_cbranch_scc1 .chain_kernel_next35
    v_mfma_f32_16x16x32_bf16 v[128:131], v[20:23], a[224:227], 0
    v_mfma_f32_16x16x32_bf16 v[132:135], v[20:23], v[200:203], 0
    v_mfma_f32_16x16x32_bf16 v[128:131], v[24:27], a[228:231], v[128:131]
    v_mfma_f32_16x16x32_bf16 v[132:135], v[24:27], v[204:207], v[132:135]
    v_mfma_f32_16x16x32_bf16 v[128:131], v[28:31], a[232:235], v[128:131]
    v_mfma_f32_16x16x32_bf16 v[132:135], v[28:31], v[208:211], v[132:135]
    v_mfma_f32_16x16x32_bf16 v[128:131], v[32:35], a[236:239], v[128:131]
    v_mfma_f32_16x16x32_bf16 v[132:135], v[32:35], v[212:215], v[132:135]
    v_mfma_f32_16x16x32_bf16 v[128:131], v[36:39], a[240:243], v[128:131]
    v_mfma_f32_16x16x32_bf16 v[132:135], v[36:39], v[216:219], v[132:135]
    v_mfma_f32_16x16x32_bf16 v[128:131], v[40:43], a[244:247], v[128:131]
    v_mfma_f32_16x16x32_bf16 v[132:135], v[40:43], v[220:223], v[132:135]
    v_mfma_f32_16x16x32_bf16 v[128:131], v[44:47], a[248:251], v[128:131]
    v_mfma_f32_16x16x32_bf16 v[132:135], v[44:47], v[224:227], v[132:135]
    v_mfma_f32_16x16x32_bf16 v[128:131], v[48:51], a[252:255], v[128:131]
    v_mfma_f32_16x16x32_bf16 v[132:135], v[48:51], v[228:231], v[132:135]
    v_mfma_f32_16x16x32_bf16 v[128:131], v[52:55], v[176:179], v[128:131]
    v_mfma_f32_16x16x32_bf16 v[132:135], v[52:55], v[232:235], v[132:135]
    v_mfma_f32_16x16x32_bf16 v[128:131], v[56:59], v[180:183], v[128:131]
    v_mfma_f32_16x16x32_bf16 v[132:135], v[56:59], v[236:239], v[132:135]
    v_mfma_f32_16x16x32_bf16 v[128:131], v[60:63], v[184:187], v[128:131]
    v_mfma_f32_16x16x32_bf16 v[132:135], v[60:63], v[240:243], v[132:135]
    v_mfma_f32_16x16x32_bf16 v[128:131], v[64:67], v[188:191], v[128:131]
    v_mfma_f32_16x16x32_bf16 v[132:135], v[64:67], v[244:247], v[132:135]
    v_mfma_f32_16x16x32_bf16 v[128:131], v[68:71], v[192:195], v[128:131]
    v_mfma_f32_16x16x32_bf16 v[132:135], v[68:71], v[248:251], v[132:135]
    v_mfma_f32_16x16x32_bf16 v[128:131], v[72:75], v[196:199], v[128:131]
    v_mfma_f32_16x16x32_bf16 v[132:135], v[72:75], v[252:255], v[132:135]
    v_mov_b32 v168, 0
    v_mov_b32 v169, 0
    v_mov_b32 v170, 0
    v_mov_b32 v171, 0
    s_mov_b32 s45, 0
.chain_kernel_pl46:
    global_load_dwordx4 v[160:163], v6, s[28:29] sc1
    global_load_dwordx4 v[164:167], v6, s[28:29] offset:2048 sc1
    s_mov_b64 exec, s[42:43]
    global_load_dwordx2 v[168:169], v2, s[28:29] offset:512 sc1
    global_load_dwordx2 v[170:171], v2, s[28:29] offset:2560 sc1
    s_mov_b64 exec, -1
    s_waitcnt vmcnt(0)
    v_max3_u32 v10, v160, v161, v162
    v_max3_u32 v10, v10, v163, v164
    v_max3_u32 v10, v10, v165, v166
    v_max3_u32 v10, v10, v167, v168
    v_max3_u32 v10, v10, v169, v170
    v_max_u32 v10, v10, v171
    v_cmp_eq_u32 vcc, -1, v10
    s_add_u32 s45, s45, 1
    s_cbranch_vccz .chain_kernel_pld47
    s_cmp_lt_u32 s45, 1048576
    s_cbranch_scc1 .chain_kernel_pl46
    s_branch .chain_kernel_end1
.chain_kernel_pld47:
    v_cvt_pk_bf16_f32 v76, v128, v129
    v_cvt_pk_bf16_f32 v77, v130, v131
    v_cvt_pk_bf16_f32 v78, v136, v137
    v_cvt_pk_bf16_f32 v79, v138, v139
    v_cvt_pk_bf16_f32 v80, v132, v133
    v_cvt_pk_bf16_f32 v81, v134, v135
    v_cvt_pk_bf16_f32 v82, v140, v141
    v_cvt_pk_bf16_f32 v83, v142, v143
    s_nop 0
    v_mfma_f32_16x16x32_bf16 v[128:131], v[144:147], v[160:163], 0
    v_mfma_f32_16x16x32_bf16 v[132:135], v[148:151], v[160:163], 0
    v_mfma_f32_16x16x32_bf16 v[128:131], v[152:155], v[164:167], v[128:131]
    v_mfma_f32_16x16x32_bf16 v[132:135], v[156:159], v[164:167], v[132:135]
    v_mfma_f32_16x16x32_bf16 v[128:131], v[76:79], v[168:171], v[128:131]
    v_mfma_f32_16x16x32_bf16 v[132:135], v[80:83], v[168:171], v[132:135]
    s_nop 7
    ds_write_b128 v11, v[128:131]
    ds_write_b128 v11, v[132:135] offset:1024
    s_waitcnt lgkmcnt(0)
    s_barrier
    s_cmp_lg_u32 s18, 0
    s_cbranch_scc1 .chain_kernel_next35
    ds_read_b128 v[84:87], v12 offset:0
    ds_read_b128 v[88:91], v12 offset:1152
    ds_read_b128 v[92:95], v12 offset:2048
    ds_read_b128 v[96:99], v12 offset:3200
    ds_read_b128 v[116:119], v12 offset:4096
    ds_read_b128 v[120:123], v12 offset:5248
    ds_read_b128 v[124:127], v12 offset:6144
    ds_read_b128 v[136:139], v12 offset:7296
    s_waitcnt lgkmcnt(0)
    v_pk_add_f32 v[84:85], v[84:85], v[88:89]
    v_pk_add_f32 v[86:87], v[86:87], v[90:91]
    v_pk_add_f32 v[84:85], v[84:85], v[92:93]
    v_pk_add_f32 v[86:87], v[86:87], v[94:95]
    v_pk_add_f32 v[84:85], v[84:85], v[96:97]
    v_pk_add_f32 v[86:87], v[86:87], v[98:99]
    v_pk_add_f32 v[84:85], v[84:85], v[116:117]
    v_pk_add_f32 v[86:87], v[86:87], v[118:119]
    v_pk_add_f32 v[84:85], v[84:85], v[120:121]
    v_pk_add_f32 v[86:87], v[86:87], v[122:123]
    v_pk_add_f32 v[84:85], v[84:85], v[124:125]
    v_pk_add_f32 v[86:87], v[86:87], v[126:127]
    v_pk_add_f32 v[84:85], v[84:85], v[136:137]
    v_pk_add_f32 v[86:87], v[86:87], v[138:139]
    v_cvt_pk_bf16_f32 v84, v84, v85
    v_cvt_pk_bf16_f32 v85, v86, v87
    v_min_u32 v84, -2, v84
    v_min_u32 v85, -2, v85
    s_mov_b64 exec, s[40:41]
    global_store_dwordx2 v5, v[84:85], s[36:37]
    s_mov_b64 exec, -1
.chain_kernel_next35:
    s_add_u32 s24, s24, 7168
    s_addc_u32 s25, s25, 0
    s_add_u32 s26, s26, 49152
    s_addc_u32 s27, s27, 0
    s_add_u32 s28, s28, 16384
    s_addc_u32 s29, s29, 0
    s_add_u32 s72, s72, 16384
    s_addc_u32 s73, s73, 0
    s_add_u32 s74, s74, 49152
    s_addc_u32 s75, s75, 0
    s_add_u32 s36, s36, 7168
    s_addc_u32 s37, s37, 0
    s_add_u32 s82, s82, 7168
    s_addc_u32 s83, s83, 0
    s_add_u32 s23, s23, 1
    s_cmp_lt_u32 s23, 64
    s_cbranch_scc1 .chain_kernel_loop13
    s_cmp_ge_u32 s20, 28
    s_cbranch_scc1 .chain_kernel_nuf348
    s_mov_b64 exec, s[42:43]
    global_store_dwordx2 v4, v[76:77], s[34:35] sc1
    global_store_dwordx2 v4, v[80:81], s[34:35] offset:8 sc1
    global_store_dwordx2 v4, v[78:79], s[34:35] offset:512 sc1
    global_store_dwordx2 v4, v[82:83], s[34:35] offset:520 sc1
    s_mov_b64 exec, -1
    s_add_u32 s34, s34, 114688
    s_addc_u32 s35, s35, 0
.chain_kernel_nuf348:
    s_waitcnt vmcnt(0)
    s_barrier
    s_cmp_lg_u32 s18, 1
    s_cbranch_scc1 .chain_kernel_nsg49
    s_cmp_ge_u32 s20, 29
    s_cbranch_scc1 .chain_kernel_nsg49
    s_mov_b32 s38, 7
    s_lshl_b32 s38, s38, 2
    s_add_u32 s38, s38, 448
    s_mov_b64 exec, 1
    v_mov_b32 v10, s38
    v_mov_b32 v1, 1
    global_atomic_add v10, v1, s[46:47] sc1
    s_mov_b64 exec, -1
.chain_kernel_nsg49:
    v_lshrrev_b32 v0, 4, v4
    s_lshl_b32 s38, s18, 6
    v_add_u32 v0, s38, v0
.chain_kernel_work7:
    s_add_u32 s46, s16, 0x0
    s_addc_u32 s47, s17, 0
    s_barrier
    s_cmp_lg_u32 s18, 0
    s_cbranch_scc1 .chain_kernel_w150
    s_mov_b64 exec, 1
    v_mov_b32 v10, 128
    v_mov_b32 v11, 1
    global_atomic_add v12, v10, v11, s[46:47] sc0 sc1
    s_waitcnt vmcnt(0)
    v_readfirstlane_b32 s2, v12
    s_nop 3
    s_cmp_ge_u32 s2, 3152
    s_cbranch_scc1 .chain_kernel_nodep51
    s_mov_b32 s95, s2
    s_mov_b32 s87, 0
    s_mov_b32 s86, 0
    s_cmp_ge_u32 s2, 64
    s_cbranch_scc1 .chain_kernel_dc058
    s_mov_b32 s84, 6
    s_mov_b32 s85, s2
    s_mov_b32 s87, 256
    s_branch .chain_kernel_dec52
.chain_kernel_dc058:
    s_sub_u32 s2, s2, 48
    s_cmp_ge_u32 s2, 256
    s_cbranch_scc1 .chain_kernel_dc53
    s_mov_b32 s84, 0
    s_mov_b32 s85, s2
    s_lshr_b32 s87, s2, 4
    s_lshl_b32 s87, s87, 2
    s_add_u32 s87, s87, 256
    s_branch .chain_kernel_dec52
.chain_kernel_dc53:
    s_cmp_ge_u32 s2, 512
    s_cbranch_scc1 .chain_kernel_dc54
    s_mov_b32 s84, 1
    s_sub_u32 s85, s2, 256
    s_lshr_b32 s87, s85, 5
    s_lshl_b32 s87, s87, 2
    s_add_u32 s87, s87, 384
    s_branch .chain_kernel_dec52
.chain_kernel_dc54:
    s_sub_u32 s38, s2, 512
    s_mul_i32 s86, s38, 3641
    s_lshr_b32 s86, s86, 20
    s_mul_i32 s39, s86, 288
    s_sub_u32 s38, s38, s39
    s_mov_b32 s84, 7
    s_cmp_ge_u32 s38, 144
    s_cselect_b32 s39, 1, 0
    s_sub_u32 s86, s86, s39
    s_cmp_ge_u32 s86, 8
    s_cbranch_scc1 .chain_kernel_dec52
    s_cmp_ge_u32 s38, 128
    s_cbranch_scc1 .chain_kernel_dc55
    s_mov_b32 s84, 2
    s_lshl_b32 s85, s86, 7
    s_add_u32 s85, s85, s38
    s_lshl_b32 s87, s86, 2
    s_add_u32 s87, s87, 512
    s_branch .chain_kernel_dec52
.chain_kernel_dc55:
    s_cmp_ge_u32 s38, 144
    s_cbranch_scc1 .chain_kernel_dc56
    s_mov_b32 s84, 3
    s_lshl_b32 s85, s86, 4
    s_add_u32 s85, s85, s38
    s_sub_u32 s85, s85, 128
    s_lshr_b32 s87, s85, 1
    s_lshl_b32 s87, s87, 2
    s_add_u32 s87, s87, 576
    s_branch .chain_kernel_dec52
.chain_kernel_dc56:
    s_cmp_ge_u32 s38, 256
    s_cbranch_scc1 .chain_kernel_dc57
    s_mov_b32 s84, 4
    s_sub_u32 s38, s38, 144
    s_and_b32 s39, s38, 7
    s_lshl_b32 s87, s86, 3
    s_add_u32 s39, s39, s87
    s_lshr_b32 s38, s38, 3
    s_lshl_b32 s85, s38, 6
    s_add_u32 s85, s85, s39
    s_lshl_b32 s87, s39, 2
    s_add_u32 s87, s87, 832
    s_branch .chain_kernel_dec52
.chain_kernel_dc57:
    s_mov_b32 s84, 5
    s_sub_u32 s38, s38, 256
    s_and_b32 s39, s38, 7
    s_lshl_b32 s85, s86, 3
    s_add_u32 s39, s39, s85
    s_lshr_b32 s38, s38, 3
    s_lshl_b32 s85, s38, 6
    s_add_u32 s85, s85, s39
.chain_kernel_dec52:
    s_mov_b32 s2, s95
    s_cmp_lt_u32 s84, 3
    s_cbranch_scc1 .chain_kernel_nodep51
    s_cmp_ge_u32 s84, 6
    s_cbranch_scc1 .chain_kernel_nodep51
.chain_kernel_dp60:
    s_cmp_lg_u32 s84, 3
    s_cbranch_scc1 .chain_kernel_dp61
    s_lshr_b32 s88, s85, 3
    s_cmp_eq_u32 s88, 0
    s_cselect_b32 s89, 64, 16
    s_lshl_b32 s88, s88, 2
    s_add_u32 s88, s88, 256
    v_mov_b32 v10, s88
    s_mov_b32 s45, 0
.chain_kernel_wc63:
    global_load_dword v11, v10, s[46:47] sc1
    s_waitcnt vmcnt(0)
    v_readfirstlane_b32 s38, v11
    s_nop 3
    s_cmp_ge_u32 s38, s89
    s_cbranch_scc1 .chain_kernel_wcd64
    s_sleep 14
    s_add_u32 s45, s45, 1
    s_cmp_lt_u32 s45, 1048576
    s_cbranch_scc1 .chain_kernel_wc63
    s_branch .chain_kernel_end1
.chain_kernel_wcd64:
    s_branch .chain_kernel_nodep51
.chain_kernel_dp61:
    s_cmp_eq_u32 s84, 4
    s_cbranch_scc1 .chain_kernel_nodep51
.chain_kernel_dp62:
.chain_kernel_nodep51:
    v_mov_b32 v13, 143360
    v_mov_b32 v12, s2
    ds_write_b32 v13, v12
    s_waitcnt lgkmcnt(0)
    s_mov_b64 exec, -1
.chain_kernel_w150:
    s_barrier
    v_mov_b32 v13, 143360
    ds_read_b32 v12, v13
    s_waitcnt lgkmcnt(0)
    v_readfirstlane_b32 s2, v12
    s_nop 3
    s_cmp_ge_u32 s2, 3152
    s_cbranch_scc1 .chain_kernel_end1
    s_mov_b32 s95, s2
    s_mov_b32 s87, 0
    s_mov_b32 s86, 0
    s_cmp_ge_u32 s2, 64
    s_cbranch_scc1 .chain_kernel_dc071
    s_mov_b32 s84, 6
    s_mov_b32 s85, s2
    s_mov_b32 s87, 256
    s_branch .chain_kernel_dec65
.chain_kernel_dc071:
    s_sub_u32 s2, s2, 48
    s_cmp_ge_u32 s2, 256
    s_cbranch_scc1 .chain_kernel_dc66
    s_mov_b32 s84, 0
    s_mov_b32 s85, s2
    s_lshr_b32 s87, s2, 4
    s_lshl_b32 s87, s87, 2
    s_add_u32 s87, s87, 256
    s_branch .chain_kernel_dec65
.chain_kernel_dc66:
    s_cmp_ge_u32 s2, 512
    s_cbranch_scc1 .chain_kernel_dc67
    s_mov_b32 s84, 1
    s_sub_u32 s85, s2, 256
    s_lshr_b32 s87, s85, 5
    s_lshl_b32 s87, s87, 2
    s_add_u32 s87, s87, 384
    s_branch .chain_kernel_dec65
.chain_kernel_dc67:
    s_sub_u32 s38, s2, 512
    s_mul_i32 s86, s38, 3641
    s_lshr_b32 s86, s86, 20
    s_mul_i32 s39, s86, 288
    s_sub_u32 s38, s38, s39
    s_mov_b32 s84, 7
    s_cmp_ge_u32 s38, 144
    s_cselect_b32 s39, 1, 0
    s_sub_u32 s86, s86, s39
    s_cmp_ge_u32 s86, 8
    s_cbranch_scc1 .chain_kernel_dec65
    s_cmp_ge_u32 s38, 128
    s_cbranch_scc1 .chain_kernel_dc68
    s_mov_b32 s84, 2
    s_lshl_b32 s85, s86, 7
    s_add_u32 s85, s85, s38
    s_lshl_b32 s87, s86, 2
    s_add_u32 s87, s87, 512
    s_branch .chain_kernel_dec65
.chain_kernel_dc68:
    s_cmp_ge_u32 s38, 144
    s_cbranch_scc1 .chain_kernel_dc69
    s_mov_b32 s84, 3
    s_lshl_b32 s85, s86, 4
    s_add_u32 s85, s85, s38
    s_sub_u32 s85, s85, 128
    s_lshr_b32 s87, s85, 1
    s_lshl_b32 s87, s87, 2
    s_add_u32 s87, s87, 576
    s_branch .chain_kernel_dec65
.chain_kernel_dc69:
    s_cmp_ge_u32 s38, 256
    s_cbranch_scc1 .chain_kernel_dc70
    s_mov_b32 s84, 4
    s_sub_u32 s38, s38, 144
    s_and_b32 s39, s38, 7
    s_lshl_b32 s87, s86, 3
    s_add_u32 s39, s39, s87
    s_lshr_b32 s38, s38, 3
    s_lshl_b32 s85, s38, 6
    s_add_u32 s85, s85, s39
    s_lshl_b32 s87, s39, 2
    s_add_u32 s87, s87, 832
    s_branch .chain_kernel_dec65
.chain_kernel_dc70:
    s_mov_b32 s84, 5
    s_sub_u32 s38, s38, 256
    s_and_b32 s39, s38, 7
    s_lshl_b32 s85, s86, 3
    s_add_u32 s39, s39, s85
    s_lshr_b32 s38, s38, 3
    s_lshl_b32 s85, s38, 6
    s_add_u32 s85, s85, s39
.chain_kernel_dec65:
    s_mov_b32 s2, s85
    s_mov_b32 s92, s87
    v_and_b32 v4, 63, v0
    v_lshlrev_b32 v4, 4, v4
    s_cmp_eq_u32 s84, 7
    s_cbranch_scc1 .chain_kernel_fin79
    s_cmp_eq_u32 s84, 1
    s_cbranch_scc1 .chain_kernel_ty73
    s_cmp_eq_u32 s84, 2
    s_cbranch_scc1 .chain_kernel_ty74
    s_cmp_eq_u32 s84, 3
    s_cbranch_scc1 .chain_kernel_ty75
    s_cmp_eq_u32 s84, 4
    s_cbranch_scc1 .chain_kernel_ty76
    s_cmp_eq_u32 s84, 5
    s_cbranch_scc1 .chain_kernel_ty77
    s_cmp_eq_u32 s84, 6
    s_cbranch_scc1 .chain_kernel_ty78
    s_lshr_b32 s21, s2, 4
    s_and_b32 s20, s2, 15
    s_mul_i32 s22, s21, 114688
    s_add_u32 s22, s22, 0x1000
    s_add_u32 s26, s16, s22
    s_addc_u32 s27, s17, 0
    v_add_u32 v5, 14336, v4
    global_load_dwordx4 v[8:11], v4, s[26:27] offset:0
    global_load_dwordx4 v[12:15], v5, s[26:27] offset:0
    global_load_dwordx4 v[16:19], v4, s[26:27] offset:1024
    global_load_dwordx4 v[20:23], v5, s[26:27] offset:1024
    global_load_dwordx4 v[24:27], v4, s[26:27] offset:2048
    global_load_dwordx4 v[28:31], v5, s[26:27] offset:2048
    global_load_dwordx4 v[32:35], v4, s[26:27] offset:3072
    global_load_dwordx4 v[36:39], v5, s[26:27] offset:3072
    s_mul_i32 s22, s20, 28
    s_mul_i32 s23, s18, 7
    s_add_u32 s22, s22, s23
    s_mul_i32 s22, s22, 14336
    s_add_u32 s22, s22, 0x2099000
    s_add_u32 s24, s16, s22
    s_addc_u32 s25, s17, 0
    s_add_u32 s40, s24, 0x0
    s_addc_u32 s41, s25, 0
    s_add_u32 s42, s24, 0x3800
    s_addc_u32 s43, s25, 0
    s_add_u32 s44, s24, 0x7000
    s_addc_u32 s45, s25, 0
    s_add_u32 s46, s24, 0xa800
    s_addc_u32 s47, s25, 0
    s_add_u32 s48, s24, 0xe000
    s_addc_u32 s49, s25, 0
    s_add_u32 s50, s24, 0x11800
    s_addc_u32 s51, s25, 0
    s_add_u32 s52, s24, 0x15000
    s_addc_u32 s53, s25, 0
    global_load_dwordx4 a[0:3], v4, s[40:41] offset:0
    global_load_dwordx4 a[56:59], v4, s[42:43] offset:0
    global_load_dwordx4 a[112:115], v4, s[44:45] offset:0
    global_load_dwordx4 a[168:171], v4, s[46:47] offset:0
    global_load_dwordx4 a[224:227], v4, s[48:49] offset:0
    global_load_dwordx4 v[144:147], v4, s[50:51] offset:0
    global_load_dwordx4 v[200:203], v4, s[52:53] offset:0
    global_load_dwordx4 a[4:7], v4, s[40:41] offset:1024
    global_load_dwordx4 a[60:63], v4, s[42:43] offset:1024
    global_load_dwordx4 a[116:119], v4, s[44:45] offset:1024
    global_load_dwordx4 a[172:175], v4, s[46:47] offset:1024
    global_load_dwordx4 a[228:231], v4, s[48:49] offset:1024
    global_load_dwordx4 v[148:151], v4, s[50:51] offset:1024
    global_load_dwordx4 v[204:207], v4, s[52:53] offset:1024
    global_load_dwordx4 a[8:11], v4, s[40:41] offset:2048
    global_load_dwordx4 a[64:67], v4, s[42:43] offset:2048
    global_load_dwordx4 a[120:123], v4, s[44:45] offset:2048
    global_load_dwordx4 a[176:179], v4, s[46:47] offset:2048
    global_load_dwordx4 a[232:235], v4, s[48:49] offset:2048
    global_load_dwordx4 v[152:155], v4, s[50:51] offset:2048
    global_load_dwordx4 v[208:211], v4, s[52:53] offset:2048
    global_load_dwordx4 a[12:15], v4, s[40:41] offset:3072
    global_load_dwordx4 a[68:71], v4, s[42:43] offset:3072
    global_load_dwordx4 a[124:127], v4, s[44:45] offset:3072
    global_load_dwordx4 a[180:183], v4, s[46:47] offset:3072
    global_load_dwordx4 a[236:239], v4, s[48:49] offset:3072
    global_load_dwordx4 v[156:159], v4, s[50:51] offset:3072
    global_load_dwordx4 v[212:215], v4, s[52:53] offset:3072
    s_add_u32 s40, s40, 4096
    s_addc_u32 s41, s41, 0
    global_load_dwordx4 a[16:19], v4, s[40:41] offset:0
    s_add_u32 s42, s42, 4096
    s_addc_u32 s43, s43, 0
    global_load_dwordx4 a[72:75], v4, s[42:43] offset:0
    s_add_u32 s44, s44, 4096
    s_addc_u32 s45, s45, 0
    global_load_dwordx4 a[128:131], v4, s[44:45] offset:0
    s_add_u32 s46, s46, 4096
    s_addc_u32 s47, s47, 0
    global_load_dwordx4 a[184:187], v4, s[46:47] offset:0
    s_add_u32 s48, s48, 4096
    s_addc_u32 s49, s49, 0
    global_load_dwordx4 a[240:243], v4, s[48:49] offset:0
    s_add_u32 s50, s50, 4096
    s_addc_u32 s51, s51, 0
    global_load_dwordx4 v[160:163], v4, s[50:51] offset:0
    s_add_u32 s52, s52, 4096
    s_addc_u32 s53, s53, 0
    global_load_dwordx4 v[216:219], v4, s[52:53] offset:0
    global_load_dwordx4 a[20:23], v4, s[40:41] offset:1024
    global_load_dwordx4 a[76:79], v4, s[42:43] offset:1024
    global_load_dwordx4 a[132:135], v4, s[44:45] offset:1024
    global_load_dwordx4 a[188:191], v4, s[46:47] offset:1024
    global_load_dwordx4 a[244:247], v4, s[48:49] offset:1024
    global_load_dwordx4 v[164:167], v4, s[50:51] offset:1024
    global_load_dwordx4 v[220:223], v4, s[52:53] offset:1024
    global_load_dwordx4 a[24:27], v4, s[40:41] offset:2048
    global_load_dwordx4 a[80:83], v4, s[42:43] offset:2048
    global_load_dwordx4 a[136:139], v4, s[44:45] offset:2048
    global_load_dwordx4 a[192:195], v4, s[46:47] offset:2048
    global_load_dwordx4 a[248:251], v4, s[48:49] offset:2048
    global_load_dwordx4 v[168:171], v4, s[50:51] offset:2048
    global_load_dwordx4 v[224:227], v4, s[52:53] offset:2048
    global_load_dwordx4 a[28:31], v4, s[40:41] offset:3072
    global_load_dwordx4 a[84:87], v4, s[42:43] offset:3072
    global_load_dwordx4 a[140:143], v4, s[44:45] offset:3072
    global_load_dwordx4 a[196:199], v4, s[46:47] offset:3072
    global_load_dwordx4 a[252:255], v4, s[48:49] offset:3072
    global_load_dwordx4 v[172:175], v4, s[50:51] offset:3072
    global_load_dwordx4 v[228:231], v4, s[52:53] offset:3072
    s_add_u32 s40, s40, 4096
    s_addc_u32 s41, s41, 0
    global_load_dwordx4 a[32:35], v4, s[40:41] offset:0
    s_add_u32 s42, s42, 4096
    s_addc_u32 s43, s43, 0
    global_load_dwordx4 a[88:91], v4, s[42:43] offset:0
    s_add_u32 s44, s44, 4096
    s_addc_u32 s45, s45, 0
    global_load_dwordx4 a[144:147], v4, s[44:45] offset:0
    s_add_u32 s46, s46, 4096
    s_addc_u32 s47, s47, 0
    global_load_dwordx4 a[200:203], v4, s[46:47] offset:0
    s_add_u32 s48, s48, 4096
    s_addc_u32 s49, s49, 0
    global_load_dwordx4 v[120:123], v4, s[48:49] offset:0
    s_add_u32 s50, s50, 4096
    s_addc_u32 s51, s51, 0
    global_load_dwordx4 v[176:179], v4, s[50:51] offset:0
    s_add_u32 s52, s52, 4096
    s_addc_u32 s53, s53, 0
    global_load_dwordx4 v[232:235], v4, s[52:53] offset:0
    global_load_dwordx4 a[36:39], v4, s[40:41] offset:1024
    global_load_dwordx4 a[92:95], v4, s[42:43] offset:1024
    global_load_dwordx4 a[148:151], v4, s[44:45] offset:1024
    global_load_dwordx4 a[204:207], v4, s[46:47] offset:1024
    global_load_dwordx4 v[124:127], v4, s[48:49] offset:1024
    global_load_dwordx4 v[180:183], v4, s[50:51] offset:1024
    global_load_dwordx4 v[236:239], v4, s[52:53] offset:1024
    global_load_dwordx4 a[40:43], v4, s[40:41] offset:2048
    global_load_dwordx4 a[96:99], v4, s[42:43] offset:2048
    global_load_dwordx4 a[152:155], v4, s[44:45] offset:2048
    global_load_dwordx4 a[208:211], v4, s[46:47] offset:2048
    global_load_dwordx4 v[128:131], v4, s[48:49] offset:2048
    global_load_dwordx4 v[184:187], v4, s[50:51] offset:2048
    global_load_dwordx4 v[240:243], v4, s[52:53] offset:2048
    global_load_dwordx4 a[44:47], v4, s[40:41] offset:3072
    global_load_dwordx4 a[100:103], v4, s[42:43] offset:3072
    global_load_dwordx4 a[156:159], v4, s[44:45] offset:3072
    global_load_dwordx4 a[212:215], v4, s[46:47] offset:3072
    global_load_dwordx4 v[132:135], v4, s[48:49] offset:3072
    global_load_dwordx4 v[188:191], v4, s[50:51] offset:3072
    global_load_dwordx4 v[244:247], v4, s[52:53] offset:3072
    s_add_u32 s40, s40, 4096
    s_addc_u32 s41, s41, 0
    global_load_dwordx4 a[48:51], v4, s[40:41] offset:0
    s_add_u32 s42, s42, 4096
    s_addc_u32 s43, s43, 0
    global_load_dwordx4 a[104:107], v4, s[42:43] offset:0
    s_add_u32 s44, s44, 4096
    s_addc_u32 s45, s45, 0
    global_load_dwordx4 a[160:163], v4, s[44:45] offset:0
    s_add_u32 s46, s46, 4096
    s_addc_u32 s47, s47, 0
    global_load_dwordx4 a[216:219], v4, s[46:47] offset:0
    s_add_u32 s48, s48, 4096
    s_addc_u32 s49, s49, 0
    global_load_dwordx4 v[136:139], v4, s[48:49] offset:0
    s_add_u32 s50, s50, 4096
    s_addc_u32 s51, s51, 0
    global_load_dwordx4 v[192:195], v4, s[50:51] offset:0
    s_add_u32 s52, s52, 4096
    s_addc_u32 s53, s53, 0
    global_load_dwordx4 v[248:251], v4, s[52:53] offset:0
    global_load_dwordx4 a[52:55], v4, s[40:41] offset:1024
    global_load_dwordx4 a[108:111], v4, s[42:43] offset:1024
    global_load_dwordx4 a[164:167], v4, s[44:45] offset:1024
    global_load_dwordx4 a[220:223], v4, s[46:47] offset:1024
    global_load_dwordx4 v[140:143], v4, s[48:49] offset:1024
    global_load_dwordx4 v[196:199], v4, s[50:51] offset:1024
    global_load_dwordx4 v[252:255], v4, s[52:53] offset:1024
    s_lshl_b32 s22, s21, 6
    s_add_u32 s22, s22, s20
    s_mul_i32 s22, s22, 28
    s_add_u32 s22, s22, s23
    s_lshl_b32 s22, s22, 10
    s_add_u32 s22, s22, 0x26b9000
    s_add_u32 s28, s16, s22
    s_addc_u32 s29, s17, 0
    s_add_u32 s26, s26, 4096
    s_addc_u32 s27, s27, 0
    global_load_dwordx4 v[40:43], v4, s[26:27] offset:0
    global_load_dwordx4 v[44:47], v5, s[26:27] offset:0
    s_waitcnt vmcnt(63)
    v_mfma_f32_16x16x32_bf16 v[48:51], v[8:11], a[0:3], 0
    v_mfma_f32_16x16x32_bf16 v[52:55], v[12:15], a[0:3], 0
    v_mfma_f32_16x16x32_bf16 v[56:59], v[8:11], a[56:59], 0
    v_mfma_f32_16x16x32_bf16 v[60:63], v[12:15], a[56:59], 0
    v_mfma_f32_16x16x32_bf16 v[64:67], v[8:11], a[112:115], 0
    v_mfma_f32_16x16x32_bf16 v[68:71], v[12:15], a[112:115], 0
    v_mfma_f32_16x16x32_bf16 v[72:75], v[8:11], a[168:171], 0
    v_mfma_f32_16x16x32_bf16 v[76:79], v[12:15], a[168:171], 0
    v_mfma_f32_16x16x32_bf16 v[80:83], v[8:11], a[224:227], 0
    v_mfma_f32_16x16x32_bf16 v[84:87], v[12:15], a[224:227], 0
    v_mfma_f32_16x16x32_bf16 v[88:91], v[8:11], v[144:147], 0
    v_mfma_f32_16x16x32_bf16 v[92:95], v[12:15], v[144:147], 0
    v_mfma_f32_16x16x32_bf16 v[96:99], v[8:11], v[200:203], 0
    v_mfma_f32_16x16x32_bf16 v[100:103], v[12:15], v[200:203], 0
    global_load_dwordx4 v[8:11], v4, s[26:27] offset:1024
    global_load_dwordx4 v[12:15], v5, s[26:27] offset:1024
    s_waitcnt vmcnt(63)
    v_mfma_f32_16x16x32_bf16 v[48:51], v[16:19], a[4:7], v[48:51]
    v_mfma_f32_16x16x32_bf16 v[52:55], v[20:23], a[4:7], v[52:55]
    v_mfma_f32_16x16x32_bf16 v[56:59], v[16:19], a[60:63], v[56:59]
    v_mfma_f32_16x16x32_bf16 v[60:63], v[20:23], a[60:63], v[60:63]
    v_mfma_f32_16x16x32_bf16 v[64:67], v[16:19], a[116:119], v[64:67]
    v_mfma_f32_16x16x32_bf16 v[68:71], v[20:23], a[116:119], v[68:71]
    v_mfma_f32_16x16x32_bf16 v[72:75], v[16:19], a[172:175], v[72:75]
    v_mfma_f32_16x16x32_bf16 v[76:79], v[20:23], a[172:175], v[76:79]
    v_mfma_f32_16x16x32_bf16 v[80:83], v[16:19], a[228:231], v[80:83]
    v_mfma_f32_16x16x32_bf16 v[84:87], v[20:23], a[228:231], v[84:87]
    v_mfma_f32_16x16x32_bf16 v[88:91], v[16:19], v[148:151], v[88:91]
    v_mfma_f32_16x16x32_bf16 v[92:95], v[20:23], v[148:151], v[92:95]
    v_mfma_f32_16x16x32_bf16 v[96:99], v[16:19], v[204:207], v[96:99]
    v_mfma_f32_16x16x32_bf16 v[100:103], v[20:23], v[204:207], v[100:103]
    global_load_dwordx4 v[16:19], v4, s[26:27] offset:2048
    global_load_dwordx4 v[20:23], v5, s[26:27] offset:2048
    s_waitcnt vmcnt(63)
    v_mfma_f32_16x16x32_bf16 v[48:51], v[24:27], a[8:11], v[48:51]
    v_mfma_f32_16x16x32_bf16 v[52:55], v[28:31], a[8:11], v[52:55]
    v_mfma_f32_16x16x32_bf16 v[56:59], v[24:27], a[64:67], v[56:59]
    v_mfma_f32_16x16x32_bf16 v[60:63], v[28:31], a[64:67], v[60:63]
    v_mfma_f32_16x16x32_bf16 v[64:67], v[24:27], a[120:123], v[64:67]
    v_mfma_f32_16x16x32_bf16 v[68:71], v[28:31], a[120:123], v[68:71]
    v_mfma_f32_16x16x32_bf16 v[72:75], v[24:27], a[176:179], v[72:75]
    v_mfma_f32_16x16x32_bf16 v[76:79], v[28:31], a[176:179], v[76:79]
    v_mfma_f32_16x16x32_bf16 v[80:83], v[24:27], a[232:235], v[80:83]
    v_mfma_f32_16x16x32_bf16 v[84:87], v[28:31], a[232:235], v[84:87]
    v_mfma_f32_16x16x32_bf16 v[88:91], v[24:27], v[152:155], v[88:91]
    v_mfma_f32_16x16x32_bf16 v[92:95], v[28:31], v[152:155], v[92:95]
    v_mfma_f32_16x16x32_bf16 v[96:99], v[24:27], v[208:211], v[96:99]
    v_mfma_f32_16x16x32_bf16 v[100:103], v[28:31], v[208:211], v[100:103]
    global_load_dwordx4 v[24:27], v4, s[26:27] offset:3072
    global_load_dwordx4 v[28:31], v5, s[26:27] offset:3072
    s_waitcnt vmcnt(63)
    v_mfma_f32_16x16x32_bf16 v[48:51], v[32:35], a[12:15], v[48:51]
    v_mfma_f32_16x16x32_bf16 v[52:55], v[36:39], a[12:15], v[52:55]
    v_mfma_f32_16x16x32_bf16 v[56:59], v[32:35], a[68:71], v[56:59]
    v_mfma_f32_16x16x32_bf16 v[60:63], v[36:39], a[68:71], v[60:63]
    v_mfma_f32_16x16x32_bf16 v[64:67], v[32:35], a[124:127], v[64:67]
    v_mfma_f32_16x16x32_bf16 v[68:71], v[36:39], a[124:127], v[68:71]
    v_mfma_f32_16x16x32_bf16 v[72:75], v[32:35], a[180:183], v[72:75]
    v_mfma_f32_16x16x32_bf16 v[76:79], v[36:39], a[180:183], v[76:79]
    v_mfma_f32_16x16x32_bf16 v[80:83], v[32:35], a[236:239], v[80:83]
    v_mfma_f32_16x16x32_bf16 v[84:87], v[36:39], a[236:239], v[84:87]
    v_mfma_f32_16x16x32_bf16 v[88:91], v[32:35], v[156:159], v[88:91]
    v_mfma_f32_16x16x32_bf16 v[92:95], v[36:39], v[156:159], v[92:95]
    v_mfma_f32_16x16x32_bf16 v[96:99], v[32:35], v[212:215], v[96:99]
    v_mfma_f32_16x16x32_bf16 v[100:103], v[36:39], v[212:215], v[100:103]
    s_add_u32 s26, s26, 4096
    s_addc_u32 s27, s27, 0
    global_load_dwordx4 v[32:35], v4, s[26:27] offset:0
    global_load_dwordx4 v[36:39], v5, s[26:27] offset:0
    s_waitcnt vmcnt(8)
    v_mfma_f32_16x16x32_bf16 v[48:51], v[40:43], a[16:19], v[48:51]
    v_mfma_f32_16x16x32_bf16 v[52:55], v[44:47], a[16:19], v[52:55]
    v_mfma_f32_16x16x32_bf16 v[56:59], v[40:43], a[72:75], v[56:59]
    v_mfma_f32_16x16x32_bf16 v[60:63], v[44:47], a[72:75], v[60:63]
    v_mfma_f32_16x16x32_bf16 v[64:67], v[40:43], a[128:131], v[64:67]
    v_mfma_f32_16x16x32_bf16 v[68:71], v[44:47], a[128:131], v[68:71]
    v_mfma_f32_16x16x32_bf16 v[72:75], v[40:43], a[184:187], v[72:75]
    v_mfma_f32_16x16x32_bf16 v[76:79], v[44:47], a[184:187], v[76:79]
    v_mfma_f32_16x16x32_bf16 v[80:83], v[40:43], a[240:243], v[80:83]
    v_mfma_f32_16x16x32_bf16 v[84:87], v[44:47], a[240:243], v[84:87]
    v_mfma_f32_16x16x32_bf16 v[88:91], v[40:43], v[160:163], v[88:91]
    v_mfma_f32_16x16x32_bf16 v[92:95], v[44:47], v[160:163], v[92:95]
    v_mfma_f32_16x16x32_bf16 v[96:99], v[40:43], v[216:219], v[96:99]
    v_mfma_f32_16x16x32_bf16 v[100:103], v[44:47], v[216:219], v[100:103]
    global_load_dwordx4 v[40:43], v4, s[26:27] offset:1024
    global_load_dwordx4 v[44:47], v5, s[26:27] offset:1024
    s_waitcnt vmcnt(8)
    v_mfma_f32_16x16x32_bf16 v[48:51], v[8:11], a[20:23], v[48:51]
    v_mfma_f32_16x16x32_bf16 v[52:55], v[12:15], a[20:23], v[52:55]
    v_mfma_f32_16x16x32_bf16 v[56:59], v[8:11], a[76:79], v[56:59]
    v_mfma_f32_16x16x32_bf16 v[60:63], v[12:15], a[76:79], v[60:63]
    v_mfma_f32_16x16x32_bf16 v[64:67], v[8:11], a[132:135], v[64:67]
    v_mfma_f32_16x16x32_bf16 v[68:71], v[12:15], a[132:135], v[68:71]
    v_mfma_f32_16x16x32_bf16 v[72:75], v[8:11], a[188:191], v[72:75]
    v_mfma_f32_16x16x32_bf16 v[76:79], v[12:15], a[188:191], v[76:79]
    v_mfma_f32_16x16x32_bf16 v[80:83], v[8:11], a[244:247], v[80:83]
    v_mfma_f32_16x16x32_bf16 v[84:87], v[12:15], a[244:247], v[84:87]
    v_mfma_f32_16x16x32_bf16 v[88:91], v[8:11], v[164:167], v[88:91]
    v_mfma_f32_16x16x32_bf16 v[92:95], v[12:15], v[164:167], v[92:95]
    v_mfma_f32_16x16x32_bf16 v[96:99], v[8:11], v[220:223], v[96:99]
    v_mfma_f32_16x16x32_bf16 v[100:103], v[12:15], v[220:223], v[100:103]
    global_load_dwordx4 v[8:11], v4, s[26:27] offset:2048
    global_load_dwordx4 v[12:15], v5, s[26:27] offset:2048
    s_waitcnt vmcnt(8)
    v_mfma_f32_16x16x32_bf16 v[48:51], v[16:19], a[24:27], v[48:51]
    v_mfma_f32_16x16x32_bf16 v[52:55], v[20:23], a[24:27], v[52:55]
    v_mfma_f32_16x16x32_bf16 v[56:59], v[16:19], a[80:83], v[56:59]
    v_mfma_f32_16x16x32_bf16 v[60:63], v[20:23], a[80:83], v[60:63]
    v_mfma_f32_16x16x32_bf16 v[64:67], v[16:19], a[136:139], v[64:67]
    v_mfma_f32_16x16x32_bf16 v[68:71], v[20:23], a[136:139], v[68:71]
    v_mfma_f32_16x16x32_bf16 v[72:75], v[16:19], a[192:195], v[72:75]
    v_mfma_f32_16x16x32_bf16 v[76:79], v[20:23], a[192:195], v[76:79]
    v_mfma_f32_16x16x32_bf16 v[80:83], v[16:19], a[248:251], v[80:83]
    v_mfma_f32_16x16x32_bf16 v[84:87], v[20:23], a[248:251], v[84:87]
    v_mfma_f32_16x16x32_bf16 v[88:91], v[16:19], v[168:171], v[88:91]
    v_mfma_f32_16x16x32_bf16 v[92:95], v[20:23], v[168:171], v[92:95]
    v_mfma_f32_16x16x32_bf16 v[96:99], v[16:19], v[224:227], v[96:99]
    v_mfma_f32_16x16x32_bf16 v[100:103], v[20:23], v[224:227], v[100:103]
    global_load_dwordx4 v[16:19], v4, s[26:27] offset:3072
    global_load_dwordx4 v[20:23], v5, s[26:27] offset:3072
    s_waitcnt vmcnt(8)
    v_mfma_f32_16x16x32_bf16 v[48:51], v[24:27], a[28:31], v[48:51]
    v_mfma_f32_16x16x32_bf16 v[52:55], v[28:31], a[28:31], v[52:55]
    v_mfma_f32_16x16x32_bf16 v[56:59], v[24:27], a[84:87], v[56:59]
    v_mfma_f32_16x16x32_bf16 v[60:63], v[28:31], a[84:87], v[60:63]
    v_mfma_f32_16x16x32_bf16 v[64:67], v[24:27], a[140:143], v[64:67]
    v_mfma_f32_16x16x32_bf16 v[68:71], v[28:31], a[140:143], v[68:71]
    v_mfma_f32_16x16x32_bf16 v[72:75], v[24:27], a[196:199], v[72:75]
    v_mfma_f32_16x16x32_bf16 v[76:79], v[28:31], a[196:199], v[76:79]
    v_mfma_f32_16x16x32_bf16 v[80:83], v[24:27], a[252:255], v[80:83]
    v_mfma_f32_16x16x32_bf16 v[84:87], v[28:31], a[252:255], v[84:87]
    v_mfma_f32_16x16x32_bf16 v[88:91], v[24:27], v[172:175], v[88:91]
    v_mfma_f32_16x16x32_bf16 v[92:95], v[28:31], v[172:175], v[92:95]
    v_mfma_f32_16x16x32_bf16 v[96:99], v[24:27], v[228:231], v[96:99]
    v_mfma_f32_16x16x32_bf16 v[100:103], v[28:31], v[228:231], v[100:103]
    s_add_u32 s26, s26, 4096
    s_addc_u32 s27, s27, 0
    global_load_dwordx4 v[24:27], v4, s[26:27] offset:0
    global_load_dwordx4 v[28:31], v5, s[26:27] offset:0
    s_waitcnt vmcnt(8)
    v_mfma_f32_16x16x32_bf16 v[48:51], v[32:35], a[32:35], v[48:51]
    v_mfma_f32_16x16x32_bf16 v[52:55], v[36:39], a[32:35], v[52:55]
    v_mfma_f32_16x16x32_bf16 v[56:59], v[32:35], a[88:91], v[56:59]
    v_mfma_f32_16x16x32_bf16 v[60:63], v[36:39], a[88:91], v[60:63]
    v_mfma_f32_16x16x32_bf16 v[64:67], v[32:35], a[144:147], v[64:67]
    v_mfma_f32_16x16x32_bf16 v[68:71], v[36:39], a[144:147], v[68:71]
    v_mfma_f32_16x16x32_bf16 v[72:75], v[32:35], a[200:203], v[72:75]
    v_mfma_f32_16x16x32_bf16 v[76:79], v[36:39], a[200:203], v[76:79]
    v_mfma_f32_16x16x32_bf16 v[80:83], v[32:35], v[120:123], v[80:83]
    v_mfma_f32_16x16x32_bf16 v[84:87], v[36:39], v[120:123], v[84:87]
    v_mfma_f32_16x16x32_bf16 v[88:91], v[32:35], v[176:179], v[88:91]
    v_mfma_f32_16x16x32_bf16 v[92:95], v[36:39], v[176:179], v[92:95]
    v_mfma_f32_16x16x32_bf16 v[96:99], v[32:35], v[232:235], v[96:99]
    v_mfma_f32_16x16x32_bf16 v[100:103], v[36:39], v[232:235], v[100:103]
    global_load_dwordx4 v[32:35], v4, s[26:27] offset:1024
    global_load_dwordx4 v[36:39], v5, s[26:27] offset:1024
    s_waitcnt vmcnt(8)
    v_mfma_f32_16x16x32_bf16 v[48:51], v[40:43], a[36:39], v[48:51]
    v_mfma_f32_16x16x32_bf16 v[52:55], v[44:47], a[36:39], v[52:55]
    v_mfma_f32_16x16x32_bf16 v[56:59], v[40:43], a[92:95], v[56:59]
    v_mfma_f32_16x16x32_bf16 v[60:63], v[44:47], a[92:95], v[60:63]
    v_mfma_f32_16x16x32_bf16 v[64:67], v[40:43], a[148:151], v[64:67]
    v_mfma_f32_16x16x32_bf16 v[68:71], v[44:47], a[148:151], v[68:71]
    v_mfma_f32_16x16x32_bf16 v[72:75], v[40:43], a[204:207], v[72:75]
    v_mfma_f32_16x16x32_bf16 v[76:79], v[44:47], a[204:207], v[76:79]
    v_mfma_f32_16x16x32_bf16 v[80:83], v[40:43], v[124:127], v[80:83]
    v_mfma_f32_16x16x32_bf16 v[84:87], v[44:47], v[124:127], v[84:87]
    v_mfma_f32_16x16x32_bf16 v[88:91], v[40:43], v[180:183], v[88:91]
    v_mfma_f32_16x16x32_bf16 v[92:95], v[44:47], v[180:183], v[92:95]
    v_mfma_f32_16x16x32_bf16 v[96:99], v[40:43], v[236:239], v[96:99]
    v_mfma_f32_16x16x32_bf16 v[100:103], v[44:47], v[236:239], v[100:103]
    s_add_u32 s26, s26, 16384
    s_addc_u32 s27, s27, 0
    global_load_dwordx4 v[40:43], v4, s[26:27] offset:0
    global_load_dwordx4 v[44:47], v5, s[26:27] offset:0
    s_waitcnt vmcnt(8)
    v_mfma_f32_16x16x32_bf16 v[48:51], v[8:11], a[40:43], v[48:51]
    v_mfma_f32_16x16x32_bf16 v[52:55], v[12:15], a[40:43], v[52:55]
    v_mfma_f32_16x16x32_bf16 v[56:59], v[8:11], a[96:99], v[56:59]
    v_mfma_f32_16x16x32_bf16 v[60:63], v[12:15], a[96:99], v[60:63]
    v_mfma_f32_16x16x32_bf16 v[64:67], v[8:11], a[152:155], v[64:67]
    v_mfma_f32_16x16x32_bf16 v[68:71], v[12:15], a[152:155], v[68:71]
    v_mfma_f32_16x16x32_bf16 v[72:75], v[8:11], a[208:211], v[72:75]
    v_mfma_f32_16x16x32_bf16 v[76:79], v[12:15], a[208:211], v[76:79]
    v_mfma_f32_16x16x32_bf16 v[80:83], v[8:11], v[128:131], v[80:83]
    v_mfma_f32_16x16x32_bf16 v[84:87], v[12:15], v[128:131], v[84:87]
    v_mfma_f32_16x16x32_bf16 v[88:91], v[8:11], v[184:187], v[88:91]
    v_mfma_f32_16x16x32_bf16 v[92:95], v[12:15], v[184:187], v[92:95]
    v_mfma_f32_16x16x32_bf16 v[96:99], v[8:11], v[240:243], v[96:99]
    v_mfma_f32_16x16x32_bf16 v[100:103], v[12:15], v[240:243], v[100:103]
    global_load_dwordx4 v[8:11], v4, s[26:27] offset:1024
    global_load_dwordx4 v[12:15], v5, s[26:27] offset:1024
    s_waitcnt vmcnt(8)
    v_mfma_f32_16x16x32_bf16 v[48:51], v[16:19], a[44:47], v[48:51]
    v_mfma_f32_16x16x32_bf16 v[52:55], v[20:23], a[44:47], v[52:55]
    v_mfma_f32_16x16x32_bf16 v[56:59], v[16:19], a[100:103], v[56:59]
    v_mfma_f32_16x16x32_bf16 v[60:63], v[20:23], a[100:103], v[60:63]
    v_mfma_f32_16x16x32_bf16 v[64:67], v[16:19], a[156:159], v[64:67]
    v_mfma_f32_16x16x32_bf16 v[68:71], v[20:23], a[156:159], v[68:71]
    v_mfma_f32_16x16x32_bf16 v[72:75], v[16:19], a[212:215], v[72:75]
    v_mfma_f32_16x16x32_bf16 v[76:79], v[20:23], a[212:215], v[76:79]
    v_mfma_f32_16x16x32_bf16 v[80:83], v[16:19], v[132:135], v[80:83]
    v_mfma_f32_16x16x32_bf16 v[84:87], v[20:23], v[132:135], v[84:87]
    v_mfma_f32_16x16x32_bf16 v[88:91], v[16:19], v[188:191], v[88:91]
    v_mfma_f32_16x16x32_bf16 v[92:95], v[20:23], v[188:191], v[92:95]
    v_mfma_f32_16x16x32_bf16 v[96:99], v[16:19], v[244:247], v[96:99]
    v_mfma_f32_16x16x32_bf16 v[100:103], v[20:23], v[244:247], v[100:103]
    global_load_dwordx4 v[16:19], v4, s[26:27] offset:2048
    global_load_dwordx4 v[20:23], v5, s[26:27] offset:2048
    s_waitcnt vmcnt(8)
    v_mfma_f32_16x16x32_bf16 v[48:51], v[24:27], a[48:51], v[48:51]
    v_mfma_f32_16x16x32_bf16 v[52:55], v[28:31], a[48:51], v[52:55]
    v_mfma_f32_16x16x32_bf16 v[56:59], v[24:27], a[104:107], v[56:59]
    v_mfma_f32_16x16x32_bf16 v[60:63], v[28:31], a[104:107], v[60:63]
    v_mfma_f32_16x16x32_bf16 v[64:67], v[24:27], a[160:163], v[64:67]
    v_mfma_f32_16x16x32_bf16 v[68:71], v[28:31], a[160:163], v[68:71]
    v_mfma_f32_16x16x32_bf16 v[72:75], v[24:27], a[216:219], v[72:75]
    v_mfma_f32_16x16x32_bf16 v[76:79], v[28:31], a[216:219], v[76:79]
    v_mfma_f32_16x16x32_bf16 v[80:83], v[24:27], v[136:139], v[80:83]
    v_mfma_f32_16x16x32_bf16 v[84:87], v[28:31], v[136:139], v[84:87]
    v_mfma_f32_16x16x32_bf16 v[88:91], v[24:27], v[192:195], v[88:91]
    v_mfma_f32_16x16x32_bf16 v[92:95], v[28:31], v[192:195], v[92:95]
    v_mfma_f32_16x16x32_bf16 v[96:99], v[24:27], v[248:251], v[96:99]
    v_mfma_f32_16x16x32_bf16 v[100:103], v[28:31], v[248:251], v[100:103]
    global_load_dwordx4 v[24:27], v4, s[26:27] offset:3072
    global_load_dwordx4 v[28:31], v5, s[26:27] offset:3072
    s_waitcnt vmcnt(8)
    v_mfma_f32_16x16x32_bf16 v[48:51], v[32:35], a[52:55], v[48:51]
    v_mfma_f32_16x16x32_bf16 v[52:55], v[36:39], a[52:55], v[52:55]
    v_mfma_f32_16x16x32_bf16 v[56:59], v[32:35], a[108:111], v[56:59]
    v_mfma_f32_16x16x32_bf16 v[60:63], v[36:39], a[108:111], v[60:63]
    v_mfma_f32_16x16x32_bf16 v[64:67], v[32:35], a[164:167], v[64:67]
    v_mfma_f32_16x16x32_bf16 v[68:71], v[36:39], a[164:167], v[68:71]
    v_mfma_f32_16x16x32_bf16 v[72:75], v[32:35], a[220:223], v[72:75]
    v_mfma_f32_16x16x32_bf16 v[76:79], v[36:39], a[220:223], v[76:79]
    v_mfma_f32_16x16x32_bf16 v[80:83], v[32:35], v[140:143], v[80:83]
    v_mfma_f32_16x16x32_bf16 v[84:87], v[36:39], v[140:143], v[84:87]
    v_mfma_f32_16x16x32_bf16 v[88:91], v[32:35], v[196:199], v[88:91]
    v_mfma_f32_16x16x32_bf16 v[92:95], v[36:39], v[196:199], v[92:95]
    v_mfma_f32_16x16x32_bf16 v[96:99], v[32:35], v[252:255], v[96:99]
    v_mfma_f32_16x16x32_bf16 v[100:103], v[36:39], v[252:255], v[100:103]
    s_nop 7
    s_add_u32 s38, s28, 0x1000
    s_addc_u32 s39, s29, 0
    v_cvt_pk_bf16_f32 v104, v48, v49
    v_cvt_pk_bf16_f32 v105, v50, v51
    v_cvt_pk_bf16_f32 v106, v52, v53
    v_cvt_pk_bf16_f32 v107, v54, v55
    global_store_dwordx4 v4, v[104:107], s[28:29] offset:0 sc1
    v_cvt_pk_bf16_f32 v108, v56, v57
    v_cvt_pk_bf16_f32 v109, v58, v59
    v_cvt_pk_bf16_f32 v110, v60, v61
    v_cvt_pk_bf16_f32 v111, v62, v63
    global_store_dwordx4 v4, v[108:111], s[28:29] offset:1024 sc1
    v_cvt_pk_bf16_f32 v112, v64, v65
    v_cvt_pk_bf16_f32 v113, v66, v67
    v_cvt_pk_bf16_f32 v114, v68, v69
    v_cvt_pk_bf16_f32 v115, v70, v71
    global_store_dwordx4 v4, v[112:115], s[28:29] offset:2048 sc1
    v_cvt_pk_bf16_f32 v116, v72, v73
    v_cvt_pk_bf16_f32 v117, v74, v75
    v_cvt_pk_bf16_f32 v118, v76, v77
    v_cvt_pk_bf16_f32 v119, v78, v79
    global_store_dwordx4 v4, v[116:119], s[28:29] offset:3072 sc1
    v_cvt_pk_bf16_f32 v104, v80, v81
    v_cvt_pk_bf16_f32 v105, v82, v83
    v_cvt_pk_bf16_f32 v106, v84, v85
    v_cvt_pk_bf16_f32 v107, v86, v87
    global_store_dwordx4 v4, v[104:107], s[38:39] offset:0 sc1
    v_cvt_pk_bf16_f32 v108, v88, v89
    v_cvt_pk_bf16_f32 v109, v90, v91
    v_cvt_pk_bf16_f32 v110, v92, v93
    v_cvt_pk_bf16_f32 v111, v94, v95
    global_store_dwordx4 v4, v[108:111], s[38:39] offset:1024 sc1
    v_cvt_pk_bf16_f32 v112, v96, v97
    v_cvt_pk_bf16_f32 v113, v98, v99
    v_cvt_pk_bf16_f32 v114, v100, v101
    v_cvt_pk_bf16_f32 v115, v102, v103
    global_store_dwordx4 v4, v[112:115], s[38:39] offset:2048 sc1
    s_add_u32 s28, s28, 458752
    s_addc_u32 s29, s29, 0
    s_nop 1
    s_add_u32 s26, s26, 4096
    s_addc_u32 s27, s27, 0
    global_load_dwordx4 v[32:35], v4, s[26:27] offset:0
    global_load_dwordx4 v[36:39], v5, s[26:27] offset:0
    s_waitcnt vmcnt(15)
    v_mfma_f32_16x16x32_bf16 v[48:51], v[40:43], a[0:3], 0
    v_mfma_f32_16x16x32_bf16 v[52:55], v[44:47], a[0:3], 0
    v_mfma_f32_16x16x32_bf16 v[56:59], v[40:43], a[56:59], 0
    v_mfma_f32_16x16x32_bf16 v[60:63], v[44:47], a[56:59], 0
    v_mfma_f32_16x16x32_bf16 v[64:67], v[40:43], a[112:115], 0
    v_mfma_f32_16x16x32_bf16 v[68:71], v[44:47], a[112:115], 0
    v_mfma_f32_16x16x32_bf16 v[72:75], v[40:43], a[168:171], 0
    v_mfma_f32_16x16x32_bf16 v[76:79], v[44:47], a[168:171], 0
    v_mfma_f32_16x16x32_bf16 v[80:83], v[40:43], a[224:227], 0
    v_mfma_f32_16x16x32_bf16 v[84:87], v[44:47], a[224:227], 0
    v_mfma_f32_16x16x32_bf16 v[88:91], v[40:43], v[144:147], 0
    v_mfma_f32_16x16x32_bf16 v[92:95], v[44:47], v[144:147], 0
    v_mfma_f32_16x16x32_bf16 v[96:99], v[40:43], v[200:203], 0
    v_mfma_f32_16x16x32_bf16 v[100:103], v[44:47], v[200:203], 0
    global_load_dwordx4 v[40:43], v4, s[26:27] offset:1024
    global_load_dwordx4 v[44:47], v5, s[26:27] offset:1024
    s_waitcnt vmcnt(15)
    v_mfma_f32_16x16x32_bf16 v[48:51], v[8:11], a[4:7], v[48:51]
    v_mfma_f32_16x16x32_bf16 v[52:55], v[12:15], a[4:7], v[52:55]
    v_mfma_f32_16x16x32_bf16 v[56:59], v[8:11], a[60:63], v[56:59]
    v_mfma_f32_16x16x32_bf16 v[60:63], v[12:15], a[60:63], v[60:63]
    v_mfma_f32_16x16x32_bf16 v[64:67], v[8:11], a[116:119], v[64:67]
    v_mfma_f32_16x16x32_bf16 v[68:71], v[12:15], a[116:119], v[68:71]
    v_mfma_f32_16x16x32_bf16 v[72:75], v[8:11], a[172:175], v[72:75]
    v_mfma_f32_16x16x32_bf16 v[76:79], v[12:15], a[172:175], v[76:79]
    v_mfma_f32_16x16x32_bf16 v[80:83], v[8:11], a[228:231], v[80:83]
    v_mfma_f32_16x16x32_bf16 v[84:87], v[12:15], a[228:231], v[84:87]
    v_mfma_f32_16x16x32_bf16 v[88:91], v[8:11], v[148:151], v[88:91]
    v_mfma_f32_16x16x32_bf16 v[92:95], v[12:15], v[148:151], v[92:95]
    v_mfma_f32_16x16x32_bf16 v[96:99], v[8:11], v[204:207], v[96:99]
    v_mfma_f32_16x16x32_bf16 v[100:103], v[12:15], v[204:207], v[100:103]
    global_load_dwordx4 v[8:11], v4, s[26:27] offset:2048
    global_load_dwordx4 v[12:15], v5, s[26:27] offset:2048
    s_waitcnt vmcnt(15)
    v_mfma_f32_16x16x32_bf16 v[48:51], v[16:19], a[8:11], v[48:51]
    v_mfma_f32_16x16x32_bf16 v[52:55], v[20:23], a[8:11], v[52:55]
    v_mfma_f32_16x16x32_bf16 v[56:59], v[16:19], a[64:67], v[56:59]
    v_mfma_f32_16x16x32_bf16 v[60:63], v[20:23], a[64:67], v[60:63]
    v_mfma_f32_16x16x32_bf16 v[64:67], v[16:19], a[120:123], v[64:67]
    v_mfma_f32_16x16x32_bf16 v[68:71], v[20:23], a[120:123], v[68:71]
    v_mfma_f32_16x16x32_bf16 v[72:75], v[16:19], a[176:179], v[72:75]
    v_mfma_f32_16x16x32_bf16 v[76:79], v[20:23], a[176:179], v[76:79]
    v_mfma_f32_16x16x32_bf16 v[80:83], v[16:19], a[232:235], v[80:83]
    v_mfma_f32_16x16x32_bf16 v[84:87], v[20:23], a[232:235], v[84:87]
    v_mfma_f32_16x16x32_bf16 v[88:91], v[16:19], v[152:155], v[88:91]
    v_mfma_f32_16x16x32_bf16 v[92:95], v[20:23], v[152:155], v[92:95]
    v_mfma_f32_16x16x32_bf16 v[96:99], v[16:19], v[208:211], v[96:99]
    v_mfma_f32_16x16x32_bf16 v[100:103], v[20:23], v[208:211], v[100:103]
    global_load_dwordx4 v[16:19], v4, s[26:27] offset:3072
    global_load_dwordx4 v[20:23], v5, s[26:27] offset:3072
    s_waitcnt vmcnt(15)
    v_mfma_f32_16x16x32_bf16 v[48:51], v[24:27], a[12:15], v[48:51]
    v_mfma_f32_16x16x32_bf16 v[52:55], v[28:31], a[12:15], v[52:55]
    v_mfma_f32_16x16x32_bf16 v[56:59], v[24:27], a[68:71], v[56:59]
    v_mfma_f32_16x16x32_bf16 v[60:63], v[28:31], a[68:71], v[60:63]
    v_mfma_f32_16x16x32_bf16 v[64:67], v[24:27], a[124:127], v[64:67]
    v_mfma_f32_16x16x32_bf16 v[68:71], v[28:31], a[124:127], v[68:71]
    v_mfma_f32_16x16x32_bf16 v[72:75], v[24:27], a[180:183], v[72:75]
    v_mfma_f32_16x16x32_bf16 v[76:79], v[28:31], a[180:183], v[76:79]
    v_mfma_f32_16x16x32_bf16 v[80:83], v[24:27], a[236:239], v[80:83]
    v_mfma_f32_16x16x32_bf16 v[84:87], v[28:31], a[236:239], v[84:87]
    v_mfma_f32_16x16x32_bf16 v[88:91], v[24:27], v[156:159], v[88:91]
    v_mfma_f32_16x16x32_bf16 v[92:95], v[28:31], v[156:159], v[92:95]
    v_mfma_f32_16x16x32_bf16 v[96:99], v[24:27], v[212:215], v[96:99]
    v_mfma_f32_16x16x32_bf16 v[100:103], v[28:31], v[212:215], v[100:103]
    s_add_u32 s26, s26, 4096
    s_addc_u32 s27, s27, 0
    global_load_dwordx4 v[24:27], v4, s[26:27] offset:0
    global_load_dwordx4 v[28:31], v5, s[26:27] offset:0
    s_waitcnt vmcnt(8)
    v_mfma_f32_16x16x32_bf16 v[48:51], v[32:35], a[16:19], v[48:51]
    v_mfma_f32_16x16x32_bf16 v[52:55], v[36:39], a[16:19], v[52:55]
    v_mfma_f32_16x16x32_bf16 v[56:59], v[32:35], a[72:75], v[56:59]
    v_mfma_f32_16x16x32_bf16 v[60:63], v[36:39], a[72:75], v[60:63]
    v_mfma_f32_16x16x32_bf16 v[64:67], v[32:35], a[128:131], v[64:67]
    v_mfma_f32_16x16x32_bf16 v[68:71], v[36:39], a[128:131], v[68:71]
    v_mfma_f32_16x16x32_bf16 v[72:75], v[32:35], a[184:187], v[72:75]
    v_mfma_f32_16x16x32_bf16 v[76:79], v[36:39], a[184:187], v[76:79]
    v_mfma_f32_16x16x32_bf16 v[80:83], v[32:35], a[240:243], v[80:83]
    v_mfma_f32_16x16x32_bf16 v[84:87], v[36:39], a[240:243], v[84:87]
    v_mfma_f32_16x16x32_bf16 v[88:91], v[32:35], v[160:163], v[88:91]
    v_mfma_f32_16x16x32_bf16 v[92:95], v[36:39], v[160:163], v[92:95]
    v_mfma_f32_16x16x32_bf16 v[96:99], v[32:35], v[216:219], v[96:99]
    v_mfma_f32_16x16x32_bf16 v[100:103], v[36:39], v[216:219], v[100:103]
    global_load_dwordx4 v[32:35], v4, s[26:27] offset:1024
    global_load_dwordx4 v[36:39], v5, s[26:27] offset:1024
    s_waitcnt vmcnt(8)
    v_mfma_f32_16x16x32_bf16 v[48:51], v[40:43], a[20:23], v[48:51]
    v_mfma_f32_16x16x32_bf16 v[52:55], v[44:47], a[20:23], v[52:55]
    v_mfma_f32_16x16x32_bf16 v[56:59], v[40:43], a[76:79], v[56:59]
    v_mfma_f32_16x16x32_bf16 v[60:63], v[44:47], a[76:79], v[60:63]
    v_mfma_f32_16x16x32_bf16 v[64:67], v[40:43], a[132:135], v[64:67]
    v_mfma_f32_16x16x32_bf16 v[68:71], v[44:47], a[132:135], v[68:71]
    v_mfma_f32_16x16x32_bf16 v[72:75], v[40:43], a[188:191], v[72:75]
    v_mfma_f32_16x16x32_bf16 v[76:79], v[44:47], a[188:191], v[76:79]
    v_mfma_f32_16x16x32_bf16 v[80:83], v[40:43], a[244:247], v[80:83]
    v_mfma_f32_16x16x32_bf16 v[84:87], v[44:47], a[244:247], v[84:87]
    v_mfma_f32_16x16x32_bf16 v[88:91], v[40:43], v[164:167], v[88:91]
    v_mfma_f32_16x16x32_bf16 v[92:95], v[44:47], v[164:167], v[92:95]
    v_mfma_f32_16x16x32_bf16 v[96:99], v[40:43], v[220:223], v[96:99]
    v_mfma_f32_16x16x32_bf16 v[100:103], v[44:47], v[220:223], v[100:103]
    global_load_dwordx4 v[40:43], v4, s[26:27] offset:2048
    global_load_dwordx4 v[44:47], v5, s[26:27] offset:2048
    s_waitcnt vmcnt(8)
    v_mfma_f32_16x16x32_bf16 v[48:51], v[8:11], a[24:27], v[48:51]
    v_mfma_f32_16x16x32_bf16 v[52:55], v[12:15], a[24:27], v[52:55]
    v_mfma_f32_16x16x32_bf16 v[56:59], v[8:11], a[80:83], v[56:59]
    v_mfma_f32_16x16x32_bf16 v[60:63], v[12:15], a[80:83], v[60:63]
    v_mfma_f32_16x16x32_bf16 v[64:67], v[8:11], a[136:139], v[64:67]
    v_mfma_f32_16x16x32_bf16 v[68:71], v[12:15], a[136:139], v[68:71]
    v_mfma_f32_16x16x32_bf16 v[72:75], v[8:11], a[192:195], v[72:75]
    v_mfma_f32_16x16x32_bf16 v[76:79], v[12:15], a[192:195], v[76:79]
    v_mfma_f32_16x16x32_bf16 v[80:83], v[8:11], a[248:251], v[80:83]
    v_mfma_f32_16x16x32_bf16 v[84:87], v[12:15], a[248:251], v[84:87]
    v_mfma_f32_16x16x32_bf16 v[88:91], v[8:11], v[168:171], v[88:91]
    v_mfma_f32_16x16x32_bf16 v[92:95], v[12:15], v[168:171], v[92:95]
    v_mfma_f32_16x16x32_bf16 v[96:99], v[8:11], v[224:227], v[96:99]
    v_mfma_f32_16x16x32_bf16 v[100:103], v[12:15], v[224:227], v[100:103]
    global_load_dwordx4 v[8:11], v4, s[26:27] offset:3072
    global_load_dwordx4 v[12:15], v5, s[26:27] offset:3072
    s_waitcnt vmcnt(8)
    v_mfma_f32_16x16x32_bf16 v[48:51], v[16:19], a[28:31], v[48:51]
    v_mfma_f32_16x16x32_bf16 v[52:55], v[20:23], a[28:31], v[52:55]
    v_mfma_f32_16x16x32_bf16 v[56:59], v[16:19], a[84:87], v[56:59]
    v_mfma_f32_16x16x32_bf16 v[60:63], v[20:23], a[84:87], v[60:63]
    v_mfma_f32_16x16x32_bf16 v[64:67], v[16:19], a[140:143], v[64:67]
    v_mfma_f32_16x16x32_bf16 v[68:71], v[20:23], a[140:143], v[68:71]
    v_mfma_f32_16x16x32_bf16 v[72:75], v[16:19], a[196:199], v[72:75]
    v_mfma_f32_16x16x32_bf16 v[76:79], v[20:23], a[196:199], v[76:79]
    v_mfma_f32_16x16x32_bf16 v[80:83], v[16:19], a[252:255], v[80:83]
    v_mfma_f32_16x16x32_bf16 v[84:87], v[20:23], a[252:255], v[84:87]
    v_mfma_f32_16x16x32_bf16 v[88:91], v[16:19], v[172:175], v[88:91]
    v_mfma_f32_16x16x32_bf16 v[92:95], v[20:23], v[172:175], v[92:95]
    v_mfma_f32_16x16x32_bf16 v[96:99], v[16:19], v[228:231], v[96:99]
    v_mfma_f32_16x16x32_bf16 v[100:103], v[20:23], v[228:231], v[100:103]
    s_add_u32 s26, s26, 4096
    s_addc_u32 s27, s27, 0
    global_load_dwordx4 v[16:19], v4, s[26:27] offset:0
    global_load_dwordx4 v[20:23], v5, s[26:27] offset:0
    s_waitcnt vmcnt(8)
    v_mfma_f32_16x16x32_bf16 v[48:51], v[24:27], a[32:35], v[48:51]
    v_mfma_f32_16x16x32_bf16 v[52:55], v[28:31], a[32:35], v[52:55]
    v_mfma_f32_16x16x32_bf16 v[56:59], v[24:27], a[88:91], v[56:59]
    v_mfma_f32_16x16x32_bf16 v[60:63], v[28:31], a[88:91], v[60:63]
    v_mfma_f32_16x16x32_bf16 v[64:67], v[24:27], a[144:147], v[64:67]
    v_mfma_f32_16x16x32_bf16 v[68:71], v[28:31], a[144:147], v[68:71]
    v_mfma_f32_16x16x32_bf16 v[72:75], v[24:27], a[200:203], v[72:75]
    v_mfma_f32_16x16x32_bf16 v[76:79], v[28:31], a[200:203], v[76:79]
    v_mfma_f32_16x16x32_bf16 v[80:83], v[24:27], v[120:123], v[80:83]
    v_mfma_f32_16x16x32_bf16 v[84:87], v[28:31], v[120:123], v[84:87]
    v_mfma_f32_16x16x32_bf16 v[88:91], v[24:27], v[176:179], v[88:91]
    v_mfma_f32_16x16x32_bf16 v[92:95], v[28:31], v[176:179], v[92:95]
    v_mfma_f32_16x16x32_bf16 v[96:99], v[24:27], v[232:235], v[96:99]
    v_mfma_f32_16x16x32_bf16 v[100:103], v[28:31], v[232:235], v[100:103]
    global_load_dwordx4 v[24:27], v4, s[26:27] offset:1024
    global_load_dwordx4 v[28:31], v5, s[26:27] offset:1024
    s_waitcnt vmcnt(8)
    v_mfma_f32_16x16x32_bf16 v[48:51], v[32:35], a[36:39], v[48:51]
    v_mfma_f32_16x16x32_bf16 v[52:55], v[36:39], a[36:39], v[52:55]
    v_mfma_f32_16x16x32_bf16 v[56:59], v[32:35], a[92:95], v[56:59]
    v_mfma_f32_16x16x32_bf16 v[60:63], v[36:39], a[92:95], v[60:63]
    v_mfma_f32_16x16x32_bf16 v[64:67], v[32:35], a[148:151], v[64:67]
    v_mfma_f32_16x16x32_bf16 v[68:71], v[36:39], a[148:151], v[68:71]
    v_mfma_f32_16x16x32_bf16 v[72:75], v[32:35], a[204:207], v[72:75]
    v_mfma_f32_16x16x32_bf16 v[76:79], v[36:39], a[204:207], v[76:79]
    v_mfma_f32_16x16x32_bf16 v[80:83], v[32:35], v[124:127], v[80:83]
    v_mfma_f32_16x16x32_bf16 v[84:87], v[36:39], v[124:127], v[84:87]
    v_mfma_f32_16x16x32_bf16 v[88:91], v[32:35], v[180:183], v[88:91]
    v_mfma_f32_16x16x32_bf16 v[92:95], v[36:39], v[180:183], v[92:95]
    v_mfma_f32_16x16x32_bf16 v[96:99], v[32:35], v[236:239], v[96:99]
    v_mfma_f32_16x16x32_bf16 v[100:103], v[36:39], v[236:239], v[100:103]
    s_add_u32 s26, s26, 16384
    s_addc_u32 s27, s27, 0
    global_load_dwordx4 v[32:35], v4, s[26:27] offset:0
    global_load_dwordx4 v[36:39], v5, s[26:27] offset:0
    s_waitcnt vmcnt(8)
    v_mfma_f32_16x16x32_bf16 v[48:51], v[40:43], a[40:43], v[48:51]
    v_mfma_f32_16x16x32_bf16 v[52:55], v[44:47], a[40:43], v[52:55]
    v_mfma_f32_16x16x32_bf16 v[56:59], v[40:43], a[96:99], v[56:59]
    v_mfma_f32_16x16x32_bf16 v[60:63], v[44:47], a[96:99], v[60:63]
    v_mfma_f32_16x16x32_bf16 v[64:67], v[40:43], a[152:155], v[64:67]
    v_mfma_f32_16x16x32_bf16 v[68:71], v[44:47], a[152:155], v[68:71]
    v_mfma_f32_16x16x32_bf16 v[72:75], v[40:43], a[208:211], v[72:75]
    v_mfma_f32_16x16x32_bf16 v[76:79], v[44:47], a[208:211], v[76:79]
    v_mfma_f32_16x16x32_bf16 v[80:83], v[40:43], v[128:131], v[80:83]
    v_mfma_f32_16x16x32_bf16 v[84:87], v[44:47], v[128:131], v[84:87]
    v_mfma_f32_16x16x32_bf16 v[88:91], v[40:43], v[184:187], v[88:91]
    v_mfma_f32_16x16x32_bf16 v[92:95], v[44:47], v[184:187], v[92:95]
    v_mfma_f32_16x16x32_bf16 v[96:99], v[40:43], v[240:243], v[96:99]
    v_mfma_f32_16x16x32_bf16 v[100:103], v[44:47], v[240:243], v[100:103]
    global_load_dwordx4 v[40:43], v4, s[26:27] offset:1024
    global_load_dwordx4 v[44:47], v5, s[26:27] offset:1024
    s_waitcnt vmcnt(8)
    v_mfma_f32_16x16x32_bf16 v[48:51], v[8:11], a[44:47], v[48:51]
    v_mfma_f32_16x16x32_bf16 v[52:55], v[12:15], a[44:47], v[52:55]
    v_mfma_f32_16x16x32_bf16 v[56:59], v[8:11], a[100:103], v[56:59]
    v_mfma_f32_16x16x32_bf16 v[60:63], v[12:15], a[100:103], v[60:63]
    v_mfma_f32_16x16x32_bf16 v[64:67], v[8:11], a[156:159], v[64:67]
    v_mfma_f32_16x16x32_bf16 v[68:71], v[12:15], a[156:159], v[68:71]
    v_mfma_f32_16x16x32_bf16 v[72:75], v[8:11], a[212:215], v[72:75]
    v_mfma_f32_16x16x32_bf16 v[76:79], v[12:15], a[212:215], v[76:79]
    v_mfma_f32_16x16x32_bf16 v[80:83], v[8:11], v[132:135], v[80:83]
    v_mfma_f32_16x16x32_bf16 v[84:87], v[12:15], v[132:135], v[84:87]
    v_mfma_f32_16x16x32_bf16 v[88:91], v[8:11], v[188:191], v[88:91]
    v_mfma_f32_16x16x32_bf16 v[92:95], v[12:15], v[188:191], v[92:95]
    v_mfma_f32_16x16x32_bf16 v[96:99], v[8:11], v[244:247], v[96:99]
    v_mfma_f32_16x16x32_bf16 v[100:103], v[12:15], v[244:247], v[100:103]
    global_load_dwordx4 v[8:11], v4, s[26:27] offset:2048
    global_load_dwordx4 v[12:15], v5, s[26:27] offset:2048
    s_waitcnt vmcnt(8)
    v_mfma_f32_16x16x32_bf16 v[48:51], v[16:19], a[48:51], v[48:51]
    v_mfma_f32_16x16x32_bf16 v[52:55], v[20:23], a[48:51], v[52:55]
    v_mfma_f32_16x16x32_bf16 v[56:59], v[16:19], a[104:107], v[56:59]
    v_mfma_f32_16x16x32_bf16 v[60:63], v[20:23], a[104:107], v[60:63]
    v_mfma_f32_16x16x32_bf16 v[64:67], v[16:19], a[160:163], v[64:67]
    v_mfma_f32_16x16x32_bf16 v[68:71], v[20:23], a[160:163], v[68:71]
    v_mfma_f32_16x16x32_bf16 v[72:75], v[16:19], a[216:219], v[72:75]
    v_mfma_f32_16x16x32_bf16 v[76:79], v[20:23], a[216:219], v[76:79]
    v_mfma_f32_16x16x32_bf16 v[80:83], v[16:19], v[136:139], v[80:83]
    v_mfma_f32_16x16x32_bf16 v[84:87], v[20:23], v[136:139], v[84:87]
    v_mfma_f32_16x16x32_bf16 v[88:91], v[16:19], v[192:195], v[88:91]
    v_mfma_f32_16x16x32_bf16 v[92:95], v[20:23], v[192:195], v[92:95]
    v_mfma_f32_16x16x32_bf16 v[96:99], v[16:19], v[248:251], v[96:99]
    v_mfma_f32_16x16x32_bf16 v[100:103], v[20:23], v[248:251], v[100:103]
    global_load_dwordx4 v[16:19], v4, s[26:27] offset:3072
    global_load_dwordx4 v[20:23], v5, s[26:27] offset:3072
    s_waitcnt vmcnt(8)
    v_mfma_f32_16x16x32_bf16 v[48:51], v[24:27], a[52:55], v[48:51]
    v_mfma_f32_16x16x32_bf16 v[52:55], v[28:31], a[52:55], v[52:55]
    v_mfma_f32_16x16x32_bf16 v[56:59], v[24:27], a[108:111], v[56:59]
    v_mfma_f32_16x16x32_bf16 v[60:63], v[28:31], a[108:111], v[60:63]
    v_mfma_f32_16x16x32_bf16 v[64:67], v[24:27], a[164:167], v[64:67]
    v_mfma_f32_16x16x32_bf16 v[68:71], v[28:31], a[164:167], v[68:71]
    v_mfma_f32_16x16x32_bf16 v[72:75], v[24:27], a[220:223], v[72:75]
    v_mfma_f32_16x16x32_bf16 v[76:79], v[28:31], a[220:223], v[76:79]
    v_mfma_f32_16x16x32_bf16 v[80:83], v[24:27], v[140:143], v[80:83]
    v_mfma_f32_16x16x32_bf16 v[84:87], v[28:31], v[140:143], v[84:87]
    v_mfma_f32_16x16x32_bf16 v[88:91], v[24:27], v[196:199], v[88:91]
    v_mfma_f32_16x16x32_bf16 v[92:95], v[28:31], v[196:199], v[92:95]
    v_mfma_f32_16x16x32_bf16 v[96:99], v[24:27], v[252:255], v[96:99]
    v_mfma_f32_16x16x32_bf16 v[100:103], v[28:31], v[252:255], v[100:103]
    s_nop 7
    s_add_u32 s38, s28, 0x1000
    s_addc_u32 s39, s29, 0
    v_cvt_pk_bf16_f32 v104, v48, v49
    v_cvt_pk_bf16_f32 v105, v50, v51
    v_cvt_pk_bf16_f32 v106, v52, v53
    v_cvt_pk_bf16_f32 v107, v54, v55
    global_store_dwordx4 v4, v[104:107], s[28:29] offset:0 sc1
    v_cvt_pk_bf16_f32 v108, v56, v57
    v_cvt_pk_bf16_f32 v109, v58, v59
    v_cvt_pk_bf16_f32 v110, v60, v61
    v_cvt_pk_bf16_f32 v111, v62, v63
    global_store_dwordx4 v4, v[108:111], s[28:29] offset:1024 sc1
    v_cvt_pk_bf16_f32 v112, v64, v65
    v_cvt_pk_bf16_f32 v113, v66, v67
    v_cvt_pk_bf16_f32 v114, v68, v69
    v_cvt_pk_bf16_f32 v115, v70, v71
    global_store_dwordx4 v4, v[112:115], s[28:29] offset:2048 sc1
    v_cvt_pk_bf16_f32 v116, v72, v73
    v_cvt_pk_bf16_f32 v117, v74, v75
    v_cvt_pk_bf16_f32 v118, v76, v77
    v_cvt_pk_bf16_f32 v119, v78, v79
    global_store_dwordx4 v4, v[116:119], s[28:29] offset:3072 sc1
    v_cvt_pk_bf16_f32 v104, v80, v81
    v_cvt_pk_bf16_f32 v105, v82, v83
    v_cvt_pk_bf16_f32 v106, v84, v85
    v_cvt_pk_bf16_f32 v107, v86, v87
    global_store_dwordx4 v4, v[104:107], s[38:39] offset:0 sc1
    v_cvt_pk_bf16_f32 v108, v88, v89
    v_cvt_pk_bf16_f32 v109, v90, v91
    v_cvt_pk_bf16_f32 v110, v92, v93
    v_cvt_pk_bf16_f32 v111, v94, v95
    global_store_dwordx4 v4, v[108:111], s[38:39] offset:1024 sc1
    v_cvt_pk_bf16_f32 v112, v96, v97
    v_cvt_pk_bf16_f32 v113, v98, v99
    v_cvt_pk_bf16_f32 v114, v100, v101
    v_cvt_pk_bf16_f32 v115, v102, v103
    global_store_dwordx4 v4, v[112:115], s[38:39] offset:2048 sc1
    s_add_u32 s28, s28, 458752
    s_addc_u32 s29, s29, 0
    s_nop 1
    s_add_u32 s26, s26, 4096
    s_addc_u32 s27, s27, 0
    global_load_dwordx4 v[24:27], v4, s[26:27] offset:0
    global_load_dwordx4 v[28:31], v5, s[26:27] offset:0
    s_waitcnt vmcnt(15)
    v_mfma_f32_16x16x32_bf16 v[48:51], v[32:35], a[0:3], 0
    v_mfma_f32_16x16x32_bf16 v[52:55], v[36:39], a[0:3], 0
    v_mfma_f32_16x16x32_bf16 v[56:59], v[32:35], a[56:59], 0
    v_mfma_f32_16x16x32_bf16 v[60:63], v[36:39], a[56:59], 0
    v_mfma_f32_16x16x32_bf16 v[64:67], v[32:35], a[112:115], 0
    v_mfma_f32_16x16x32_bf16 v[68:71], v[36:39], a[112:115], 0
    v_mfma_f32_16x16x32_bf16 v[72:75], v[32:35], a[168:171], 0
    v_mfma_f32_16x16x32_bf16 v[76:79], v[36:39], a[168:171], 0
    v_mfma_f32_16x16x32_bf16 v[80:83], v[32:35], a[224:227], 0
    v_mfma_f32_16x16x32_bf16 v[84:87], v[36:39], a[224:227], 0
    v_mfma_f32_16x16x32_bf16 v[88:91], v[32:35], v[144:147], 0
    v_mfma_f32_16x16x32_bf16 v[92:95], v[36:39], v[144:147], 0
    v_mfma_f32_16x16x32_bf16 v[96:99], v[32:35], v[200:203], 0
    v_mfma_f32_16x16x32_bf16 v[100:103], v[36:39], v[200:203], 0
    global_load_dwordx4 v[32:35], v4, s[26:27] offset:1024
    global_load_dwordx4 v[36:39], v5, s[26:27] offset:1024
    s_waitcnt vmcnt(15)
    v_mfma_f32_16x16x32_bf16 v[48:51], v[40:43], a[4:7], v[48:51]
    v_mfma_f32_16x16x32_bf16 v[52:55], v[44:47], a[4:7], v[52:55]
    v_mfma_f32_16x16x32_bf16 v[56:59], v[40:43], a[60:63], v[56:59]
    v_mfma_f32_16x16x32_bf16 v[60:63], v[44:47], a[60:63], v[60:63]
    v_mfma_f32_16x16x32_bf16 v[64:67], v[40:43], a[116:119], v[64:67]
    v_mfma_f32_16x16x32_bf16 v[68:71], v[44:47], a[116:119], v[68:71]
    v_mfma_f32_16x16x32_bf16 v[72:75], v[40:43], a[172:175], v[72:75]
    v_mfma_f32_16x16x32_bf16 v[76:79], v[44:47], a[172:175], v[76:79]
    v_mfma_f32_16x16x32_bf16 v[80:83], v[40:43], a[228:231], v[80:83]
    v_mfma_f32_16x16x32_bf16 v[84:87], v[44:47], a[228:231], v[84:87]
    v_mfma_f32_16x16x32_bf16 v[88:91], v[40:43], v[148:151], v[88:91]
    v_mfma_f32_16x16x32_bf16 v[92:95], v[44:47], v[148:151], v[92:95]
    v_mfma_f32_16x16x32_bf16 v[96:99], v[40:43], v[204:207], v[96:99]
    v_mfma_f32_16x16x32_bf16 v[100:103], v[44:47], v[204:207], v[100:103]
    global_load_dwordx4 v[40:43], v4, s[26:27] offset:2048
    global_load_dwordx4 v[44:47], v5, s[26:27] offset:2048
    s_waitcnt vmcnt(15)
    v_mfma_f32_16x16x32_bf16 v[48:51], v[8:11], a[8:11], v[48:51]
    v_mfma_f32_16x16x32_bf16 v[52:55], v[12:15], a[8:11], v[52:55]
    v_mfma_f32_16x16x32_bf16 v[56:59], v[8:11], a[64:67], v[56:59]
    v_mfma_f32_16x16x32_bf16 v[60:63], v[12:15], a[64:67], v[60:63]
    v_mfma_f32_16x16x32_bf16 v[64:67], v[8:11], a[120:123], v[64:67]
    v_mfma_f32_16x16x32_bf16 v[68:71], v[12:15], a[120:123], v[68:71]
    v_mfma_f32_16x16x32_bf16 v[72:75], v[8:11], a[176:179], v[72:75]
    v_mfma_f32_16x16x32_bf16 v[76:79], v[12:15], a[176:179], v[76:79]
    v_mfma_f32_16x16x32_bf16 v[80:83], v[8:11], a[232:235], v[80:83]
    v_mfma_f32_16x16x32_bf16 v[84:87], v[12:15], a[232:235], v[84:87]
    v_mfma_f32_16x16x32_bf16 v[88:91], v[8:11], v[152:155], v[88:91]
    v_mfma_f32_16x16x32_bf16 v[92:95], v[12:15], v[152:155], v[92:95]
    v_mfma_f32_16x16x32_bf16 v[96:99], v[8:11], v[208:211], v[96:99]
    v_mfma_f32_16x16x32_bf16 v[100:103], v[12:15], v[208:211], v[100:103]
    global_load_dwordx4 v[8:11], v4, s[26:27] offset:3072
    global_load_dwordx4 v[12:15], v5, s[26:27] offset:3072
    s_waitcnt vmcnt(15)
    v_mfma_f32_16x16x32_bf16 v[48:51], v[16:19], a[12:15], v[48:51]
    v_mfma_f32_16x16x32_bf16 v[52:55], v[20:23], a[12:15], v[52:55]
    v_mfma_f32_16x16x32_bf16 v[56:59], v[16:19], a[68:71], v[56:59]
    v_mfma_f32_16x16x32_bf16 v[60:63], v[20:23], a[68:71], v[60:63]
    v_mfma_f32_16x16x32_bf16 v[64:67], v[16:19], a[124:127], v[64:67]
    v_mfma_f32_16x16x32_bf16 v[68:71], v[20:23], a[124:127], v[68:71]
    v_mfma_f32_16x16x32_bf16 v[72:75], v[16:19], a[180:183], v[72:75]
    v_mfma_f32_16x16x32_bf16 v[76:79], v[20:23], a[180:183], v[76:79]
    v_mfma_f32_16x16x32_bf16 v[80:83], v[16:19], a[236:239], v[80:83]
    v_mfma_f32_16x16x32_bf16 v[84:87], v[20:23], a[236:239], v[84:87]
    v_mfma_f32_16x16x32_bf16 v[88:91], v[16:19], v[156:159], v[88:91]
    v_mfma_f32_16x16x32_bf16 v[92:95], v[20:23], v[156:159], v[92:95]
    v_mfma_f32_16x16x32_bf16 v[96:99], v[16:19], v[212:215], v[96:99]
    v_mfma_f32_16x16x32_bf16 v[100:103], v[20:23], v[212:215], v[100:103]
    s_add_u32 s26, s26, 4096
    s_addc_u32 s27, s27, 0
    global_load_dwordx4 v[16:19], v4, s[26:27] offset:0
    global_load_dwordx4 v[20:23], v5, s[26:27] offset:0
    s_waitcnt vmcnt(8)
    v_mfma_f32_16x16x32_bf16 v[48:51], v[24:27], a[16:19], v[48:51]
    v_mfma_f32_16x16x32_bf16 v[52:55], v[28:31], a[16:19], v[52:55]
    v_mfma_f32_16x16x32_bf16 v[56:59], v[24:27], a[72:75], v[56:59]
    v_mfma_f32_16x16x32_bf16 v[60:63], v[28:31], a[72:75], v[60:63]
    v_mfma_f32_16x16x32_bf16 v[64:67], v[24:27], a[128:131], v[64:67]
    v_mfma_f32_16x16x32_bf16 v[68:71], v[28:31], a[128:131], v[68:71]
    v_mfma_f32_16x16x32_bf16 v[72:75], v[24:27], a[184:187], v[72:75]
    v_mfma_f32_16x16x32_bf16 v[76:79], v[28:31], a[184:187], v[76:79]
    v_mfma_f32_16x16x32_bf16 v[80:83], v[24:27], a[240:243], v[80:83]
    v_mfma_f32_16x16x32_bf16 v[84:87], v[28:31], a[240:243], v[84:87]
    v_mfma_f32_16x16x32_bf16 v[88:91], v[24:27], v[160:163], v[88:91]
    v_mfma_f32_16x16x32_bf16 v[92:95], v[28:31], v[160:163], v[92:95]
    v_mfma_f32_16x16x32_bf16 v[96:99], v[24:27], v[216:219], v[96:99]
    v_mfma_f32_16x16x32_bf16 v[100:103], v[28:31], v[216:219], v[100:103]
    global_load_dwordx4 v[24:27], v4, s[26:27] offset:1024
    global_load_dwordx4 v[28:31], v5, s[26:27] offset:1024
    s_waitcnt vmcnt(8)
    v_mfma_f32_16x16x32_bf16 v[48:51], v[32:35], a[20:23], v[48:51]
    v_mfma_f32_16x16x32_bf16 v[52:55], v[36:39], a[20:23], v[52:55]
    v_mfma_f32_16x16x32_bf16 v[56:59], v[32:35], a[76:79], v[56:59]
    v_mfma_f32_16x16x32_bf16 v[60:63], v[36:39], a[76:79], v[60:63]
    v_mfma_f32_16x16x32_bf16 v[64:67], v[32:35], a[132:135], v[64:67]
    v_mfma_f32_16x16x32_bf16 v[68:71], v[36:39], a[132:135], v[68:71]
    v_mfma_f32_16x16x32_bf16 v[72:75], v[32:35], a[188:191], v[72:75]
    v_mfma_f32_16x16x32_bf16 v[76:79], v[36:39], a[188:191], v[76:79]
    v_mfma_f32_16x16x32_bf16 v[80:83], v[32:35], a[244:247], v[80:83]
    v_mfma_f32_16x16x32_bf16 v[84:87], v[36:39], a[244:247], v[84:87]
    v_mfma_f32_16x16x32_bf16 v[88:91], v[32:35], v[164:167], v[88:91]
    v_mfma_f32_16x16x32_bf16 v[92:95], v[36:39], v[164:167], v[92:95]
    v_mfma_f32_16x16x32_bf16 v[96:99], v[32:35], v[220:223], v[96:99]
    v_mfma_f32_16x16x32_bf16 v[100:103], v[36:39], v[220:223], v[100:103]
    global_load_dwordx4 v[32:35], v4, s[26:27] offset:2048
    global_load_dwordx4 v[36:39], v5, s[26:27] offset:2048
    s_waitcnt vmcnt(8)
    v_mfma_f32_16x16x32_bf16 v[48:51], v[40:43], a[24:27], v[48:51]
    v_mfma_f32_16x16x32_bf16 v[52:55], v[44:47], a[24:27], v[52:55]
    v_mfma_f32_16x16x32_bf16 v[56:59], v[40:43], a[80:83], v[56:59]
    v_mfma_f32_16x16x32_bf16 v[60:63], v[44:47], a[80:83], v[60:63]
    v_mfma_f32_16x16x32_bf16 v[64:67], v[40:43], a[136:139], v[64:67]
    v_mfma_f32_16x16x32_bf16 v[68:71], v[44:47], a[136:139], v[68:71]
    v_mfma_f32_16x16x32_bf16 v[72:75], v[40:43], a[192:195], v[72:75]
    v_mfma_f32_16x16x32_bf16 v[76:79], v[44:47], a[192:195], v[76:79]
    v_mfma_f32_16x16x32_bf16 v[80:83], v[40:43], a[248:251], v[80:83]
    v_mfma_f32_16x16x32_bf16 v[84:87], v[44:47], a[248:251], v[84:87]
    v_mfma_f32_16x16x32_bf16 v[88:91], v[40:43], v[168:171], v[88:91]
    v_mfma_f32_16x16x32_bf16 v[92:95], v[44:47], v[168:171], v[92:95]
    v_mfma_f32_16x16x32_bf16 v[96:99], v[40:43], v[224:227], v[96:99]
    v_mfma_f32_16x16x32_bf16 v[100:103], v[44:47], v[224:227], v[100:103]
    global_load_dwordx4 v[40:43], v4, s[26:27] offset:3072
    global_load_dwordx4 v[44:47], v5, s[26:27] offset:3072
    s_waitcnt vmcnt(8)
    v_mfma_f32_16x16x32_bf16 v[48:51], v[8:11], a[28:31], v[48:51]
    v_mfma_f32_16x16x32_bf16 v[52:55], v[12:15], a[28:31], v[52:55]
    v_mfma_f32_16x16x32_bf16 v[56:59], v[8:11], a[84:87], v[56:59]
    v_mfma_f32_16x16x32_bf16 v[60:63], v[12:15], a[84:87], v[60:63]
    v_mfma_f32_16x16x32_bf16 v[64:67], v[8:11], a[140:143], v[64:67]
    v_mfma_f32_16x16x32_bf16 v[68:71], v[12:15], a[140:143], v[68:71]
    v_mfma_f32_16x16x32_bf16 v[72:75], v[8:11], a[196:199], v[72:75]
    v_mfma_f32_16x16x32_bf16 v[76:79], v[12:15], a[196:199], v[76:79]
    v_mfma_f32_16x16x32_bf16 v[80:83], v[8:11], a[252:255], v[80:83]
    v_mfma_f32_16x16x32_bf16 v[84:87], v[12:15], a[252:255], v[84:87]
    v_mfma_f32_16x16x32_bf16 v[88:91], v[8:11], v[172:175], v[88:91]
    v_mfma_f32_16x16x32_bf16 v[92:95], v[12:15], v[172:175], v[92:95]
    v_mfma_f32_16x16x32_bf16 v[96:99], v[8:11], v[228:231], v[96:99]
    v_mfma_f32_16x16x32_bf16 v[100:103], v[12:15], v[228:231], v[100:103]
    s_add_u32 s26, s26, 4096
    s_addc_u32 s27, s27, 0
    global_load_dwordx4 v[8:11], v4, s[26:27] offset:0
    global_load_dwordx4 v[12:15], v5, s[26:27] offset:0
    s_waitcnt vmcnt(8)
    v_mfma_f32_16x16x32_bf16 v[48:51], v[16:19], a[32:35], v[48:51]
    v_mfma_f32_16x16x32_bf16 v[52:55], v[20:23], a[32:35], v[52:55]
    v_mfma_f32_16x16x32_bf16 v[56:59], v[16:19], a[88:91], v[56:59]
    v_mfma_f32_16x16x32_bf16 v[60:63], v[20:23], a[88:91], v[60:63]
    v_mfma_f32_16x16x32_bf16 v[64:67], v[16:19], a[144:147], v[64:67]
    v_mfma_f32_16x16x32_bf16 v[68:71], v[20:23], a[144:147], v[68:71]
    v_mfma_f32_16x16x32_bf16 v[72:75], v[16:19], a[200:203], v[72:75]
    v_mfma_f32_16x16x32_bf16 v[76:79], v[20:23], a[200:203], v[76:79]
    v_mfma_f32_16x16x32_bf16 v[80:83], v[16:19], v[120:123], v[80:83]
    v_mfma_f32_16x16x32_bf16 v[84:87], v[20:23], v[120:123], v[84:87]
    v_mfma_f32_16x16x32_bf16 v[88:91], v[16:19], v[176:179], v[88:91]
    v_mfma_f32_16x16x32_bf16 v[92:95], v[20:23], v[176:179], v[92:95]
    v_mfma_f32_16x16x32_bf16 v[96:99], v[16:19], v[232:235], v[96:99]
    v_mfma_f32_16x16x32_bf16 v[100:103], v[20:23], v[232:235], v[100:103]
    global_load_dwordx4 v[16:19], v4, s[26:27] offset:1024
    global_load_dwordx4 v[20:23], v5, s[26:27] offset:1024
    s_waitcnt vmcnt(8)
    v_mfma_f32_16x16x32_bf16 v[48:51], v[24:27], a[36:39], v[48:51]
    v_mfma_f32_16x16x32_bf16 v[52:55], v[28:31], a[36:39], v[52:55]
    v_mfma_f32_16x16x32_bf16 v[56:59], v[24:27], a[92:95], v[56:59]
    v_mfma_f32_16x16x32_bf16 v[60:63], v[28:31], a[92:95], v[60:63]
    v_mfma_f32_16x16x32_bf16 v[64:67], v[24:27], a[148:151], v[64:67]
    v_mfma_f32_16x16x32_bf16 v[68:71], v[28:31], a[148:151], v[68:71]
    v_mfma_f32_16x16x32_bf16 v[72:75], v[24:27], a[204:207], v[72:75]
    v_mfma_f32_16x16x32_bf16 v[76:79], v[28:31], a[204:207], v[76:79]
    v_mfma_f32_16x16x32_bf16 v[80:83], v[24:27], v[124:127], v[80:83]
    v_mfma_f32_16x16x32_bf16 v[84:87], v[28:31], v[124:127], v[84:87]
    v_mfma_f32_16x16x32_bf16 v[88:91], v[24:27], v[180:183], v[88:91]
    v_mfma_f32_16x16x32_bf16 v[92:95], v[28:31], v[180:183], v[92:95]
    v_mfma_f32_16x16x32_bf16 v[96:99], v[24:27], v[236:239], v[96:99]
    v_mfma_f32_16x16x32_bf16 v[100:103], v[28:31], v[236:239], v[100:103]
    s_add_u32 s26, s26, 16384
    s_addc_u32 s27, s27, 0
    global_load_dwordx4 v[24:27], v4, s[26:27] offset:0
    global_load_dwordx4 v[28:31], v5, s[26:27] offset:0
    s_waitcnt vmcnt(8)
    v_mfma_f32_16x16x32_bf16 v[48:51], v[32:35], a[40:43], v[48:51]
    v_mfma_f32_16x16x32_bf16 v[52:55], v[36:39], a[40:43], v[52:55]
    v_mfma_f32_16x16x32_bf16 v[56:59], v[32:35], a[96:99], v[56:59]
    v_mfma_f32_16x16x32_bf16 v[60:63], v[36:39], a[96:99], v[60:63]
    v_mfma_f32_16x16x32_bf16 v[64:67], v[32:35], a[152:155], v[64:67]
    v_mfma_f32_16x16x32_bf16 v[68:71], v[36:39], a[152:155], v[68:71]
    v_mfma_f32_16x16x32_bf16 v[72:75], v[32:35], a[208:211], v[72:75]
    v_mfma_f32_16x16x32_bf16 v[76:79], v[36:39], a[208:211], v[76:79]
    v_mfma_f32_16x16x32_bf16 v[80:83], v[32:35], v[128:131], v[80:83]
    v_mfma_f32_16x16x32_bf16 v[84:87], v[36:39], v[128:131], v[84:87]
    v_mfma_f32_16x16x32_bf16 v[88:91], v[32:35], v[184:187], v[88:91]
    v_mfma_f32_16x16x32_bf16 v[92:95], v[36:39], v[184:187], v[92:95]
    v_mfma_f32_16x16x32_bf16 v[96:99], v[32:35], v[240:243], v[96:99]
    v_mfma_f32_16x16x32_bf16 v[100:103], v[36:39], v[240:243], v[100:103]
    global_load_dwordx4 v[32:35], v4, s[26:27] offset:1024
    global_load_dwordx4 v[36:39], v5, s[26:27] offset:1024
    s_waitcnt vmcnt(8)
    v_mfma_f32_16x16x32_bf16 v[48:51], v[40:43], a[44:47], v[48:51]
    v_mfma_f32_16x16x32_bf16 v[52:55], v[44:47], a[44:47], v[52:55]
    v_mfma_f32_16x16x32_bf16 v[56:59], v[40:43], a[100:103], v[56:59]
    v_mfma_f32_16x16x32_bf16 v[60:63], v[44:47], a[100:103], v[60:63]
    v_mfma_f32_16x16x32_bf16 v[64:67], v[40:43], a[156:159], v[64:67]
    v_mfma_f32_16x16x32_bf16 v[68:71], v[44:47], a[156:159], v[68:71]
    v_mfma_f32_16x16x32_bf16 v[72:75], v[40:43], a[212:215], v[72:75]
    v_mfma_f32_16x16x32_bf16 v[76:79], v[44:47], a[212:215], v[76:79]
    v_mfma_f32_16x16x32_bf16 v[80:83], v[40:43], v[132:135], v[80:83]
    v_mfma_f32_16x16x32_bf16 v[84:87], v[44:47], v[132:135], v[84:87]
    v_mfma_f32_16x16x32_bf16 v[88:91], v[40:43], v[188:191], v[88:91]
    v_mfma_f32_16x16x32_bf16 v[92:95], v[44:47], v[188:191], v[92:95]
    v_mfma_f32_16x16x32_bf16 v[96:99], v[40:43], v[244:247], v[96:99]
    v_mfma_f32_16x16x32_bf16 v[100:103], v[44:47], v[244:247], v[100:103]
    global_load_dwordx4 v[40:43], v4, s[26:27] offset:2048
    global_load_dwordx4 v[44:47], v5, s[26:27] offset:2048
    s_waitcnt vmcnt(8)
    v_mfma_f32_16x16x32_bf16 v[48:51], v[8:11], a[48:51], v[48:51]
    v_mfma_f32_16x16x32_bf16 v[52:55], v[12:15], a[48:51], v[52:55]
    v_mfma_f32_16x16x32_bf16 v[56:59], v[8:11], a[104:107], v[56:59]
    v_mfma_f32_16x16x32_bf16 v[60:63], v[12:15], a[104:107], v[60:63]
    v_mfma_f32_16x16x32_bf16 v[64:67], v[8:11], a[160:163], v[64:67]
    v_mfma_f32_16x16x32_bf16 v[68:71], v[12:15], a[160:163], v[68:71]
    v_mfma_f32_16x16x32_bf16 v[72:75], v[8:11], a[216:219], v[72:75]
    v_mfma_f32_16x16x32_bf16 v[76:79], v[12:15], a[216:219], v[76:79]
    v_mfma_f32_16x16x32_bf16 v[80:83], v[8:11], v[136:139], v[80:83]
    v_mfma_f32_16x16x32_bf16 v[84:87], v[12:15], v[136:139], v[84:87]
    v_mfma_f32_16x16x32_bf16 v[88:91], v[8:11], v[192:195], v[88:91]
    v_mfma_f32_16x16x32_bf16 v[92:95], v[12:15], v[192:195], v[92:95]
    v_mfma_f32_16x16x32_bf16 v[96:99], v[8:11], v[248:251], v[96:99]
    v_mfma_f32_16x16x32_bf16 v[100:103], v[12:15], v[248:251], v[100:103]
    global_load_dwordx4 v[8:11], v4, s[26:27] offset:3072
    global_load_dwordx4 v[12:15], v5, s[26:27] offset:3072
    s_waitcnt vmcnt(8)
    v_mfma_f32_16x16x32_bf16 v[48:51], v[16:19], a[52:55], v[48:51]
    v_mfma_f32_16x16x32_bf16 v[52:55], v[20:23], a[52:55], v[52:55]
    v_mfma_f32_16x16x32_bf16 v[56:59], v[16:19], a[108:111], v[56:59]
    v_mfma_f32_16x16x32_bf16 v[60:63], v[20:23], a[108:111], v[60:63]
    v_mfma_f32_16x16x32_bf16 v[64:67], v[16:19], a[164:167], v[64:67]
    v_mfma_f32_16x16x32_bf16 v[68:71], v[20:23], a[164:167], v[68:71]
    v_mfma_f32_16x16x32_bf16 v[72:75], v[16:19], a[220:223], v[72:75]
    v_mfma_f32_16x16x32_bf16 v[76:79], v[20:23], a[220:223], v[76:79]
    v_mfma_f32_16x16x32_bf16 v[80:83], v[16:19], v[140:143], v[80:83]
    v_mfma_f32_16x16x32_bf16 v[84:87], v[20:23], v[140:143], v[84:87]
    v_mfma_f32_16x16x32_bf16 v[88:91], v[16:19], v[196:199], v[88:91]
    v_mfma_f32_16x16x32_bf16 v[92:95], v[20:23], v[196:199], v[92:95]
    v_mfma_f32_16x16x32_bf16 v[96:99], v[16:19], v[252:255], v[96:99]
    v_mfma_f32_16x16x32_bf16 v[100:103], v[20:23], v[252:255], v[100:103]
    s_nop 7
    s_add_u32 s38, s28, 0x1000
    s_addc_u32 s39, s29, 0
    v_cvt_pk_bf16_f32 v104, v48, v49
    v_cvt_pk_bf16_f32 v105, v50, v51
    v_cvt_pk_bf16_f32 v106, v52, v53
    v_cvt_pk_bf16_f32 v107, v54, v55
    global_store_dwordx4 v4, v[104:107], s[28:29] offset:0 sc1
    v_cvt_pk_bf16_f32 v108, v56, v57
    v_cvt_pk_bf16_f32 v109, v58, v59
    v_cvt_pk_bf16_f32 v110, v60, v61
    v_cvt_pk_bf16_f32 v111, v62, v63
    global_store_dwordx4 v4, v[108:111], s[28:29] offset:1024 sc1
    v_cvt_pk_bf16_f32 v112, v64, v65
    v_cvt_pk_bf16_f32 v113, v66, v67
    v_cvt_pk_bf16_f32 v114, v68, v69
    v_cvt_pk_bf16_f32 v115, v70, v71
    global_store_dwordx4 v4, v[112:115], s[28:29] offset:2048 sc1
    v_cvt_pk_bf16_f32 v116, v72, v73
    v_cvt_pk_bf16_f32 v117, v74, v75
    v_cvt_pk_bf16_f32 v118, v76, v77
    v_cvt_pk_bf16_f32 v119, v78, v79
    global_store_dwordx4 v4, v[116:119], s[28:29] offset:3072 sc1
    v_cvt_pk_bf16_f32 v104, v80, v81
    v_cvt_pk_bf16_f32 v105, v82, v83
    v_cvt_pk_bf16_f32 v106, v84, v85
    v_cvt_pk_bf16_f32 v107, v86, v87
    global_store_dwordx4 v4, v[104:107], s[38:39] offset:0 sc1
    v_cvt_pk_bf16_f32 v108, v88, v89
    v_cvt_pk_bf16_f32 v109, v90, v91
    v_cvt_pk_bf16_f32 v110, v92, v93
    v_cvt_pk_bf16_f32 v111, v94, v95
    global_store_dwordx4 v4, v[108:111], s[38:39] offset:1024 sc1
    v_cvt_pk_bf16_f32 v112, v96, v97
    v_cvt_pk_bf16_f32 v113, v98, v99
    v_cvt_pk_bf16_f32 v114, v100, v101
    v_cvt_pk_bf16_f32 v115, v102, v103
    global_store_dwordx4 v4, v[112:115], s[38:39] offset:2048 sc1
    s_add_u32 s28, s28, 458752
    s_addc_u32 s29, s29, 0
    s_nop 1
    s_add_u32 s26, s26, 4096
    s_addc_u32 s27, s27, 0
    global_load_dwordx4 v[16:19], v4, s[26:27] offset:0
    global_load_dwordx4 v[20:23], v5, s[26:27] offset:0
    s_waitcnt vmcnt(15)
    v_mfma_f32_16x16x32_bf16 v[48:51], v[24:27], a[0:3], 0
    v_mfma_f32_16x16x32_bf16 v[52:55], v[28:31], a[0:3], 0
    v_mfma_f32_16x16x32_bf16 v[56:59], v[24:27], a[56:59], 0
    v_mfma_f32_16x16x32_bf16 v[60:63], v[28:31], a[56:59], 0
    v_mfma_f32_16x16x32_bf16 v[64:67], v[24:27], a[112:115], 0
    v_mfma_f32_16x16x32_bf16 v[68:71], v[28:31], a[112:115], 0
    v_mfma_f32_16x16x32_bf16 v[72:75], v[24:27], a[168:171], 0
    v_mfma_f32_16x16x32_bf16 v[76:79], v[28:31], a[168:171], 0
    v_mfma_f32_16x16x32_bf16 v[80:83], v[24:27], a[224:227], 0
    v_mfma_f32_16x16x32_bf16 v[84:87], v[28:31], a[224:227], 0
    v_mfma_f32_16x16x32_bf16 v[88:91], v[24:27], v[144:147], 0
    v_mfma_f32_16x16x32_bf16 v[92:95], v[28:31], v[144:147], 0
    v_mfma_f32_16x16x32_bf16 v[96:99], v[24:27], v[200:203], 0
    v_mfma_f32_16x16x32_bf16 v[100:103], v[28:31], v[200:203], 0
    global_load_dwordx4 v[24:27], v4, s[26:27] offset:1024
    global_load_dwordx4 v[28:31], v5, s[26:27] offset:1024
    s_waitcnt vmcnt(15)
    v_mfma_f32_16x16x32_bf16 v[48:51], v[32:35], a[4:7], v[48:51]
    v_mfma_f32_16x16x32_bf16 v[52:55], v[36:39], a[4:7], v[52:55]
    v_mfma_f32_16x16x32_bf16 v[56:59], v[32:35], a[60:63], v[56:59]
    v_mfma_f32_16x16x32_bf16 v[60:63], v[36:39], a[60:63], v[60:63]
    v_mfma_f32_16x16x32_bf16 v[64:67], v[32:35], a[116:119], v[64:67]
    v_mfma_f32_16x16x32_bf16 v[68:71], v[36:39], a[116:119], v[68:71]
    v_mfma_f32_16x16x32_bf16 v[72:75], v[32:35], a[172:175], v[72:75]
    v_mfma_f32_16x16x32_bf16 v[76:79], v[36:39], a[172:175], v[76:79]
    v_mfma_f32_16x16x32_bf16 v[80:83], v[32:35], a[228:231], v[80:83]
    v_mfma_f32_16x16x32_bf16 v[84:87], v[36:39], a[228:231], v[84:87]
    v_mfma_f32_16x16x32_bf16 v[88:91], v[32:35], v[148:151], v[88:91]
    v_mfma_f32_16x16x32_bf16 v[92:95], v[36:39], v[148:151], v[92:95]
    v_mfma_f32_16x16x32_bf16 v[96:99], v[32:35], v[204:207], v[96:99]
    v_mfma_f32_16x16x32_bf16 v[100:103], v[36:39], v[204:207], v[100:103]
    global_load_dwordx4 v[32:35], v4, s[26:27] offset:2048
    global_load_dwordx4 v[36:39], v5, s[26:27] offset:2048
    s_waitcnt vmcnt(15)
    v_mfma_f32_16x16x32_bf16 v[48:51], v[40:43], a[8:11], v[48:51]
    v_mfma_f32_16x16x32_bf16 v[52:55], v[44:47], a[8:11], v[52:55]
    v_mfma_f32_16x16x32_bf16 v[56:59], v[40:43], a[64:67], v[56:59]
    v_mfma_f32_16x16x32_bf16 v[60:63], v[44:47], a[64:67], v[60:63]
    v_mfma_f32_16x16x32_bf16 v[64:67], v[40:43], a[120:123], v[64:67]
    v_mfma_f32_16x16x32_bf16 v[68:71], v[44:47], a[120:123], v[68:71]
    v_mfma_f32_16x16x32_bf16 v[72:75], v[40:43], a[176:179], v[72:75]
    v_mfma_f32_16x16x32_bf16 v[76:79], v[44:47], a[176:179], v[76:79]
    v_mfma_f32_16x16x32_bf16 v[80:83], v[40:43], a[232:235], v[80:83]
    v_mfma_f32_16x16x32_bf16 v[84:87], v[44:47], a[232:235], v[84:87]
    v_mfma_f32_16x16x32_bf16 v[88:91], v[40:43], v[152:155], v[88:91]
    v_mfma_f32_16x16x32_bf16 v[92:95], v[44:47], v[152:155], v[92:95]
    v_mfma_f32_16x16x32_bf16 v[96:99], v[40:43], v[208:211], v[96:99]
    v_mfma_f32_16x16x32_bf16 v[100:103], v[44:47], v[208:211], v[100:103]
    global_load_dwordx4 v[40:43], v4, s[26:27] offset:3072
    global_load_dwordx4 v[44:47], v5, s[26:27] offset:3072
    s_waitcnt vmcnt(15)
    v_mfma_f32_16x16x32_bf16 v[48:51], v[8:11], a[12:15], v[48:51]
    v_mfma_f32_16x16x32_bf16 v[52:55], v[12:15], a[12:15], v[52:55]
    v_mfma_f32_16x16x32_bf16 v[56:59], v[8:11], a[68:71], v[56:59]
    v_mfma_f32_16x16x32_bf16 v[60:63], v[12:15], a[68:71], v[60:63]
    v_mfma_f32_16x16x32_bf16 v[64:67], v[8:11], a[124:127], v[64:67]
    v_mfma_f32_16x16x32_bf16 v[68:71], v[12:15], a[124:127], v[68:71]
    v_mfma_f32_16x16x32_bf16 v[72:75], v[8:11], a[180:183], v[72:75]
    v_mfma_f32_16x16x32_bf16 v[76:79], v[12:15], a[180:183], v[76:79]
    v_mfma_f32_16x16x32_bf16 v[80:83], v[8:11], a[236:239], v[80:83]
    v_mfma_f32_16x16x32_bf16 v[84:87], v[12:15], a[236:239], v[84:87]
    v_mfma_f32_16x16x32_bf16 v[88:91], v[8:11], v[156:159], v[88:91]
    v_mfma_f32_16x16x32_bf16 v[92:95], v[12:15], v[156:159], v[92:95]
    v_mfma_f32_16x16x32_bf16 v[96:99], v[8:11], v[212:215], v[96:99]
    v_mfma_f32_16x16x32_bf16 v[100:103], v[12:15], v[212:215], v[100:103]
    s_add_u32 s26, s26, 4096
    s_addc_u32 s27, s27, 0
    global_load_dwordx4 v[8:11], v4, s[26:27] offset:0
    global_load_dwordx4 v[12:15], v5, s[26:27] offset:0
    s_waitcnt vmcnt(8)
    v_mfma_f32_16x16x32_bf16 v[48:51], v[16:19], a[16:19], v[48:51]
    v_mfma_f32_16x16x32_bf16 v[52:55], v[20:23], a[16:19], v[52:55]
    v_mfma_f32_16x16x32_bf16 v[56:59], v[16:19], a[72:75], v[56:59]
    v_mfma_f32_16x16x32_bf16 v[60:63], v[20:23], a[72:75], v[60:63]
    v_mfma_f32_16x16x32_bf16 v[64:67], v[16:19], a[128:131], v[64:67]
    v_mfma_f32_16x16x32_bf16 v[68:71], v[20:23], a[128:131], v[68:71]
    v_mfma_f32_16x16x32_bf16 v[72:75], v[16:19], a[184:187], v[72:75]
    v_mfma_f32_16x16x32_bf16 v[76:79], v[20:23], a[184:187], v[76:79]
    v_mfma_f32_16x16x32_bf16 v[80:83], v[16:19], a[240:243], v[80:83]
    v_mfma_f32_16x16x32_bf16 v[84:87], v[20:23], a[240:243], v[84:87]
    v_mfma_f32_16x16x32_bf16 v[88:91], v[16:19], v[160:163], v[88:91]
    v_mfma_f32_16x16x32_bf16 v[92:95], v[20:23], v[160:163], v[92:95]
    v_mfma_f32_16x16x32_bf16 v[96:99], v[16:19], v[216:219], v[96:99]
    v_mfma_f32_16x16x32_bf16 v[100:103], v[20:23], v[216:219], v[100:103]
    global_load_dwordx4 v[16:19], v4, s[26:27] offset:1024
    global_load_dwordx4 v[20:23], v5, s[26:27] offset:1024
    s_waitcnt vmcnt(8)
    v_mfma_f32_16x16x32_bf16 v[48:51], v[24:27], a[20:23], v[48:51]
    v_mfma_f32_16x16x32_bf16 v[52:55], v[28:31], a[20:23], v[52:55]
    v_mfma_f32_16x16x32_bf16 v[56:59], v[24:27], a[76:79], v[56:59]
    v_mfma_f32_16x16x32_bf16 v[60:63], v[28:31], a[76:79], v[60:63]
    v_mfma_f32_16x16x32_bf16 v[64:67], v[24:27], a[132:135], v[64:67]
    v_mfma_f32_16x16x32_bf16 v[68:71], v[28:31], a[132:135], v[68:71]
    v_mfma_f32_16x16x32_bf16 v[72:75], v[24:27], a[188:191], v[72:75]
    v_mfma_f32_16x16x32_bf16 v[76:79], v[28:31], a[188:191], v[76:79]
    v_mfma_f32_16x16x32_bf16 v[80:83], v[24:27], a[244:247], v[80:83]
    v_mfma_f32_16x16x32_bf16 v[84:87], v[28:31], a[244:247], v[84:87]
    v_mfma_f32_16x16x32_bf16 v[88:91], v[24:27], v[164:167], v[88:91]
    v_mfma_f32_16x16x32_bf16 v[92:95], v[28:31], v[164:167], v[92:95]
    v_mfma_f32_16x16x32_bf16 v[96:99], v[24:27], v[220:223], v[96:99]
    v_mfma_f32_16x16x32_bf16 v[100:103], v[28:31], v[220:223], v[100:103]
    global_load_dwordx4 v[24:27], v4, s[26:27] offset:2048
    global_load_dwordx4 v[28:31], v5, s[26:27] offset:2048
    s_waitcnt vmcnt(8)
    v_mfma_f32_16x16x32_bf16 v[48:51], v[32:35], a[24:27], v[48:51]
    v_mfma_f32_16x16x32_bf16 v[52:55], v[36:39], a[24:27], v[52:55]
    v_mfma_f32_16x16x32_bf16 v[56:59], v[32:35], a[80:83], v[56:59]
    v_mfma_f32_16x16x32_bf16 v[60:63], v[36:39], a[80:83], v[60:63]
    v_mfma_f32_16x16x32_bf16 v[64:67], v[32:35], a[136:139], v[64:67]
    v_mfma_f32_16x16x32_bf16 v[68:71], v[36:39], a[136:139], v[68:71]
    v_mfma_f32_16x16x32_bf16 v[72:75], v[32:35], a[192:195], v[72:75]
    v_mfma_f32_16x16x32_bf16 v[76:79], v[36:39], a[192:195], v[76:79]
    v_mfma_f32_16x16x32_bf16 v[80:83], v[32:35], a[248:251], v[80:83]
    v_mfma_f32_16x16x32_bf16 v[84:87], v[36:39], a[248:251], v[84:87]
    v_mfma_f32_16x16x32_bf16 v[88:91], v[32:35], v[168:171], v[88:91]
    v_mfma_f32_16x16x32_bf16 v[92:95], v[36:39], v[168:171], v[92:95]
    v_mfma_f32_16x16x32_bf16 v[96:99], v[32:35], v[224:227], v[96:99]
    v_mfma_f32_16x16x32_bf16 v[100:103], v[36:39], v[224:227], v[100:103]
    global_load_dwordx4 v[32:35], v4, s[26:27] offset:3072
    global_load_dwordx4 v[36:39], v5, s[26:27] offset:3072
    s_waitcnt vmcnt(8)
    v_mfma_f32_16x16x32_bf16 v[48:51], v[40:43], a[28:31], v[48:51]
    v_mfma_f32_16x16x32_bf16 v[52:55], v[44:47], a[28:31], v[52:55]
    v_mfma_f32_16x16x32_bf16 v[56:59], v[40:43], a[84:87], v[56:59]
    v_mfma_f32_16x16x32_bf16 v[60:63], v[44:47], a[84:87], v[60:63]
    v_mfma_f32_16x16x32_bf16 v[64:67], v[40:43], a[140:143], v[64:67]
    v_mfma_f32_16x16x32_bf16 v[68:71], v[44:47], a[140:143], v[68:71]
    v_mfma_f32_16x16x32_bf16 v[72:75], v[40:43], a[196:199], v[72:75]
    v_mfma_f32_16x16x32_bf16 v[76:79], v[44:47], a[196:199], v[76:79]
    v_mfma_f32_16x16x32_bf16 v[80:83], v[40:43], a[252:255], v[80:83]
    v_mfma_f32_16x16x32_bf16 v[84:87], v[44:47], a[252:255], v[84:87]
    v_mfma_f32_16x16x32_bf16 v[88:91], v[40:43], v[172:175], v[88:91]
    v_mfma_f32_16x16x32_bf16 v[92:95], v[44:47], v[172:175], v[92:95]
    v_mfma_f32_16x16x32_bf16 v[96:99], v[40:43], v[228:231], v[96:99]
    v_mfma_f32_16x16x32_bf16 v[100:103], v[44:47], v[228:231], v[100:103]
    s_add_u32 s26, s26, 4096
    s_addc_u32 s27, s27, 0
    global_load_dwordx4 v[40:43], v4, s[26:27] offset:0
    global_load_dwordx4 v[44:47], v5, s[26:27] offset:0
    s_waitcnt vmcnt(8)
    v_mfma_f32_16x16x32_bf16 v[48:51], v[8:11], a[32:35], v[48:51]
    v_mfma_f32_16x16x32_bf16 v[52:55], v[12:15], a[32:35], v[52:55]
    v_mfma_f32_16x16x32_bf16 v[56:59], v[8:11], a[88:91], v[56:59]
    v_mfma_f32_16x16x32_bf16 v[60:63], v[12:15], a[88:91], v[60:63]
    v_mfma_f32_16x16x32_bf16 v[64:67], v[8:11], a[144:147], v[64:67]
    v_mfma_f32_16x16x32_bf16 v[68:71], v[12:15], a[144:147], v[68:71]
    v_mfma_f32_16x16x32_bf16 v[72:75], v[8:11], a[200:203], v[72:75]
    v_mfma_f32_16x16x32_bf16 v[76:79], v[12:15], a[200:203], v[76:79]
    v_mfma_f32_16x16x32_bf16 v[80:83], v[8:11], v[120:123], v[80:83]
    v_mfma_f32_16x16x32_bf16 v[84:87], v[12:15], v[120:123], v[84:87]
    v_mfma_f32_16x16x32_bf16 v[88:91], v[8:11], v[176:179], v[88:91]
    v_mfma_f32_16x16x32_bf16 v[92:95], v[12:15], v[176:179], v[92:95]
    v_mfma_f32_16x16x32_bf16 v[96:99], v[8:11], v[232:235], v[96:99]
    v_mfma_f32_16x16x32_bf16 v[100:103], v[12:15], v[232:235], v[100:103]
    global_load_dwordx4 v[8:11], v4, s[26:27] offset:1024
    global_load_dwordx4 v[12:15], v5, s[26:27] offset:1024
    s_waitcnt vmcnt(8)
    v_mfma_f32_16x16x32_bf16 v[48:51], v[16:19], a[36:39], v[48:51]
    v_mfma_f32_16x16x32_bf16 v[52:55], v[20:23], a[36:39], v[52:55]
    v_mfma_f32_16x16x32_bf16 v[56:59], v[16:19], a[92:95], v[56:59]
    v_mfma_f32_16x16x32_bf16 v[60:63], v[20:23], a[92:95], v[60:63]
    v_mfma_f32_16x16x32_bf16 v[64:67], v[16:19], a[148:151], v[64:67]
    v_mfma_f32_16x16x32_bf16 v[68:71], v[20:23], a[148:151], v[68:71]
    v_mfma_f32_16x16x32_bf16 v[72:75], v[16:19], a[204:207], v[72:75]
    v_mfma_f32_16x16x32_bf16 v[76:79], v[20:23], a[204:207], v[76:79]
    v_mfma_f32_16x16x32_bf16 v[80:83], v[16:19], v[124:127], v[80:83]
    v_mfma_f32_16x16x32_bf16 v[84:87], v[20:23], v[124:127], v[84:87]
    v_mfma_f32_16x16x32_bf16 v[88:91], v[16:19], v[180:183], v[88:91]
    v_mfma_f32_16x16x32_bf16 v[92:95], v[20:23], v[180:183], v[92:95]
    v_mfma_f32_16x16x32_bf16 v[96:99], v[16:19], v[236:239], v[96:99]
    v_mfma_f32_16x16x32_bf16 v[100:103], v[20:23], v[236:239], v[100:103]
    s_waitcnt vmcnt(6)
    v_mfma_f32_16x16x32_bf16 v[48:51], v[24:27], a[40:43], v[48:51]
    v_mfma_f32_16x16x32_bf16 v[52:55], v[28:31], a[40:43], v[52:55]
    v_mfma_f32_16x16x32_bf16 v[56:59], v[24:27], a[96:99], v[56:59]
    v_mfma_f32_16x16x32_bf16 v[60:63], v[28:31], a[96:99], v[60:63]
    v_mfma_f32_16x16x32_bf16 v[64:67], v[24:27], a[152:155], v[64:67]
    v_mfma_f32_16x16x32_bf16 v[68:71], v[28:31], a[152:155], v[68:71]
    v_mfma_f32_16x16x32_bf16 v[72:75], v[24:27], a[208:211], v[72:75]
    v_mfma_f32_16x16x32_bf16 v[76:79], v[28:31], a[208:211], v[76:79]
    v_mfma_f32_16x16x32_bf16 v[80:83], v[24:27], v[128:131], v[80:83]
    v_mfma_f32_16x16x32_bf16 v[84:87], v[28:31], v[128:131], v[84:87]
    v_mfma_f32_16x16x32_bf16 v[88:91], v[24:27], v[184:187], v[88:91]
    v_mfma_f32_16x16x32_bf16 v[92:95], v[28:31], v[184:187], v[92:95]
    v_mfma_f32_16x16x32_bf16 v[96:99], v[24:27], v[240:243], v[96:99]
    v_mfma_f32_16x16x32_bf16 v[100:103], v[28:31], v[240:243], v[100:103]
    s_waitcnt vmcnt(4)
    v_mfma_f32_16x16x32_bf16 v[48:51], v[32:35], a[44:47], v[48:51]
    v_mfma_f32_16x16x32_bf16 v[52:55], v[36:39], a[44:47], v[52:55]
    v_mfma_f32_16x16x32_bf16 v[56:59], v[32:35], a[100:103], v[56:59]
    v_mfma_f32_16x16x32_bf16 v[60:63], v[36:39], a[100:103], v[60:63]
    v_mfma_f32_16x16x32_bf16 v[64:67], v[32:35], a[156:159], v[64:67]
    v_mfma_f32_16x16x32_bf16 v[68:71], v[36:39], a[156:159], v[68:71]
    v_mfma_f32_16x16x32_bf16 v[72:75], v[32:35], a[212:215], v[72:75]
    v_mfma_f32_16x16x32_bf16 v[76:79], v[36:39], a[212:215], v[76:79]
    v_mfma_f32_16x16x32_bf16 v[80:83], v[32:35], v[132:135], v[80:83]
    v_mfma_f32_16x16x32_bf16 v[84:87], v[36:39], v[132:135], v[84:87]
    v_mfma_f32_16x16x32_bf16 v[88:91], v[32:35], v[188:191], v[88:91]
    v_mfma_f32_16x16x32_bf16 v[92:95], v[36:39], v[188:191], v[92:95]
    v_mfma_f32_16x16x32_bf16 v[96:99], v[32:35], v[244:247], v[96:99]
    v_mfma_f32_16x16x32_bf16 v[100:103], v[36:39], v[244:247], v[100:103]
    s_waitcnt vmcnt(2)
    v_mfma_f32_16x16x32_bf16 v[48:51], v[40:43], a[48:51], v[48:51]
    v_mfma_f32_16x16x32_bf16 v[52:55], v[44:47], a[48:51], v[52:55]
    v_mfma_f32_16x16x32_bf16 v[56:59], v[40:43], a[104:107], v[56:59]
    v_mfma_f32_16x16x32_bf16 v[60:63], v[44:47], a[104:107], v[60:63]
    v_mfma_f32_16x16x32_bf16 v[64:67], v[40:43], a[160:163], v[64:67]
    v_mfma_f32_16x16x32_bf16 v[68:71], v[44:47], a[160:163], v[68:71]
    v_mfma_f32_16x16x32_bf16 v[72:75], v[40:43], a[216:219], v[72:75]
    v_mfma_f32_16x16x32_bf16 v[76:79], v[44:47], a[216:219], v[76:79]
    v_mfma_f32_16x16x32_bf16 v[80:83], v[40:43], v[136:139], v[80:83]
    v_mfma_f32_16x16x32_bf16 v[84:87], v[44:47], v[136:139], v[84:87]
    v_mfma_f32_16x16x32_bf16 v[88:91], v[40:43], v[192:195], v[88:91]
    v_mfma_f32_16x16x32_bf16 v[92:95], v[44:47], v[192:195], v[92:95]
    v_mfma_f32_16x16x32_bf16 v[96:99], v[40:43], v[248:251], v[96:99]
    v_mfma_f32_16x16x32_bf16 v[100:103], v[44:47], v[248:251], v[100:103]
    s_waitcnt vmcnt(0)
    v_mfma_f32_16x16x32_bf16 v[48:51], v[8:11], a[52:55], v[48:51]
    v_mfma_f32_16x16x32_bf16 v[52:55], v[12:15], a[52:55], v[52:55]
    v_mfma_f32_16x16x32_bf16 v[56:59], v[8:11], a[108:111], v[56:59]
    v_mfma_f32_16x16x32_bf16 v[60:63], v[12:15], a[108:111], v[60:63]
    v_mfma_f32_16x16x32_bf16 v[64:67], v[8:11], a[164:167], v[64:67]
    v_mfma_f32_16x16x32_bf16 v[68:71], v[12:15], a[164:167], v[68:71]
    v_mfma_f32_16x16x32_bf16 v[72:75], v[8:11], a[220:223], v[72:75]
    v_mfma_f32_16x16x32_bf16 v[76:79], v[12:15], a[220:223], v[76:79]
    v_mfma_f32_16x16x32_bf16 v[80:83], v[8:11], v[140:143], v[80:83]
    v_mfma_f32_16x16x32_bf16 v[84:87], v[12:15], v[140:143], v[84:87]
    v_mfma_f32_16x16x32_bf16 v[88:91], v[8:11], v[196:199], v[88:91]
    v_mfma_f32_16x16x32_bf16 v[92:95], v[12:15], v[196:199], v[92:95]
    v_mfma_f32_16x16x32_bf16 v[96:99], v[8:11], v[252:255], v[96:99]
    v_mfma_f32_16x16x32_bf16 v[100:103], v[12:15], v[252:255], v[100:103]
    s_nop 7
    s_add_u32 s38, s28, 0x1000
    s_addc_u32 s39, s29, 0
    v_cvt_pk_bf16_f32 v104, v48, v49
    v_cvt_pk_bf16_f32 v105, v50, v51
    v_cvt_pk_bf16_f32 v106, v52, v53
    v_cvt_pk_bf16_f32 v107, v54, v55
    global_store_dwordx4 v4, v[104:107], s[28:29] offset:0 sc1
    v_cvt_pk_bf16_f32 v108, v56, v57
    v_cvt_pk_bf16_f32 v109, v58, v59
    v_cvt_pk_bf16_f32 v110, v60, v61
    v_cvt_pk_bf16_f32 v111, v62, v63
    global_store_dwordx4 v4, v[108:111], s[28:29] offset:1024 sc1
    v_cvt_pk_bf16_f32 v112, v64, v65
    v_cvt_pk_bf16_f32 v113, v66, v67
    v_cvt_pk_bf16_f32 v114, v68, v69
    v_cvt_pk_bf16_f32 v115, v70, v71
    global_store_dwordx4 v4, v[112:115], s[28:29] offset:2048 sc1
    v_cvt_pk_bf16_f32 v116, v72, v73
    v_cvt_pk_bf16_f32 v117, v74, v75
    v_cvt_pk_bf16_f32 v118, v76, v77
    v_cvt_pk_bf16_f32 v119, v78, v79
    global_store_dwordx4 v4, v[116:119], s[28:29] offset:3072 sc1
    v_cvt_pk_bf16_f32 v104, v80, v81
    v_cvt_pk_bf16_f32 v105, v82, v83
    v_cvt_pk_bf16_f32 v106, v84, v85
    v_cvt_pk_bf16_f32 v107, v86, v87
    global_store_dwordx4 v4, v[104:107], s[38:39] offset:0 sc1
    v_cvt_pk_bf16_f32 v108, v88, v89
    v_cvt_pk_bf16_f32 v109, v90, v91
    v_cvt_pk_bf16_f32 v110, v92, v93
    v_cvt_pk_bf16_f32 v111, v94, v95
    global_store_dwordx4 v4, v[108:111], s[38:39] offset:1024 sc1
    v_cvt_pk_bf16_f32 v112, v96, v97
    v_cvt_pk_bf16_f32 v113, v98, v99
    v_cvt_pk_bf16_f32 v114, v100, v101
    v_cvt_pk_bf16_f32 v115, v102, v103
    global_store_dwordx4 v4, v[112:115], s[38:39] offset:2048 sc1
    s_add_u32 s28, s28, 458752
    s_addc_u32 s29, s29, 0
    s_nop 1
    s_branch .chain_kernel_fin79
.chain_kernel_ty73:
    s_lshr_b32 s21, s2, 1
    s_and_b32 s21, s21, 15
    s_and_b32 s22, s2, 1
    s_lshr_b32 s20, s2, 5
    v_add_u32 v7, 14336, v4
    s_mul_i32 s38, s21, 28
    s_mul_i32 s39, s22, 14
    s_add_u32 s38, s38, s39
    s_lshl_b32 s39, s18, 2
    s_add_u32 s38, s38, s39
    s_mul_i32 s38, s38, 14336
    s_add_u32 s38, s38, 0x1459000
    s_add_u32 s24, s16, s38
    s_addc_u32 s25, s17, 0
    global_load_dwordx4 a[0:3], v4, s[24:25] offset:0
    global_load_dwordx4 a[4:7], v4, s[24:25] offset:1024
    global_load_dwordx4 a[8:11], v4, s[24:25] offset:2048
    global_load_dwordx4 a[12:15], v4, s[24:25] offset:3072
    s_add_u32 s24, s24, 4096
    s_addc_u32 s25, s25, 0
    global_load_dwordx4 a[16:19], v4, s[24:25] offset:0
    global_load_dwordx4 a[20:23], v4, s[24:25] offset:1024
    global_load_dwordx4 a[24:27], v4, s[24:25] offset:2048
    global_load_dwordx4 a[28:31], v4, s[24:25] offset:3072
    s_add_u32 s24, s24, 4096
    s_addc_u32 s25, s25, 0
    global_load_dwordx4 a[32:35], v4, s[24:25] offset:0
    global_load_dwordx4 a[36:39], v4, s[24:25] offset:1024
    global_load_dwordx4 a[40:43], v4, s[24:25] offset:2048
    global_load_dwordx4 a[44:47], v4, s[24:25] offset:3072
    s_add_u32 s24, s24, 4096
    s_addc_u32 s25, s25, 0
    global_load_dwordx4 a[48:51], v4, s[24:25] offset:0
    global_load_dwordx4 a[52:55], v4, s[24:25] offset:1024
    global_load_dwordx4 a[56:59], v4, s[24:25] offset:2048
    global_load_dwordx4 a[60:63], v4, s[24:25] offset:3072
    s_add_u32 s24, s24, 4096
    s_addc_u32 s25, s25, 0
    global_load_dwordx4 a[64:67], v4, s[24:25] offset:0
    global_load_dwordx4 a[68:71], v4, s[24:25] offset:1024
    global_load_dwordx4 a[72:75], v4, s[24:25] offset:2048
    global_load_dwordx4 a[76:79], v4, s[24:25] offset:3072
    s_add_u32 s24, s24, 4096
    s_addc_u32 s25, s25, 0
    global_load_dwordx4 a[80:83], v4, s[24:25] offset:0
    global_load_dwordx4 a[84:87], v4, s[24:25] offset:1024
    global_load_dwordx4 a[88:91], v4, s[24:25] offset:2048
    global_load_dwordx4 a[92:95], v4, s[24:25] offset:3072
    s_add_u32 s24, s24, 4096
    s_addc_u32 s25, s25, 0
    global_load_dwordx4 a[96:99], v4, s[24:25] offset:0
    global_load_dwordx4 a[100:103], v4, s[24:25] offset:1024
    global_load_dwordx4 a[104:107], v4, s[24:25] offset:2048
    global_load_dwordx4 a[108:111], v4, s[24:25] offset:3072
    s_cmp_eq_u32 s18, 3
    s_cbranch_scc1 .chain_kernel_af280
    s_add_u32 s24, s24, 4096
    s_addc_u32 s25, s25, 0
    global_load_dwordx4 a[112:115], v4, s[24:25] offset:0
    global_load_dwordx4 a[116:119], v4, s[24:25] offset:1024
    global_load_dwordx4 a[120:123], v4, s[24:25] offset:2048
    global_load_dwordx4 a[124:127], v4, s[24:25] offset:3072
    s_add_u32 s24, s24, 4096
    s_addc_u32 s25, s25, 0
    global_load_dwordx4 a[128:131], v4, s[24:25] offset:0
    global_load_dwordx4 a[132:135], v4, s[24:25] offset:1024
    global_load_dwordx4 a[136:139], v4, s[24:25] offset:2048
    global_load_dwordx4 a[140:143], v4, s[24:25] offset:3072
    s_add_u32 s24, s24, 4096
    s_addc_u32 s25, s25, 0
    global_load_dwordx4 a[144:147], v4, s[24:25] offset:0
    global_load_dwordx4 a[148:151], v4, s[24:25] offset:1024
    global_load_dwordx4 a[152:155], v4, s[24:25] offset:2048
    global_load_dwordx4 a[156:159], v4, s[24:25] offset:3072
    s_add_u32 s24, s24, 4096
    s_addc_u32 s25, s25, 0
    global_load_dwordx4 a[160:163], v4, s[24:25] offset:0
    global_load_dwordx4 a[164:167], v4, s[24:25] offset:1024
    global_load_dwordx4 a[168:171], v4, s[24:25] offset:2048
    global_load_dwordx4 a[172:175], v4, s[24:25] offset:3072
    s_add_u32 s24, s24, 4096
    s_addc_u32 s25, s25, 0
    global_load_dwordx4 a[176:179], v4, s[24:25] offset:0
    global_load_dwordx4 a[180:183], v4, s[24:25] offset:1024
    global_load_dwordx4 a[184:187], v4, s[24:25] offset:2048
    global_load_dwordx4 a[188:191], v4, s[24:25] offset:3072
    s_add_u32 s24, s24, 4096
    s_addc_u32 s25, s25, 0
    global_load_dwordx4 a[192:195], v4, s[24:25] offset:0
    global_load_dwordx4 a[196:199], v4, s[24:25] offset:1024
    global_load_dwordx4 a[200:203], v4, s[24:25] offset:2048
    global_load_dwordx4 a[204:207], v4, s[24:25] offset:3072
    s_add_u32 s24, s24, 4096
    s_addc_u32 s25, s25, 0
    global_load_dwordx4 a[208:211], v4, s[24:25] offset:0
    global_load_dwordx4 a[212:215], v4, s[24:25] offset:1024
    global_load_dwordx4 a[216:219], v4, s[24:25] offset:2048
    global_load_dwordx4 a[220:223], v4, s[24:25] offset:3072
.chain_kernel_af280:
    s_mul_i32 s38, s20, 229376
    s_add_u32 s38, s38, 0x1000
    s_add_u32 s26, s16, s38
    s_addc_u32 s27, s17, 0
    s_mul_i32 s38, s22, 7
    s_lshl_b32 s39, s18, 1
    s_add_u32 s38, s38, s39
    s_lshl_b32 s38, s38, 10
    s_add_u32 s28, s26, s38
    s_addc_u32 s29, s27, 0
    s_lshl_b32 s38, s20, 7
    s_add_u32 s38, s38, s21
    s_lshl_b32 s38, s38, 1
    s_add_u32 s38, s38, s22
    s_lshl_b32 s38, s38, 2
    s_cmp_eq_u32 s18, 2
    s_cselect_b32 s39, 3, s18
    s_add_u32 s38, s38, s39
    s_lshl_b32 s38, s38, 10
    s_add_u32 s38, s38, 0x4e9d000
    s_add_u32 s30, s16, s38
    s_addc_u32 s31, s17, 0
    s_mul_i32 s38, s18, 3072
    s_add_u32 s38, s38, 114688
    v_add_u32 v8, s38, v4
    s_lshl_b32 s38, s18, 10
    s_add_u32 s38, s38, 114688
    v_add_u32 v9, s38, v4
    s_mov_b32 s23, 0
.chain_kernel_loop81:
    s_add_u32 s32, s26, 0x1000
    s_addc_u32 s33, s27, 0
    s_add_u32 s34, s26, 0x2000
    s_addc_u32 s35, s27, 0
    s_add_u32 s36, s26, 0x3000
    s_addc_u32 s37, s27, 0
    global_load_dwordx4 v[16:19], v4, s[26:27] offset:0
    global_load_dwordx4 v[20:23], v7, s[26:27] offset:0
    global_load_dwordx4 v[24:27], v4, s[26:27] offset:1024
    global_load_dwordx4 v[28:31], v7, s[26:27] offset:1024
    global_load_dwordx4 v[32:35], v4, s[26:27] offset:2048
    global_load_dwordx4 v[36:39], v7, s[26:27] offset:2048
    global_load_dwordx4 v[40:43], v4, s[26:27] offset:3072
    global_load_dwordx4 v[44:47], v7, s[26:27] offset:3072
    global_load_dwordx4 v[48:51], v4, s[32:33] offset:0
    global_load_dwordx4 v[52:55], v7, s[32:33] offset:0
    global_load_dwordx4 v[56:59], v4, s[32:33] offset:1024
    global_load_dwordx4 v[60:63], v7, s[32:33] offset:1024
    global_load_dwordx4 v[64:67], v4, s[32:33] offset:2048
    global_load_dwordx4 v[68:71], v7, s[32:33] offset:2048
    global_load_dwordx4 v[72:75], v4, s[32:33] offset:3072
    global_load_dwordx4 v[76:79], v7, s[32:33] offset:3072
    global_load_dwordx4 v[80:83], v4, s[34:35] offset:0
    global_load_dwordx4 v[84:87], v7, s[34:35] offset:0
    global_load_dwordx4 v[88:91], v4, s[34:35] offset:1024
    global_load_dwordx4 v[92:95], v7, s[34:35] offset:1024
    global_load_dwordx4 v[96:99], v4, s[34:35] offset:2048
    global_load_dwordx4 v[100:103], v7, s[34:35] offset:2048
    global_load_dwordx4 v[104:107], v4, s[34:35] offset:3072
    global_load_dwordx4 v[108:111], v7, s[34:35] offset:3072
    global_load_dwordx4 v[112:115], v4, s[36:37] offset:0
    global_load_dwordx4 v[116:119], v7, s[36:37] offset:0
    global_load_dwordx4 v[120:123], v4, s[36:37] offset:1024
    global_load_dwordx4 v[124:127], v7, s[36:37] offset:1024
    global_load_dwordx4 v[176:179], v4, s[28:29]
    global_load_dwordx4 v[184:187], v7, s[28:29]
    global_load_dwordx4 v[180:183], v4, s[28:29] offset:1024
    global_load_dwordx4 v[188:191], v7, s[28:29] offset:1024
    s_cmp_eq_u32 s18, 3
    s_cbranch_scc1 .chain_kernel_t282
    s_waitcnt vmcnt(30)
    v_mfma_f32_16x16x32_bf16 v[128:131], a[0:3], v[16:19], 0
    v_mfma_f32_16x16x32_bf16 v[132:135], a[0:3], v[20:23], 0
    v_mfma_f32_16x16x32_bf16 v[136:139], a[56:59], v[16:19], 0
    v_mfma_f32_16x16x32_bf16 v[140:143], a[56:59], v[20:23], 0
    v_mfma_f32_16x16x32_bf16 v[144:147], a[112:115], v[16:19], 0
    v_mfma_f32_16x16x32_bf16 v[148:151], a[112:115], v[20:23], 0
    v_mfma_f32_16x16x32_bf16 v[152:155], a[168:171], v[16:19], 0
    v_mfma_f32_16x16x32_bf16 v[156:159], a[168:171], v[20:23], 0
    s_waitcnt vmcnt(28)
    v_mfma_f32_16x16x32_bf16 v[128:131], a[4:7], v[24:27], v[128:131]
    v_mfma_f32_16x16x32_bf16 v[132:135], a[4:7], v[28:31], v[132:135]
    v_mfma_f32_16x16x32_bf16 v[136:139], a[60:63], v[24:27], v[136:139]
    v_mfma_f32_16x16x32_bf16 v[140:143], a[60:63], v[28:31], v[140:143]
    v_mfma_f32_16x16x32_bf16 v[144:147], a[116:119], v[24:27], v[144:147]
    v_mfma_f32_16x16x32_bf16 v[148:151], a[116:119], v[28:31], v[148:151]
    v_mfma_f32_16x16x32_bf16 v[152:155], a[172:175], v[24:27], v[152:155]
    v_mfma_f32_16x16x32_bf16 v[156:159], a[172:175], v[28:31], v[156:159]
    s_waitcnt vmcnt(26)
    v_mfma_f32_16x16x32_bf16 v[128:131], a[8:11], v[32:35], v[128:131]
    v_mfma_f32_16x16x32_bf16 v[132:135], a[8:11], v[36:39], v[132:135]
    v_mfma_f32_16x16x32_bf16 v[136:139], a[64:67], v[32:35], v[136:139]
    v_mfma_f32_16x16x32_bf16 v[140:143], a[64:67], v[36:39], v[140:143]
    v_mfma_f32_16x16x32_bf16 v[144:147], a[120:123], v[32:35], v[144:147]
    v_mfma_f32_16x16x32_bf16 v[148:151], a[120:123], v[36:39], v[148:151]
    v_mfma_f32_16x16x32_bf16 v[152:155], a[176:179], v[32:35], v[152:155]
    v_mfma_f32_16x16x32_bf16 v[156:159], a[176:179], v[36:39], v[156:159]
    s_waitcnt vmcnt(24)
    v_mfma_f32_16x16x32_bf16 v[128:131], a[12:15], v[40:43], v[128:131]
    v_mfma_f32_16x16x32_bf16 v[132:135], a[12:15], v[44:47], v[132:135]
    v_mfma_f32_16x16x32_bf16 v[136:139], a[68:71], v[40:43], v[136:139]
    v_mfma_f32_16x16x32_bf16 v[140:143], a[68:71], v[44:47], v[140:143]
    v_mfma_f32_16x16x32_bf16 v[144:147], a[124:127], v[40:43], v[144:147]
    v_mfma_f32_16x16x32_bf16 v[148:151], a[124:127], v[44:47], v[148:151]
    v_mfma_f32_16x16x32_bf16 v[152:155], a[180:183], v[40:43], v[152:155]
    v_mfma_f32_16x16x32_bf16 v[156:159], a[180:183], v[44:47], v[156:159]
    s_waitcnt vmcnt(22)
    v_mfma_f32_16x16x32_bf16 v[128:131], a[16:19], v[48:51], v[128:131]
    v_mfma_f32_16x16x32_bf16 v[132:135], a[16:19], v[52:55], v[132:135]
    v_mfma_f32_16x16x32_bf16 v[136:139], a[72:75], v[48:51], v[136:139]
    v_mfma_f32_16x16x32_bf16 v[140:143], a[72:75], v[52:55], v[140:143]
    v_mfma_f32_16x16x32_bf16 v[144:147], a[128:131], v[48:51], v[144:147]
    v_mfma_f32_16x16x32_bf16 v[148:151], a[128:131], v[52:55], v[148:151]
    v_mfma_f32_16x16x32_bf16 v[152:155], a[184:187], v[48:51], v[152:155]
    v_mfma_f32_16x16x32_bf16 v[156:159], a[184:187], v[52:55], v[156:159]
    s_waitcnt vmcnt(20)
    v_mfma_f32_16x16x32_bf16 v[128:131], a[20:23], v[56:59], v[128:131]
    v_mfma_f32_16x16x32_bf16 v[132:135], a[20:23], v[60:63], v[132:135]
    v_mfma_f32_16x16x32_bf16 v[136:139], a[76:79], v[56:59], v[136:139]
    v_mfma_f32_16x16x32_bf16 v[140:143], a[76:79], v[60:63], v[140:143]
    v_mfma_f32_16x16x32_bf16 v[144:147], a[132:135], v[56:59], v[144:147]
    v_mfma_f32_16x16x32_bf16 v[148:151], a[132:135], v[60:63], v[148:151]
    v_mfma_f32_16x16x32_bf16 v[152:155], a[188:191], v[56:59], v[152:155]
    v_mfma_f32_16x16x32_bf16 v[156:159], a[188:191], v[60:63], v[156:159]
    s_waitcnt vmcnt(18)
    v_mfma_f32_16x16x32_bf16 v[128:131], a[24:27], v[64:67], v[128:131]
    v_mfma_f32_16x16x32_bf16 v[132:135], a[24:27], v[68:71], v[132:135]
    v_mfma_f32_16x16x32_bf16 v[136:139], a[80:83], v[64:67], v[136:139]
    v_mfma_f32_16x16x32_bf16 v[140:143], a[80:83], v[68:71], v[140:143]
    v_mfma_f32_16x16x32_bf16 v[144:147], a[136:139], v[64:67], v[144:147]
    v_mfma_f32_16x16x32_bf16 v[148:151], a[136:139], v[68:71], v[148:151]
    v_mfma_f32_16x16x32_bf16 v[152:155], a[192:195], v[64:67], v[152:155]
    v_mfma_f32_16x16x32_bf16 v[156:159], a[192:195], v[68:71], v[156:159]
    s_waitcnt vmcnt(16)
    v_mfma_f32_16x16x32_bf16 v[128:131], a[28:31], v[72:75], v[128:131]
    v_mfma_f32_16x16x32_bf16 v[132:135], a[28:31], v[76:79], v[132:135]
    v_mfma_f32_16x16x32_bf16 v[136:139], a[84:87], v[72:75], v[136:139]
    v_mfma_f32_16x16x32_bf16 v[140:143], a[84:87], v[76:79], v[140:143]
    v_mfma_f32_16x16x32_bf16 v[144:147], a[140:143], v[72:75], v[144:147]
    v_mfma_f32_16x16x32_bf16 v[148:151], a[140:143], v[76:79], v[148:151]
    v_mfma_f32_16x16x32_bf16 v[152:155], a[196:199], v[72:75], v[152:155]
    v_mfma_f32_16x16x32_bf16 v[156:159], a[196:199], v[76:79], v[156:159]
    s_waitcnt vmcnt(14)
    v_mfma_f32_16x16x32_bf16 v[128:131], a[32:35], v[80:83], v[128:131]
    v_mfma_f32_16x16x32_bf16 v[132:135], a[32:35], v[84:87], v[132:135]
    v_mfma_f32_16x16x32_bf16 v[136:139], a[88:91], v[80:83], v[136:139]
    v_mfma_f32_16x16x32_bf16 v[140:143], a[88:91], v[84:87], v[140:143]
    v_mfma_f32_16x16x32_bf16 v[144:147], a[144:147], v[80:83], v[144:147]
    v_mfma_f32_16x16x32_bf16 v[148:151], a[144:147], v[84:87], v[148:151]
    v_mfma_f32_16x16x32_bf16 v[152:155], a[200:203], v[80:83], v[152:155]
    v_mfma_f32_16x16x32_bf16 v[156:159], a[200:203], v[84:87], v[156:159]
    s_waitcnt vmcnt(12)
    v_mfma_f32_16x16x32_bf16 v[128:131], a[36:39], v[88:91], v[128:131]
    v_mfma_f32_16x16x32_bf16 v[132:135], a[36:39], v[92:95], v[132:135]
    v_mfma_f32_16x16x32_bf16 v[136:139], a[92:95], v[88:91], v[136:139]
    v_mfma_f32_16x16x32_bf16 v[140:143], a[92:95], v[92:95], v[140:143]
    v_mfma_f32_16x16x32_bf16 v[144:147], a[148:151], v[88:91], v[144:147]
    v_mfma_f32_16x16x32_bf16 v[148:151], a[148:151], v[92:95], v[148:151]
    v_mfma_f32_16x16x32_bf16 v[152:155], a[204:207], v[88:91], v[152:155]
    v_mfma_f32_16x16x32_bf16 v[156:159], a[204:207], v[92:95], v[156:159]
    s_waitcnt vmcnt(10)
    v_mfma_f32_16x16x32_bf16 v[128:131], a[40:43], v[96:99], v[128:131]
    v_mfma_f32_16x16x32_bf16 v[132:135], a[40:43], v[100:103], v[132:135]
    v_mfma_f32_16x16x32_bf16 v[136:139], a[96:99], v[96:99], v[136:139]
    v_mfma_f32_16x16x32_bf16 v[140:143], a[96:99], v[100:103], v[140:143]
    v_mfma_f32_16x16x32_bf16 v[144:147], a[152:155], v[96:99], v[144:147]
    v_mfma_f32_16x16x32_bf16 v[148:151], a[152:155], v[100:103], v[148:151]
    v_mfma_f32_16x16x32_bf16 v[152:155], a[208:211], v[96:99], v[152:155]
    v_mfma_f32_16x16x32_bf16 v[156:159], a[208:211], v[100:103], v[156:159]
    s_waitcnt vmcnt(8)
    v_mfma_f32_16x16x32_bf16 v[128:131], a[44:47], v[104:107], v[128:131]
    v_mfma_f32_16x16x32_bf16 v[132:135], a[44:47], v[108:111], v[132:135]
    v_mfma_f32_16x16x32_bf16 v[136:139], a[100:103], v[104:107], v[136:139]
    v_mfma_f32_16x16x32_bf16 v[140:143], a[100:103], v[108:111], v[140:143]
    v_mfma_f32_16x16x32_bf16 v[144:147], a[156:159], v[104:107], v[144:147]
    v_mfma_f32_16x16x32_bf16 v[148:151], a[156:159], v[108:111], v[148:151]
    v_mfma_f32_16x16x32_bf16 v[152:155], a[212:215], v[104:107], v[152:155]
    v_mfma_f32_16x16x32_bf16 v[156:159], a[212:215], v[108:111], v[156:159]
    s_waitcnt vmcnt(6)
    v_mfma_f32_16x16x32_bf16 v[128:131], a[48:51], v[112:115], v[128:131]
    v_mfma_f32_16x16x32_bf16 v[132:135], a[48:51], v[116:119], v[132:135]
    v_mfma_f32_16x16x32_bf16 v[136:139], a[104:107], v[112:115], v[136:139]
    v_mfma_f32_16x16x32_bf16 v[140:143], a[104:107], v[116:119], v[140:143]
    v_mfma_f32_16x16x32_bf16 v[144:147], a[160:163], v[112:115], v[144:147]
    v_mfma_f32_16x16x32_bf16 v[148:151], a[160:163], v[116:119], v[148:151]
    v_mfma_f32_16x16x32_bf16 v[152:155], a[216:219], v[112:115], v[152:155]
    v_mfma_f32_16x16x32_bf16 v[156:159], a[216:219], v[116:119], v[156:159]
    s_waitcnt vmcnt(4)
    v_mfma_f32_16x16x32_bf16 v[128:131], a[52:55], v[120:123], v[128:131]
    v_mfma_f32_16x16x32_bf16 v[132:135], a[52:55], v[124:127], v[132:135]
    v_mfma_f32_16x16x32_bf16 v[136:139], a[108:111], v[120:123], v[136:139]
    v_mfma_f32_16x16x32_bf16 v[140:143], a[108:111], v[124:127], v[140:143]
    v_mfma_f32_16x16x32_bf16 v[144:147], a[164:167], v[120:123], v[144:147]
    v_mfma_f32_16x16x32_bf16 v[148:151], a[164:167], v[124:127], v[148:151]
    v_mfma_f32_16x16x32_bf16 v[152:155], a[220:223], v[120:123], v[152:155]
    v_mfma_f32_16x16x32_bf16 v[156:159], a[220:223], v[124:127], v[156:159]
    s_nop 7
    v_cvt_pk_bf16_f32 v160, v128, v129
    v_cvt_pk_bf16_f32 v161, v130, v131
    v_cvt_pk_bf16_f32 v168, v132, v133
    v_cvt_pk_bf16_f32 v169, v134, v135
    v_cvt_pk_bf16_f32 v162, v136, v137
    v_cvt_pk_bf16_f32 v163, v138, v139
    v_cvt_pk_bf16_f32 v170, v140, v141
    v_cvt_pk_bf16_f32 v171, v142, v143
    v_cvt_pk_bf16_f32 v164, v144, v145
    v_cvt_pk_bf16_f32 v165, v146, v147
    v_cvt_pk_bf16_f32 v172, v148, v149
    v_cvt_pk_bf16_f32 v173, v150, v151
    v_cvt_pk_bf16_f32 v166, v152, v153
    v_cvt_pk_bf16_f32 v167, v154, v155
    v_cvt_pk_bf16_f32 v174, v156, v157
    v_cvt_pk_bf16_f32 v175, v158, v159
    s_waitcnt vmcnt(0)
    v_mfma_f32_16x16x32_bf16 v[192:195], v[176:179], v[160:163], 0
    v_mfma_f32_16x16x32_bf16 v[196:199], v[176:179], v[168:171], 0
    v_mfma_f32_16x16x32_bf16 v[200:203], v[184:187], v[168:171], 0
    v_mfma_f32_16x16x32_bf16 v[192:195], v[180:183], v[164:167], v[192:195]
    v_mfma_f32_16x16x32_bf16 v[196:199], v[180:183], v[172:175], v[196:199]
    v_mfma_f32_16x16x32_bf16 v[200:203], v[188:191], v[172:175], v[200:203]
    s_branch .chain_kernel_td83
.chain_kernel_t282:
    s_waitcnt vmcnt(30)
    v_mfma_f32_16x16x32_bf16 v[128:131], a[0:3], v[16:19], 0
    v_mfma_f32_16x16x32_bf16 v[132:135], a[0:3], v[20:23], 0
    v_mfma_f32_16x16x32_bf16 v[136:139], a[56:59], v[16:19], 0
    v_mfma_f32_16x16x32_bf16 v[140:143], a[56:59], v[20:23], 0
    s_waitcnt vmcnt(28)
    v_mfma_f32_16x16x32_bf16 v[128:131], a[4:7], v[24:27], v[128:131]
    v_mfma_f32_16x16x32_bf16 v[132:135], a[4:7], v[28:31], v[132:135]
    v_mfma_f32_16x16x32_bf16 v[136:139], a[60:63], v[24:27], v[136:139]
    v_mfma_f32_16x16x32_bf16 v[140:143], a[60:63], v[28:31], v[140:143]
    s_waitcnt vmcnt(26)
    v_mfma_f32_16x16x32_bf16 v[128:131], a[8:11], v[32:35], v[128:131]
    v_mfma_f32_16x16x32_bf16 v[132:135], a[8:11], v[36:39], v[132:135]
    v_mfma_f32_16x16x32_bf16 v[136:139], a[64:67], v[32:35], v[136:139]
    v_mfma_f32_16x16x32_bf16 v[140:143], a[64:67], v[36:39], v[140:143]
    s_waitcnt vmcnt(24)
    v_mfma_f32_16x16x32_bf16 v[128:131], a[12:15], v[40:43], v[128:131]
    v_mfma_f32_16x16x32_bf16 v[132:135], a[12:15], v[44:47], v[132:135]
    v_mfma_f32_16x16x32_bf16 v[136:139], a[68:71], v[40:43], v[136:139]
    v_mfma_f32_16x16x32_bf16 v[140:143], a[68:71], v[44:47], v[140:143]
    s_waitcnt vmcnt(22)
    v_mfma_f32_16x16x32_bf16 v[128:131], a[16:19], v[48:51], v[128:131]
    v_mfma_f32_16x16x32_bf16 v[132:135], a[16:19], v[52:55], v[132:135]
    v_mfma_f32_16x16x32_bf16 v[136:139], a[72:75], v[48:51], v[136:139]
    v_mfma_f32_16x16x32_bf16 v[140:143], a[72:75], v[52:55], v[140:143]
    s_waitcnt vmcnt(20)
    v_mfma_f32_16x16x32_bf16 v[128:131], a[20:23], v[56:59], v[128:131]
    v_mfma_f32_16x16x32_bf16 v[132:135], a[20:23], v[60:63], v[132:135]
    v_mfma_f32_16x16x32_bf16 v[136:139], a[76:79], v[56:59], v[136:139]
    v_mfma_f32_16x16x32_bf16 v[140:143], a[76:79], v[60:63], v[140:143]
    s_waitcnt vmcnt(18)
    v_mfma_f32_16x16x32_bf16 v[128:131], a[24:27], v[64:67], v[128:131]
    v_mfma_f32_16x16x32_bf16 v[132:135], a[24:27], v[68:71], v[132:135]
    v_mfma_f32_16x16x32_bf16 v[136:139], a[80:83], v[64:67], v[136:139]
    v_mfma_f32_16x16x32_bf16 v[140:143], a[80:83], v[68:71], v[140:143]
    s_waitcnt vmcnt(16)
    v_mfma_f32_16x16x32_bf16 v[128:131], a[28:31], v[72:75], v[128:131]
    v_mfma_f32_16x16x32_bf16 v[132:135], a[28:31], v[76:79], v[132:135]
    v_mfma_f32_16x16x32_bf16 v[136:139], a[84:87], v[72:75], v[136:139]
    v_mfma_f32_16x16x32_bf16 v[140:143], a[84:87], v[76:79], v[140:143]
    s_waitcnt vmcnt(14)
    v_mfma_f32_16x16x32_bf16 v[128:131], a[32:35], v[80:83], v[128:131]
    v_mfma_f32_16x16x32_bf16 v[132:135], a[32:35], v[84:87], v[132:135]
    v_mfma_f32_16x16x32_bf16 v[136:139], a[88:91], v[80:83], v[136:139]
    v_mfma_f32_16x16x32_bf16 v[140:143], a[88:91], v[84:87], v[140:143]
    s_waitcnt vmcnt(12)
    v_mfma_f32_16x16x32_bf16 v[128:131], a[36:39], v[88:91], v[128:131]
    v_mfma_f32_16x16x32_bf16 v[132:135], a[36:39], v[92:95], v[132:135]
    v_mfma_f32_16x16x32_bf16 v[136:139], a[92:95], v[88:91], v[136:139]
    v_mfma_f32_16x16x32_bf16 v[140:143], a[92:95], v[92:95], v[140:143]
    s_waitcnt vmcnt(10)
    v_mfma_f32_16x16x32_bf16 v[128:131], a[40:43], v[96:99], v[128:131]
    v_mfma_f32_16x16x32_bf16 v[132:135], a[40:43], v[100:103], v[132:135]
    v_mfma_f32_16x16x32_bf16 v[136:139], a[96:99], v[96:99], v[136:139]
    v_mfma_f32_16x16x32_bf16 v[140:143], a[96:99], v[100:103], v[140:143]
    s_waitcnt vmcnt(8)
    v_mfma_f32_16x16x32_bf16 v[128:131], a[44:47], v[104:107], v[128:131]
    v_mfma_f32_16x16x32_bf16 v[132:135], a[44:47], v[108:111], v[132:135]
    v_mfma_f32_16x16x32_bf16 v[136:139], a[100:103], v[104:107], v[136:139]
    v_mfma_f32_16x16x32_bf16 v[140:143], a[100:103], v[108:111], v[140:143]
    s_waitcnt vmcnt(6)
    v_mfma_f32_16x16x32_bf16 v[128:131], a[48:51], v[112:115], v[128:131]
    v_mfma_f32_16x16x32_bf16 v[132:135], a[48:51], v[116:119], v[132:135]
    v_mfma_f32_16x16x32_bf16 v[136:139], a[104:107], v[112:115], v[136:139]
    v_mfma_f32_16x16x32_bf16 v[140:143], a[104:107], v[116:119], v[140:143]
    s_waitcnt vmcnt(4)
    v_mfma_f32_16x16x32_bf16 v[128:131], a[52:55], v[120:123], v[128:131]
    v_mfma_f32_16x16x32_bf16 v[132:135], a[52:55], v[124:127], v[132:135]
    v_mfma_f32_16x16x32_bf16 v[136:139], a[108:111], v[120:123], v[136:139]
    v_mfma_f32_16x16x32_bf16 v[140:143], a[108:111], v[124:127], v[140:143]
    s_nop 7
    v_cvt_pk_bf16_f32 v160, v128, v129
    v_cvt_pk_bf16_f32 v161, v130, v131
    v_cvt_pk_bf16_f32 v168, v132, v133
    v_cvt_pk_bf16_f32 v169, v134, v135
    v_cvt_pk_bf16_f32 v162, v136, v137
    v_cvt_pk_bf16_f32 v163, v138, v139
    v_cvt_pk_bf16_f32 v170, v140, v141
    v_cvt_pk_bf16_f32 v171, v142, v143
    s_waitcnt vmcnt(0)
    v_mfma_f32_16x16x32_bf16 v[192:195], v[176:179], v[160:163], 0
    v_mfma_f32_16x16x32_bf16 v[196:199], v[176:179], v[168:171], 0
    v_mfma_f32_16x16x32_bf16 v[200:203], v[184:187], v[168:171], 0
.chain_kernel_td83:
    s_nop 7
    ds_write_b128 v8, v[192:195] offset:0
    ds_write_b128 v8, v[196:199] offset:1024
    ds_write_b128 v8, v[200:203] offset:2048
    s_waitcnt lgkmcnt(0)
    s_barrier
    s_cmp_eq_u32 s18, 3
    s_cbranch_scc1 .chain_kernel_np84
    ds_read_b128 v[208:211], v9 offset:0
    ds_read_b128 v[212:215], v9 offset:3072
    ds_read_b128 v[216:219], v9 offset:6144
    ds_read_b128 v[220:223], v9 offset:9216
    s_waitcnt lgkmcnt(0)
    v_pk_add_f32 v[208:209], v[208:209], v[212:213]
    v_pk_add_f32 v[210:211], v[210:211], v[214:215]
    v_pk_add_f32 v[208:209], v[208:209], v[216:217]
    v_pk_add_f32 v[210:211], v[210:211], v[218:219]
    v_pk_add_f32 v[208:209], v[208:209], v[220:221]
    v_pk_add_f32 v[210:211], v[210:211], v[222:223]
    global_store_dwordx4 v4, v[208:211], s[30:31] sc1
.chain_kernel_np84:
    s_barrier
    s_add_u32 s26, s26, 28672
    s_addc_u32 s27, s27, 0
    s_add_u32 s28, s28, 28672
    s_addc_u32 s29, s29, 0
    s_add_u32 s30, s30, 131072
    s_addc_u32 s31, s31, 0
    s_add_u32 s23, s23, 1
    s_cmp_lt_u32 s23, 8
    s_cbranch_scc1 .chain_kernel_loop81
    s_branch .chain_kernel_fin79
.chain_kernel_ty74:
    v_lshrrev_b32 v2, 6, v0
    v_and_b32 v1, 63, v0
    s_nop 0
    v_readfirstlane_b32 s18, v2
    v_lshrrev_b32 v2, 4, v1
    v_and_b32 v3, 15, v1
    s_lshr_b32 s21, s2, 1
    s_and_b32 s21, s21, 15
    s_and_b32 s22, s2, 1
    s_lshr_b32 s20, s2, 5
    v_lshlrev_b32 v4, 4, v1
    v_and_b32 v5, 7, v3
    v_lshl_add_u32 v5, v2, 3, v5
    v_lshlrev_b32 v5, 4, v5
    v_lshrrev_b32 v6, 3, v3
    v_mul_u32_u24 v6, 7168, v6
    v_add_u32 v5, v5, v6
    s_mul_i32 s38, s21, 28
    s_mul_i32 s39, s22, 14
    s_add_u32 s38, s38, s39
    s_lshl_b32 s39, s18, 2
    s_add_u32 s38, s38, s39
    s_mul_i32 s38, s38, 14336
    s_add_u32 s38, s38, 0x1a79000
    s_add_u32 s24, s16, s38
    s_addc_u32 s25, s17, 0
    global_load_dwordx4 a[0:3], v4, s[24:25] offset:0
    global_load_dwordx4 a[4:7], v4, s[24:25] offset:1024
    global_load_dwordx4 a[8:11], v4, s[24:25] offset:2048
    global_load_dwordx4 a[12:15], v4, s[24:25] offset:3072
    s_add_u32 s24, s24, 4096
    s_addc_u32 s25, s25, 0
    global_load_dwordx4 a[16:19], v4, s[24:25] offset:0
    global_load_dwordx4 a[20:23], v4, s[24:25] offset:1024
    global_load_dwordx4 a[24:27], v4, s[24:25] offset:2048
    global_load_dwordx4 a[28:31], v4, s[24:25] offset:3072
    s_add_u32 s24, s24, 4096
    s_addc_u32 s25, s25, 0
    global_load_dwordx4 a[32:35], v4, s[24:25] offset:0
    global_load_dwordx4 a[36:39], v4, s[24:25] offset:1024
    global_load_dwordx4 a[40:43], v4, s[24:25] offset:2048
    global_load_dwordx4 a[44:47], v4, s[24:25] offset:3072
    s_add_u32 s24, s24, 4096
    s_addc_u32 s25, s25, 0
    global_load_dwordx4 a[48:51], v4, s[24:25] offset:0
    global_load_dwordx4 a[52:55], v4, s[24:25] offset:1024
    global_load_dwordx4 a[56:59], v4, s[24:25] offset:2048
    global_load_dwordx4 a[60:63], v4, s[24:25] offset:3072
    s_add_u32 s24, s24, 4096
    s_addc_u32 s25, s25, 0
    global_load_dwordx4 a[64:67], v4, s[24:25] offset:0
    global_load_dwordx4 a[68:71], v4, s[24:25] offset:1024
    global_load_dwordx4 a[72:75], v4, s[24:25] offset:2048
    global_load_dwordx4 a[76:79], v4, s[24:25] offset:3072
    s_add_u32 s24, s24, 4096
    s_addc_u32 s25, s25, 0
    global_load_dwordx4 a[80:83], v4, s[24:25] offset:0
    global_load_dwordx4 a[84:87], v4, s[24:25] offset:1024
    global_load_dwordx4 a[88:91], v4, s[24:25] offset:2048
    global_load_dwordx4 a[92:95], v4, s[24:25] offset:3072
    s_add_u32 s24, s24, 4096
    s_addc_u32 s25, s25, 0
    global_load_dwordx4 a[96:99], v4, s[24:25] offset:0
    global_load_dwordx4 a[100:103], v4, s[24:25] offset:1024
    global_load_dwordx4 a[104:107], v4, s[24:25] offset:2048
    global_load_dwordx4 a[108:111], v4, s[24:25] offset:3072
    s_cmp_eq_u32 s18, 3
    s_cbranch_scc1 .chain_kernel_af285
    s_add_u32 s24, s24, 4096
    s_addc_u32 s25, s25, 0
    global_load_dwordx4 a[112:115], v4, s[24:25] offset:0
    global_load_dwordx4 a[116:119], v4, s[24:25] offset:1024
    global_load_dwordx4 a[120:123], v4, s[24:25] offset:2048
    global_load_dwordx4 a[124:127], v4, s[24:25] offset:3072
    s_add_u32 s24, s24, 4096
    s_addc_u32 s25, s25, 0
    global_load_dwordx4 a[128:131], v4, s[24:25] offset:0
    global_load_dwordx4 a[132:135], v4, s[24:25] offset:1024
    global_load_dwordx4 a[136:139], v4, s[24:25] offset:2048
    global_load_dwordx4 a[140:143], v4, s[24:25] offset:3072
    s_add_u32 s24, s24, 4096
    s_addc_u32 s25, s25, 0
    global_load_dwordx4 a[144:147], v4, s[24:25] offset:0
    global_load_dwordx4 a[148:151], v4, s[24:25] offset:1024
    global_load_dwordx4 a[152:155], v4, s[24:25] offset:2048
    global_load_dwordx4 a[156:159], v4, s[24:25] offset:3072
    s_add_u32 s24, s24, 4096
    s_addc_u32 s25, s25, 0
    global_load_dwordx4 a[160:163], v4, s[24:25] offset:0
    global_load_dwordx4 a[164:167], v4, s[24:25] offset:1024
    global_load_dwordx4 a[168:171], v4, s[24:25] offset:2048
    global_load_dwordx4 a[172:175], v4, s[24:25] offset:3072
    s_add_u32 s24, s24, 4096
    s_addc_u32 s25, s25, 0
    global_load_dwordx4 a[176:179], v4, s[24:25] offset:0
    global_load_dwordx4 a[180:183], v4, s[24:25] offset:1024
    global_load_dwordx4 a[184:187], v4, s[24:25] offset:2048
    global_load_dwordx4 a[188:191], v4, s[24:25] offset:3072
    s_add_u32 s24, s24, 4096
    s_addc_u32 s25, s25, 0
    global_load_dwordx4 a[192:195], v4, s[24:25] offset:0
    global_load_dwordx4 a[196:199], v4, s[24:25] offset:1024
    global_load_dwordx4 a[200:203], v4, s[24:25] offset:2048
    global_load_dwordx4 a[204:207], v4, s[24:25] offset:3072
    s_add_u32 s24, s24, 4096
    s_addc_u32 s25, s25, 0
    global_load_dwordx4 a[208:211], v4, s[24:25] offset:0
    global_load_dwordx4 a[212:215], v4, s[24:25] offset:1024
    global_load_dwordx4 a[216:219], v4, s[24:25] offset:2048
    global_load_dwordx4 a[220:223], v4, s[24:25] offset:3072
.chain_kernel_af285:
    s_mul_i32 s33, s22, 7
    s_lshl_b32 s39, s18, 1
    s_add_u32 s33, s33, s39
    s_mul_i32 s38, s20, 57344
    s_lshl_b32 s39, s33, 10
    s_add_u32 s38, s38, s39
    s_add_u32 s38, s38, 0x1000
    s_add_u32 s28, s16, s38
    s_addc_u32 s29, s17, 0
    global_load_dwordx4 v[104:107], v4, s[28:29]
    global_load_dwordx4 v[108:111], v4, s[28:29] offset:1024
    s_add_u32 s28, s28, 14336
    s_addc_u32 s29, s29, 0
    global_load_dwordx4 v[112:115], v4, s[28:29]
    global_load_dwordx4 v[116:119], v4, s[28:29] offset:1024
    s_add_u32 s28, s28, 14336
    s_addc_u32 s29, s29, 0
    global_load_dwordx4 v[120:123], v4, s[28:29]
    global_load_dwordx4 v[124:127], v4, s[28:29] offset:1024
    s_add_u32 s28, s28, 14336
    s_addc_u32 s29, s29, 0
    global_load_dwordx4 v[128:131], v4, s[28:29]
    global_load_dwordx4 v[132:135], v4, s[28:29] offset:1024
    s_add_u32 s28, s28, 14336
    s_addc_u32 s29, s29, 0
    s_cmp_lg_u32 s18, 0
    s_cbranch_scc1 .chain_kernel_dpx86
    s_lshl_b32 s88, s86, 2
    s_add_u32 s88, s88, 448
    s_mov_b64 exec, 1
    s_add_u32 s46, s16, 0x0
    s_addc_u32 s47, s17, 0
    v_mov_b32 v8, v10
    v_mov_b32 v9, v11
    v_mov_b32 v10, s88
    s_mov_b32 s45, 0
.chain_kernel_wc87:
    global_load_dword v11, v10, s[46:47] sc1
    s_waitcnt vmcnt(0)
    v_readfirstlane_b32 s38, v11
    s_nop 3
    s_cmp_ge_u32 s38, 29
    s_cbranch_scc1 .chain_kernel_wcd88
    s_sleep 14
    s_add_u32 s45, s45, 1
    s_cmp_lt_u32 s45, 1048576
    s_cbranch_scc1 .chain_kernel_wc87
    s_branch .chain_kernel_end1
.chain_kernel_wcd88:
    v_mov_b32 v10, v8
    v_mov_b32 v11, v9
    s_mov_b64 exec, -1
.chain_kernel_dpx86:
    s_barrier
    s_mul_i32 s38, s20, 14336
    s_add_u32 s38, s38, 0x472be00
    s_add_u32 s26, s16, s38
    s_addc_u32 s27, s17, 0
    global_load_dwordx4 v[16:19], v5, s[26:27] offset:-3584
    global_load_dwordx4 v[20:23], v5, s[26:27] offset:-3072
    global_load_dwordx4 v[24:27], v5, s[26:27] offset:-2560
    global_load_dwordx4 v[28:31], v5, s[26:27] offset:-2048
    global_load_dwordx4 v[32:35], v5, s[26:27] offset:-1536
    global_load_dwordx4 v[36:39], v5, s[26:27] offset:-1024
    global_load_dwordx4 v[40:43], v5, s[26:27] offset:-512
    global_load_dwordx4 v[44:47], v5, s[26:27] offset:0
    global_load_dwordx4 v[48:51], v5, s[26:27] offset:512
    global_load_dwordx4 v[52:55], v5, s[26:27] offset:1024
    global_load_dwordx4 v[56:59], v5, s[26:27] offset:1536
    global_load_dwordx4 v[60:63], v5, s[26:27] offset:2048
    global_load_dwordx4 v[64:67], v5, s[26:27] offset:2560
    global_load_dwordx4 v[68:71], v5, s[26:27] offset:3072
    s_lshl_b32 s38, s20, 2
    s_add_u32 s38, s38, s18
    s_lshl_b32 s38, s38, 4
    s_add_u32 s38, s38, s21
    s_lshl_b32 s38, s38, 1
    s_add_u32 s38, s38, s22
    s_lshl_b32 s38, s38, 10
    s_add_u32 s38, s38, 0x569d000
    s_add_u32 s30, s16, s38
    s_addc_u32 s31, s17, 0
    s_lshl_b32 s38, s18, 12
    v_add_u32 v8, s38, v4
    s_lshl_b32 s38, s18, 10
    v_add_u32 v9, s38, v4
    s_cmp_eq_u32 s18, 3
    s_cbranch_scc1 .chain_kernel_t289
    s_waitcnt vmcnt(13)
    v_mfma_f32_16x16x32_bf16 v[72:75], a[0:3], v[16:19], 0
    v_mfma_f32_16x16x32_bf16 v[76:79], a[56:59], v[16:19], 0
    v_mfma_f32_16x16x32_bf16 v[80:83], a[112:115], v[16:19], 0
    v_mfma_f32_16x16x32_bf16 v[84:87], a[168:171], v[16:19], 0
    s_waitcnt vmcnt(12)
    v_mfma_f32_16x16x32_bf16 v[72:75], a[4:7], v[20:23], v[72:75]
    v_mfma_f32_16x16x32_bf16 v[76:79], a[60:63], v[20:23], v[76:79]
    v_mfma_f32_16x16x32_bf16 v[80:83], a[116:119], v[20:23], v[80:83]
    v_mfma_f32_16x16x32_bf16 v[84:87], a[172:175], v[20:23], v[84:87]
    s_waitcnt vmcnt(11)
    v_mfma_f32_16x16x32_bf16 v[72:75], a[8:11], v[24:27], v[72:75]
    v_mfma_f32_16x16x32_bf16 v[76:79], a[64:67], v[24:27], v[76:79]
    v_mfma_f32_16x16x32_bf16 v[80:83], a[120:123], v[24:27], v[80:83]
    v_mfma_f32_16x16x32_bf16 v[84:87], a[176:179], v[24:27], v[84:87]
    s_waitcnt vmcnt(10)
    v_mfma_f32_16x16x32_bf16 v[72:75], a[12:15], v[28:31], v[72:75]
    v_mfma_f32_16x16x32_bf16 v[76:79], a[68:71], v[28:31], v[76:79]
    v_mfma_f32_16x16x32_bf16 v[80:83], a[124:127], v[28:31], v[80:83]
    v_mfma_f32_16x16x32_bf16 v[84:87], a[180:183], v[28:31], v[84:87]
    s_waitcnt vmcnt(9)
    v_mfma_f32_16x16x32_bf16 v[72:75], a[16:19], v[32:35], v[72:75]
    v_mfma_f32_16x16x32_bf16 v[76:79], a[72:75], v[32:35], v[76:79]
    v_mfma_f32_16x16x32_bf16 v[80:83], a[128:131], v[32:35], v[80:83]
    v_mfma_f32_16x16x32_bf16 v[84:87], a[184:187], v[32:35], v[84:87]
    s_waitcnt vmcnt(8)
    v_mfma_f32_16x16x32_bf16 v[72:75], a[20:23], v[36:39], v[72:75]
    v_mfma_f32_16x16x32_bf16 v[76:79], a[76:79], v[36:39], v[76:79]
    v_mfma_f32_16x16x32_bf16 v[80:83], a[132:135], v[36:39], v[80:83]
    v_mfma_f32_16x16x32_bf16 v[84:87], a[188:191], v[36:39], v[84:87]
    s_waitcnt vmcnt(7)
    v_mfma_f32_16x16x32_bf16 v[72:75], a[24:27], v[40:43], v[72:75]
    v_mfma_f32_16x16x32_bf16 v[76:79], a[80:83], v[40:43], v[76:79]
    v_mfma_f32_16x16x32_bf16 v[80:83], a[136:139], v[40:43], v[80:83]
    v_mfma_f32_16x16x32_bf16 v[84:87], a[192:195], v[40:43], v[84:87]
    s_waitcnt vmcnt(6)
    v_mfma_f32_16x16x32_bf16 v[72:75], a[28:31], v[44:47], v[72:75]
    v_mfma_f32_16x16x32_bf16 v[76:79], a[84:87], v[44:47], v[76:79]
    v_mfma_f32_16x16x32_bf16 v[80:83], a[140:143], v[44:47], v[80:83]
    v_mfma_f32_16x16x32_bf16 v[84:87], a[196:199], v[44:47], v[84:87]
    s_waitcnt vmcnt(5)
    v_mfma_f32_16x16x32_bf16 v[72:75], a[32:35], v[48:51], v[72:75]
    v_mfma_f32_16x16x32_bf16 v[76:79], a[88:91], v[48:51], v[76:79]
    v_mfma_f32_16x16x32_bf16 v[80:83], a[144:147], v[48:51], v[80:83]
    v_mfma_f32_16x16x32_bf16 v[84:87], a[200:203], v[48:51], v[84:87]
    s_waitcnt vmcnt(4)
    v_mfma_f32_16x16x32_bf16 v[72:75], a[36:39], v[52:55], v[72:75]
    v_mfma_f32_16x16x32_bf16 v[76:79], a[92:95], v[52:55], v[76:79]
    v_mfma_f32_16x16x32_bf16 v[80:83], a[148:151], v[52:55], v[80:83]
    v_mfma_f32_16x16x32_bf16 v[84:87], a[204:207], v[52:55], v[84:87]
    s_waitcnt vmcnt(3)
    v_mfma_f32_16x16x32_bf16 v[72:75], a[40:43], v[56:59], v[72:75]
    v_mfma_f32_16x16x32_bf16 v[76:79], a[96:99], v[56:59], v[76:79]
    v_mfma_f32_16x16x32_bf16 v[80:83], a[152:155], v[56:59], v[80:83]
    v_mfma_f32_16x16x32_bf16 v[84:87], a[208:211], v[56:59], v[84:87]
    s_waitcnt vmcnt(2)
    v_mfma_f32_16x16x32_bf16 v[72:75], a[44:47], v[60:63], v[72:75]
    v_mfma_f32_16x16x32_bf16 v[76:79], a[100:103], v[60:63], v[76:79]
    v_mfma_f32_16x16x32_bf16 v[80:83], a[156:159], v[60:63], v[80:83]
    v_mfma_f32_16x16x32_bf16 v[84:87], a[212:215], v[60:63], v[84:87]
    s_waitcnt vmcnt(1)
    v_mfma_f32_16x16x32_bf16 v[72:75], a[48:51], v[64:67], v[72:75]
    v_mfma_f32_16x16x32_bf16 v[76:79], a[104:107], v[64:67], v[76:79]
    v_mfma_f32_16x16x32_bf16 v[80:83], a[160:163], v[64:67], v[80:83]
    v_mfma_f32_16x16x32_bf16 v[84:87], a[216:219], v[64:67], v[84:87]
    s_waitcnt vmcnt(0)
    v_mfma_f32_16x16x32_bf16 v[72:75], a[52:55], v[68:71], v[72:75]
    v_mfma_f32_16x16x32_bf16 v[76:79], a[108:111], v[68:71], v[76:79]
    v_mfma_f32_16x16x32_bf16 v[80:83], a[164:167], v[68:71], v[80:83]
    v_mfma_f32_16x16x32_bf16 v[84:87], a[220:223], v[68:71], v[84:87]
    s_nop 7
    v_cvt_pk_bf16_f32 v88, v72, v73
    v_cvt_pk_bf16_f32 v89, v74, v75
    v_cvt_pk_bf16_f32 v90, v76, v77
    v_cvt_pk_bf16_f32 v91, v78, v79
    v_cvt_pk_bf16_f32 v92, v80, v81
    v_cvt_pk_bf16_f32 v93, v82, v83
    v_cvt_pk_bf16_f32 v94, v84, v85
    v_cvt_pk_bf16_f32 v95, v86, v87
    s_nop 1
    v_mfma_f32_16x16x32_bf16 v[136:139], v[88:91], v[104:107], 0
    v_mfma_f32_16x16x32_bf16 v[140:143], v[88:91], v[112:115], 0
    v_mfma_f32_16x16x32_bf16 v[144:147], v[88:91], v[120:123], 0
    v_mfma_f32_16x16x32_bf16 v[148:151], v[88:91], v[128:131], 0
    v_mfma_f32_16x16x32_bf16 v[136:139], v[92:95], v[108:111], v[136:139]
    v_mfma_f32_16x16x32_bf16 v[140:143], v[92:95], v[116:119], v[140:143]
    v_mfma_f32_16x16x32_bf16 v[144:147], v[92:95], v[124:127], v[144:147]
    v_mfma_f32_16x16x32_bf16 v[148:151], v[92:95], v[132:135], v[148:151]
    s_branch .chain_kernel_td90
.chain_kernel_t289:
    s_waitcnt vmcnt(13)
    v_mfma_f32_16x16x32_bf16 v[72:75], a[0:3], v[16:19], 0
    v_mfma_f32_16x16x32_bf16 v[76:79], a[56:59], v[16:19], 0
    s_waitcnt vmcnt(12)
    v_mfma_f32_16x16x32_bf16 v[72:75], a[4:7], v[20:23], v[72:75]
    v_mfma_f32_16x16x32_bf16 v[76:79], a[60:63], v[20:23], v[76:79]
    s_waitcnt vmcnt(11)
    v_mfma_f32_16x16x32_bf16 v[72:75], a[8:11], v[24:27], v[72:75]
    v_mfma_f32_16x16x32_bf16 v[76:79], a[64:67], v[24:27], v[76:79]
    s_waitcnt vmcnt(10)
    v_mfma_f32_16x16x32_bf16 v[72:75], a[12:15], v[28:31], v[72:75]
    v_mfma_f32_16x16x32_bf16 v[76:79], a[68:71], v[28:31], v[76:79]
    s_waitcnt vmcnt(9)
    v_mfma_f32_16x16x32_bf16 v[72:75], a[16:19], v[32:35], v[72:75]
    v_mfma_f32_16x16x32_bf16 v[76:79], a[72:75], v[32:35], v[76:79]
    s_waitcnt vmcnt(8)
    v_mfma_f32_16x16x32_bf16 v[72:75], a[20:23], v[36:39], v[72:75]
    v_mfma_f32_16x16x32_bf16 v[76:79], a[76:79], v[36:39], v[76:79]
    s_waitcnt vmcnt(7)
    v_mfma_f32_16x16x32_bf16 v[72:75], a[24:27], v[40:43], v[72:75]
    v_mfma_f32_16x16x32_bf16 v[76:79], a[80:83], v[40:43], v[76:79]
    s_waitcnt vmcnt(6)
    v_mfma_f32_16x16x32_bf16 v[72:75], a[28:31], v[44:47], v[72:75]
    v_mfma_f32_16x16x32_bf16 v[76:79], a[84:87], v[44:47], v[76:79]
    s_waitcnt vmcnt(5)
    v_mfma_f32_16x16x32_bf16 v[72:75], a[32:35], v[48:51], v[72:75]
    v_mfma_f32_16x16x32_bf16 v[76:79], a[88:91], v[48:51], v[76:79]
    s_waitcnt vmcnt(4)
    v_mfma_f32_16x16x32_bf16 v[72:75], a[36:39], v[52:55], v[72:75]
    v_mfma_f32_16x16x32_bf16 v[76:79], a[92:95], v[52:55], v[76:79]
    s_waitcnt vmcnt(3)
    v_mfma_f32_16x16x32_bf16 v[72:75], a[40:43], v[56:59], v[72:75]
    v_mfma_f32_16x16x32_bf16 v[76:79], a[96:99], v[56:59], v[76:79]
    s_waitcnt vmcnt(2)
    v_mfma_f32_16x16x32_bf16 v[72:75], a[44:47], v[60:63], v[72:75]
    v_mfma_f32_16x16x32_bf16 v[76:79], a[100:103], v[60:63], v[76:79]
    s_waitcnt vmcnt(1)
    v_mfma_f32_16x16x32_bf16 v[72:75], a[48:51], v[64:67], v[72:75]
    v_mfma_f32_16x16x32_bf16 v[76:79], a[104:107], v[64:67], v[76:79]
    s_waitcnt vmcnt(0)
    v_mfma_f32_16x16x32_bf16 v[72:75], a[52:55], v[68:71], v[72:75]
    v_mfma_f32_16x16x32_bf16 v[76:79], a[108:111], v[68:71], v[76:79]
    s_nop 7
    v_cvt_pk_bf16_f32 v88, v72, v73
    v_cvt_pk_bf16_f32 v89, v74, v75
    v_cvt_pk_bf16_f32 v90, v76, v77
    v_cvt_pk_bf16_f32 v91, v78, v79
    s_nop 1
    v_mfma_f32_16x16x32_bf16 v[136:139], v[88:91], v[104:107], 0
    v_mfma_f32_16x16x32_bf16 v[140:143], v[88:91], v[112:115], 0
    v_mfma_f32_16x16x32_bf16 v[144:147], v[88:91], v[120:123], 0
    v_mfma_f32_16x16x32_bf16 v[148:151], v[88:91], v[128:131], 0
.chain_kernel_td90:
    s_nop 7
    ds_write_b128 v8, v[136:139] offset:0
    ds_write_b128 v8, v[140:143] offset:1024
    ds_write_b128 v8, v[144:147] offset:2048
    ds_write_b128 v8, v[148:151] offset:3072
    s_waitcnt lgkmcnt(0)
    s_barrier
    ds_read_b128 v[152:155], v9 offset:0
    ds_read_b128 v[156:159], v9 offset:4096
    ds_read_b128 v[160:163], v9 offset:8192
    ds_read_b128 v[164:167], v9 offset:12288
    s_waitcnt lgkmcnt(0)
    v_pk_add_f32 v[152:153], v[152:153], v[156:157]
    v_pk_add_f32 v[154:155], v[154:155], v[158:159]
    v_pk_add_f32 v[152:153], v[152:153], v[160:161]
    v_pk_add_f32 v[154:155], v[154:155], v[162:163]
    v_pk_add_f32 v[152:153], v[152:153], v[164:165]
    v_pk_add_f32 v[154:155], v[154:155], v[166:167]
    global_store_dwordx4 v4, v[152:155], s[30:31] sc1
    s_branch .chain_kernel_fin79
.chain_kernel_ty75:
    s_load_dwordx2 s[4:5], s[0:1], 0
    v_lshrrev_b32 v2, 6, v0
    v_and_b32 v1, 63, v0
    s_nop 0
    v_readfirstlane_b32 s18, v2
    v_lshrrev_b32 v2, 4, v1
    v_and_b32 v3, 15, v1
    s_lshr_b32 s20, s2, 1
    s_and_b32 s21, s2, 1
    s_and_b32 s22, s20, 1
    s_lshr_b32 s23, s20, 1
    v_lshlrev_b32 v4, 4, v1
    v_add_u32 v13, 28672, v4
    v_add_u32 v14, 57344, v4
    v_add_u32 v15, 86016, v4
    v_lshlrev_b32 v5, 2, v2
    v_add_u32 v6, 0, v5
    v_cmp_le_u32 s[50:51], v6, v3
    v_add_u32 v6, 1, v5
    v_cmp_le_u32 s[52:53], v6, v3
    v_add_u32 v6, 2, v5
    v_cmp_le_u32 s[54:55], v6, v3
    v_add_u32 v6, 3, v5
    v_cmp_le_u32 s[56:57], v6, v3
    s_nop 1
    s_cmp_eq_u32 s21, 0
    s_cselect_b64 s[60:61], s[50:51], -1
    s_cselect_b64 s[70:71], 0, s[50:51]
    s_cselect_b64 s[62:63], s[52:53], -1
    s_cselect_b64 s[72:73], 0, s[52:53]
    s_cselect_b64 s[64:65], s[54:55], -1
    s_cselect_b64 s[74:75], 0, s[54:55]
    s_cselect_b64 s[66:67], s[56:57], -1
    s_cselect_b64 s[76:77], 0, s[56:57]
    s_mov_b32 s80, 0
    s_mov_b32 s81, -1
    s_cmp_eq_u32 s22, 0
    s_cselect_b32 s82, -1, 0
    s_cselect_b32 s83, 0, -1
    s_cselect_b64 s[84:85], 0, -1
    s_mov_b32 s49, 0x3db8aa3b
    v_mov_b32 v10, 0xff800000
    s_waitcnt lgkmcnt(0)
    s_lshl_b32 s38, s20, 4
    s_lshl_b32 s39, s18, 2
    s_add_u32 s38, s38, s39
    s_mul_i32 s38, s38, 28672
    s_add_u32 s38, s38, 0x26b9000
    s_add_u32 s26, s16, s38
    s_addc_u32 s27, s17, 0
    global_load_dwordx4 a[112:115], v4, s[26:27] offset:0
    global_load_dwordx4 a[116:119], v13, s[26:27] offset:0
    global_load_dwordx4 a[120:123], v14, s[26:27] offset:0
    global_load_dwordx4 a[124:127], v15, s[26:27] offset:0
    global_load_dwordx4 a[128:131], v4, s[26:27] offset:1024
    global_load_dwordx4 a[132:135], v13, s[26:27] offset:1024
    global_load_dwordx4 a[136:139], v14, s[26:27] offset:1024
    global_load_dwordx4 a[140:143], v15, s[26:27] offset:1024
    global_load_dwordx4 a[144:147], v4, s[26:27] offset:2048
    global_load_dwordx4 a[148:151], v13, s[26:27] offset:2048
    global_load_dwordx4 a[152:155], v14, s[26:27] offset:2048
    global_load_dwordx4 a[156:159], v15, s[26:27] offset:2048
    global_load_dwordx4 a[160:163], v4, s[26:27] offset:3072
    global_load_dwordx4 a[164:167], v13, s[26:27] offset:3072
    global_load_dwordx4 a[168:171], v14, s[26:27] offset:3072
    global_load_dwordx4 a[172:175], v15, s[26:27] offset:3072
    s_add_u32 s26, s26, 4096
    s_addc_u32 s27, s27, 0
    global_load_dwordx4 a[176:179], v4, s[26:27] offset:0
    global_load_dwordx4 a[180:183], v13, s[26:27] offset:0
    global_load_dwordx4 a[184:187], v14, s[26:27] offset:0
    global_load_dwordx4 a[188:191], v15, s[26:27] offset:0
    global_load_dwordx4 a[192:195], v4, s[26:27] offset:1024
    global_load_dwordx4 a[196:199], v13, s[26:27] offset:1024
    global_load_dwordx4 a[200:203], v14, s[26:27] offset:1024
    global_load_dwordx4 a[204:207], v15, s[26:27] offset:1024
    global_load_dwordx4 a[208:211], v4, s[26:27] offset:2048
    global_load_dwordx4 a[212:215], v13, s[26:27] offset:2048
    global_load_dwordx4 a[216:219], v14, s[26:27] offset:2048
    global_load_dwordx4 a[220:223], v15, s[26:27] offset:2048
    global_load_dwordx4 a[224:227], v4, s[26:27] offset:3072
    global_load_dwordx4 a[228:231], v13, s[26:27] offset:3072
    global_load_dwordx4 a[232:235], v14, s[26:27] offset:3072
    global_load_dwordx4 a[236:239], v15, s[26:27] offset:3072
    s_add_u32 s26, s26, 4096
    s_addc_u32 s27, s27, 0
    global_load_dwordx4 a[240:243], v4, s[26:27] offset:0
    global_load_dwordx4 a[244:247], v13, s[26:27] offset:0
    global_load_dwordx4 a[248:251], v14, s[26:27] offset:0
    global_load_dwordx4 a[252:255], v15, s[26:27] offset:0
    global_load_dwordx4 v[144:147], v4, s[26:27] offset:1024
    global_load_dwordx4 v[148:151], v13, s[26:27] offset:1024
    global_load_dwordx4 v[152:155], v14, s[26:27] offset:1024
    global_load_dwordx4 v[156:159], v15, s[26:27] offset:1024
    global_load_dwordx4 v[160:163], v4, s[26:27] offset:2048
    global_load_dwordx4 v[164:167], v13, s[26:27] offset:2048
    global_load_dwordx4 v[168:171], v14, s[26:27] offset:2048
    global_load_dwordx4 v[172:175], v15, s[26:27] offset:2048
    global_load_dwordx4 v[176:179], v4, s[26:27] offset:3072
    global_load_dwordx4 v[180:183], v13, s[26:27] offset:3072
    global_load_dwordx4 v[184:187], v14, s[26:27] offset:3072
    global_load_dwordx4 v[188:191], v15, s[26:27] offset:3072
    s_add_u32 s26, s26, 4096
    s_addc_u32 s27, s27, 0
    global_load_dwordx4 v[192:195], v4, s[26:27] offset:0
    global_load_dwordx4 v[196:199], v13, s[26:27] offset:0
    global_load_dwordx4 v[200:203], v14, s[26:27] offset:0
    global_load_dwordx4 v[204:207], v15, s[26:27] offset:0
    global_load_dwordx4 v[208:211], v4, s[26:27] offset:1024
    global_load_dwordx4 v[212:215], v13, s[26:27] offset:1024
    global_load_dwordx4 v[216:219], v14, s[26:27] offset:1024
    global_load_dwordx4 v[220:223], v15, s[26:27] offset:1024
    global_load_dwordx4 v[224:227], v4, s[26:27] offset:2048
    global_load_dwordx4 v[228:231], v13, s[26:27] offset:2048
    global_load_dwordx4 v[232:235], v14, s[26:27] offset:2048
    global_load_dwordx4 v[236:239], v15, s[26:27] offset:2048
    global_load_dwordx4 v[240:243], v4, s[26:27] offset:3072
    global_load_dwordx4 v[244:247], v13, s[26:27] offset:3072
    global_load_dwordx4 v[248:251], v14, s[26:27] offset:3072
    global_load_dwordx4 v[252:255], v15, s[26:27] offset:3072
    s_cmp_lg_u32 s18, 0
    s_cbranch_scc1 .chain_kernel_dpx91
    s_lshr_b32 s88, s2, 4
    s_lshl_b32 s88, s88, 2
    s_add_u32 s88, s88, 512
    s_mov_b64 exec, 1
    s_add_u32 s46, s16, 0x0
    s_addc_u32 s47, s17, 0
    v_mov_b32 v8, v10
    v_mov_b32 v9, v11
    v_mov_b32 v10, s88
    s_mov_b32 s45, 0
.chain_kernel_wc92:
    global_load_dword v11, v10, s[46:47] sc1
    s_waitcnt vmcnt(0)
    v_readfirstlane_b32 s38, v11
    s_nop 3
    s_cmp_ge_u32 s38, 128
    s_cbranch_scc1 .chain_kernel_wcd93
    s_sleep 14
    s_add_u32 s45, s45, 1
    s_cmp_lt_u32 s45, 1048576
    s_cbranch_scc1 .chain_kernel_wc92
    s_branch .chain_kernel_end1
.chain_kernel_wcd93:
    s_lshr_b32 s88, s2, 4
    s_lshl_b32 s88, s88, 2
    s_add_u32 s88, s88, 384
    v_mov_b32 v10, s88
    s_mov_b32 s45, 0
.chain_kernel_wc94:
    global_load_dword v11, v10, s[46:47] sc1
    s_waitcnt vmcnt(0)
    v_readfirstlane_b32 s38, v11
    s_nop 3
    s_cmp_ge_u32 s38, 32
    s_cbranch_scc1 .chain_kernel_wcd95
    s_sleep 14
    s_add_u32 s45, s45, 1
    s_cmp_lt_u32 s45, 1048576
    s_cbranch_scc1 .chain_kernel_wc94
    s_branch .chain_kernel_end1
.chain_kernel_wcd95:
    v_mov_b32 v10, v8
    v_mov_b32 v11, v9
    s_mov_b64 exec, -1
.chain_kernel_dpx91:
    s_barrier
    s_lshl_b32 s38, s20, 4
    s_lshl_b32 s39, s18, 2
    s_add_u32 s38, s38, s39
    s_lshl_b32 s38, s38, 3
    s_add_u32 s38, s38, s21
    s_lshl_b32 s38, s38, 10
    s_add_u32 s38, s38, 0x4e9d000
    s_add_u32 s28, s16, s38
    s_addc_u32 s29, s17, 0
    s_lshl_b32 s38, s2, 4
    s_lshl_b32 s39, s18, 2
    s_add_u32 s38, s38, s39
    s_lshl_b32 s38, s38, 11
    s_add_u32 s38, s38, 0x569d000
    s_add_u32 s32, s16, s38
    s_addc_u32 s33, s17, 0
    s_add_u32 s30, s28, 0x1000
    s_addc_u32 s31, s29, 0
    global_load_dwordx4 v[16:19], v4, s[28:29]
    global_load_dwordx4 v[20:23], v4, s[30:31]
    global_load_dwordx4 v[24:27], v4, s[28:29] offset:2048
    global_load_dwordx4 v[28:31], v4, s[30:31] offset:2048
    global_load_dwordx4 v[80:83], v4, s[32:33] offset:0
    global_load_dwordx4 v[84:87], v4, s[32:33] offset:1024
    s_add_u32 s28, s28, 8192
    s_addc_u32 s29, s29, 0
    s_add_u32 s30, s28, 0x1000
    s_addc_u32 s31, s29, 0
    global_load_dwordx4 v[32:35], v4, s[28:29]
    global_load_dwordx4 v[36:39], v4, s[30:31]
    global_load_dwordx4 v[40:43], v4, s[28:29] offset:2048
    global_load_dwordx4 v[44:47], v4, s[30:31] offset:2048
    global_load_dwordx4 v[88:91], v4, s[32:33] offset:2048
    global_load_dwordx4 v[92:95], v4, s[32:33] offset:3072
    s_add_u32 s28, s28, 8192
    s_addc_u32 s29, s29, 0
    s_add_u32 s32, s32, 4096
    s_addc_u32 s33, s33, 0
    s_add_u32 s30, s28, 0x1000
    s_addc_u32 s31, s29, 0
    global_load_dwordx4 v[48:51], v4, s[28:29]
    global_load_dwordx4 v[52:55], v4, s[30:31]
    global_load_dwordx4 v[56:59], v4, s[28:29] offset:2048
    global_load_dwordx4 v[60:63], v4, s[30:31] offset:2048
    global_load_dwordx4 v[96:99], v4, s[32:33] offset:0
    global_load_dwordx4 v[100:103], v4, s[32:33] offset:1024
    s_add_u32 s28, s28, 8192
    s_addc_u32 s29, s29, 0
    s_add_u32 s30, s28, 0x1000
    s_addc_u32 s31, s29, 0
    global_load_dwordx4 v[64:67], v4, s[28:29]
    global_load_dwordx4 v[68:71], v4, s[30:31]
    global_load_dwordx4 v[72:75], v4, s[28:29] offset:2048
    global_load_dwordx4 v[76:79], v4, s[30:31] offset:2048
    global_load_dwordx4 v[104:107], v4, s[32:33] offset:2048
    global_load_dwordx4 v[108:111], v4, s[32:33] offset:3072
    s_add_u32 s28, s28, 8192
    s_addc_u32 s29, s29, 0
    s_waitcnt vmcnt(18)
    v_pk_add_f32 v[16:17], v[16:17], v[20:21]
    v_pk_add_f32 v[18:19], v[18:19], v[22:23]
    v_pk_add_f32 v[24:25], v[24:25], v[28:29]
    v_pk_add_f32 v[26:27], v[26:27], v[30:31]
    v_pk_add_f32 v[80:81], v[80:81], v[84:85]
    v_pk_add_f32 v[82:83], v[82:83], v[86:87]
    v_cndmask_b32 v16, v10, v16, s[60:61]
    v_cndmask_b32 v24, v10, v24, s[70:71]
    v_cndmask_b32 v17, v10, v17, s[62:63]
    v_cndmask_b32 v25, v10, v25, s[72:73]
    v_cndmask_b32 v18, v10, v18, s[64:65]
    v_cndmask_b32 v26, v10, v26, s[74:75]
    v_cndmask_b32 v19, v10, v19, s[66:67]
    v_cndmask_b32 v27, v10, v27, s[76:77]
    v_cndmask_b32 v80, v10, v80, s[82:83]
    v_cndmask_b32 v81, v10, v81, s[82:83]
    v_cndmask_b32 v82, v10, v82, s[82:83]
    v_cndmask_b32 v83, v10, v83, s[82:83]
    v_max3_f32 v20, v16, v17, v18
    v_max3_f32 v20, v20, v19, v24
    v_max3_f32 v20, v20, v25, v26
    v_max3_f32 v20, v20, v27, v80
    v_max3_f32 v20, v20, v81, v82
    v_max_f32 v20, v20, v83
    v_mov_b32 v21, v20
    s_nop 1
    v_permlane32_swap_b32 v20, v21
    s_nop 1
    v_max_f32 v20, v20, v21
    v_mov_b32 v21, v20
    s_nop 1
    v_permlane16_swap_b32 v20, v21
    s_nop 1
    v_max_f32 v20, v20, v21
    v_mul_f32 v20, s49, v20
    v_fma_f32 v16, v16, s49, -v20
    v_fma_f32 v17, v17, s49, -v20
    v_fma_f32 v18, v18, s49, -v20
    v_fma_f32 v19, v19, s49, -v20
    v_fma_f32 v24, v24, s49, -v20
    v_fma_f32 v25, v25, s49, -v20
    v_fma_f32 v26, v26, s49, -v20
    v_fma_f32 v27, v27, s49, -v20
    v_fma_f32 v80, v80, s49, -v20
    v_fma_f32 v81, v81, s49, -v20
    v_fma_f32 v82, v82, s49, -v20
    v_fma_f32 v83, v83, s49, -v20
    v_exp_f32 v16, v16
    v_exp_f32 v17, v17
    v_exp_f32 v18, v18
    v_exp_f32 v19, v19
    v_exp_f32 v24, v24
    v_exp_f32 v25, v25
    v_exp_f32 v26, v26
    v_exp_f32 v27, v27
    v_exp_f32 v80, v80
    v_exp_f32 v81, v81
    v_exp_f32 v82, v82
    v_exp_f32 v83, v83
    s_nop 0
    v_add_f32 v22, v16, v17
    v_add_f32 v22, v22, v18
    v_add_f32 v22, v22, v19
    v_add_f32 v22, v22, v24
    v_add_f32 v22, v22, v25
    v_add_f32 v22, v22, v26
    v_add_f32 v22, v22, v27
    v_add_f32 v22, v22, v80
    v_add_f32 v22, v22, v81
    v_add_f32 v22, v22, v82
    v_add_f32 v22, v22, v83
    v_mov_b32 v21, v22
    s_nop 1
    v_permlane32_swap_b32 v22, v21
    s_nop 1
    v_add_f32 v22, v22, v21
    v_mov_b32 v21, v22
    s_nop 1
    v_permlane16_swap_b32 v22, v21
    s_nop 1
    v_add_f32 v22, v22, v21
    v_rcp_f32 v22, v22
    s_nop 0
    v_mul_f32 v16, v16, v22
    v_mul_f32 v17, v17, v22
    v_mul_f32 v18, v18, v22
    v_mul_f32 v19, v19, v22
    v_mul_f32 v24, v24, v22
    v_mul_f32 v25, v25, v22
    v_mul_f32 v26, v26, v22
    v_mul_f32 v27, v27, v22
    v_mul_f32 v80, v80, v22
    v_mul_f32 v81, v81, v22
    v_mul_f32 v82, v82, v22
    v_mul_f32 v83, v83, v22
    v_cvt_pk_bf16_f32 v112, v16, v17
    v_cvt_pk_bf16_f32 v113, v18, v19
    v_cvt_pk_bf16_f32 v114, v24, v25
    v_cvt_pk_bf16_f32 v115, v26, v27
    v_cvt_pk_bf16_f32 v128, v80, v81
    v_cvt_pk_bf16_f32 v129, v82, v83
    v_mov_b32 v20, v128
    v_mov_b32 v21, v129
    s_nop 1
    v_permlane32_swap_b32 v128, v20
    v_permlane32_swap_b32 v129, v21
    s_nop 1
    v_cndmask_b32 v128, v128, v20, s[84:85]
    v_cndmask_b32 v129, v129, v21, s[84:85]
    s_waitcnt vmcnt(12)
    v_pk_add_f32 v[32:33], v[32:33], v[36:37]
    v_pk_add_f32 v[34:35], v[34:35], v[38:39]
    v_pk_add_f32 v[40:41], v[40:41], v[44:45]
    v_pk_add_f32 v[42:43], v[42:43], v[46:47]
    v_pk_add_f32 v[88:89], v[88:89], v[92:93]
    v_pk_add_f32 v[90:91], v[90:91], v[94:95]
    v_cndmask_b32 v32, v10, v32, s[60:61]
    v_cndmask_b32 v40, v10, v40, s[70:71]
    v_cndmask_b32 v33, v10, v33, s[62:63]
    v_cndmask_b32 v41, v10, v41, s[72:73]
    v_cndmask_b32 v34, v10, v34, s[64:65]
    v_cndmask_b32 v42, v10, v42, s[74:75]
    v_cndmask_b32 v35, v10, v35, s[66:67]
    v_cndmask_b32 v43, v10, v43, s[76:77]
    v_cndmask_b32 v88, v10, v88, s[82:83]
    v_cndmask_b32 v89, v10, v89, s[82:83]
    v_cndmask_b32 v90, v10, v90, s[82:83]
    v_cndmask_b32 v91, v10, v91, s[82:83]
    v_max3_f32 v36, v32, v33, v34
    v_max3_f32 v36, v36, v35, v40
    v_max3_f32 v36, v36, v41, v42
    v_max3_f32 v36, v36, v43, v88
    v_max3_f32 v36, v36, v89, v90
    v_max_f32 v36, v36, v91
    v_mov_b32 v37, v36
    s_nop 1
    v_permlane32_swap_b32 v36, v37
    s_nop 1
    v_max_f32 v36, v36, v37
    v_mov_b32 v37, v36
    s_nop 1
    v_permlane16_swap_b32 v36, v37
    s_nop 1
    v_max_f32 v36, v36, v37
    v_mul_f32 v36, s49, v36
    v_fma_f32 v32, v32, s49, -v36
    v_fma_f32 v33, v33, s49, -v36
    v_fma_f32 v34, v34, s49, -v36
    v_fma_f32 v35, v35, s49, -v36
    v_fma_f32 v40, v40, s49, -v36
    v_fma_f32 v41, v41, s49, -v36
    v_fma_f32 v42, v42, s49, -v36
    v_fma_f32 v43, v43, s49, -v36
    v_fma_f32 v88, v88, s49, -v36
    v_fma_f32 v89, v89, s49, -v36
    v_fma_f32 v90, v90, s49, -v36
    v_fma_f32 v91, v91, s49, -v36
    v_exp_f32 v32, v32
    v_exp_f32 v33, v33
    v_exp_f32 v34, v34
    v_exp_f32 v35, v35
    v_exp_f32 v40, v40
    v_exp_f32 v41, v41
    v_exp_f32 v42, v42
    v_exp_f32 v43, v43
    v_exp_f32 v88, v88
    v_exp_f32 v89, v89
    v_exp_f32 v90, v90
    v_exp_f32 v91, v91
    s_nop 0
    v_add_f32 v38, v32, v33
    v_add_f32 v38, v38, v34
    v_add_f32 v38, v38, v35
    v_add_f32 v38, v38, v40
    v_add_f32 v38, v38, v41
    v_add_f32 v38, v38, v42
    v_add_f32 v38, v38, v43
    v_add_f32 v38, v38, v88
    v_add_f32 v38, v38, v89
    v_add_f32 v38, v38, v90
    v_add_f32 v38, v38, v91
    v_mov_b32 v37, v38
    s_nop 1
    v_permlane32_swap_b32 v38, v37
    s_nop 1
    v_add_f32 v38, v38, v37
    v_mov_b32 v37, v38
    s_nop 1
    v_permlane16_swap_b32 v38, v37
    s_nop 1
    v_add_f32 v38, v38, v37
    v_rcp_f32 v38, v38
    s_nop 0
    v_mul_f32 v32, v32, v38
    v_mul_f32 v33, v33, v38
    v_mul_f32 v34, v34, v38
    v_mul_f32 v35, v35, v38
    v_mul_f32 v40, v40, v38
    v_mul_f32 v41, v41, v38
    v_mul_f32 v42, v42, v38
    v_mul_f32 v43, v43, v38
    v_mul_f32 v88, v88, v38
    v_mul_f32 v89, v89, v38
    v_mul_f32 v90, v90, v38
    v_mul_f32 v91, v91, v38
    v_cvt_pk_bf16_f32 v116, v32, v33
    v_cvt_pk_bf16_f32 v117, v34, v35
    v_cvt_pk_bf16_f32 v118, v40, v41
    v_cvt_pk_bf16_f32 v119, v42, v43
    v_cvt_pk_bf16_f32 v130, v88, v89
    v_cvt_pk_bf16_f32 v131, v90, v91
    v_mov_b32 v36, v130
    v_mov_b32 v37, v131
    s_nop 1
    v_permlane32_swap_b32 v130, v36
    v_permlane32_swap_b32 v131, v37
    s_nop 1
    v_cndmask_b32 v130, v130, v36, s[84:85]
    v_cndmask_b32 v131, v131, v37, s[84:85]
    s_waitcnt vmcnt(6)
    v_pk_add_f32 v[48:49], v[48:49], v[52:53]
    v_pk_add_f32 v[50:51], v[50:51], v[54:55]
    v_pk_add_f32 v[56:57], v[56:57], v[60:61]
    v_pk_add_f32 v[58:59], v[58:59], v[62:63]
    v_pk_add_f32 v[96:97], v[96:97], v[100:101]
    v_pk_add_f32 v[98:99], v[98:99], v[102:103]
    v_cndmask_b32 v48, v10, v48, s[60:61]
    v_cndmask_b32 v56, v10, v56, s[70:71]
    v_cndmask_b32 v49, v10, v49, s[62:63]
    v_cndmask_b32 v57, v10, v57, s[72:73]
    v_cndmask_b32 v50, v10, v50, s[64:65]
    v_cndmask_b32 v58, v10, v58, s[74:75]
    v_cndmask_b32 v51, v10, v51, s[66:67]
    v_cndmask_b32 v59, v10, v59, s[76:77]
    v_cndmask_b32 v96, v10, v96, s[82:83]
    v_cndmask_b32 v97, v10, v97, s[82:83]
    v_cndmask_b32 v98, v10, v98, s[82:83]
    v_cndmask_b32 v99, v10, v99, s[82:83]
    v_max3_f32 v52, v48, v49, v50
    v_max3_f32 v52, v52, v51, v56
    v_max3_f32 v52, v52, v57, v58
    v_max3_f32 v52, v52, v59, v96
    v_max3_f32 v52, v52, v97, v98
    v_max_f32 v52, v52, v99
    v_mov_b32 v53, v52
    s_nop 1
    v_permlane32_swap_b32 v52, v53
    s_nop 1
    v_max_f32 v52, v52, v53
    v_mov_b32 v53, v52
    s_nop 1
    v_permlane16_swap_b32 v52, v53
    s_nop 1
    v_max_f32 v52, v52, v53
    v_mul_f32 v52, s49, v52
    v_fma_f32 v48, v48, s49, -v52
    v_fma_f32 v49, v49, s49, -v52
    v_fma_f32 v50, v50, s49, -v52
    v_fma_f32 v51, v51, s49, -v52
    v_fma_f32 v56, v56, s49, -v52
    v_fma_f32 v57, v57, s49, -v52
    v_fma_f32 v58, v58, s49, -v52
    v_fma_f32 v59, v59, s49, -v52
    v_fma_f32 v96, v96, s49, -v52
    v_fma_f32 v97, v97, s49, -v52
    v_fma_f32 v98, v98, s49, -v52
    v_fma_f32 v99, v99, s49, -v52
    v_exp_f32 v48, v48
    v_exp_f32 v49, v49
    v_exp_f32 v50, v50
    v_exp_f32 v51, v51
    v_exp_f32 v56, v56
    v_exp_f32 v57, v57
    v_exp_f32 v58, v58
    v_exp_f32 v59, v59
    v_exp_f32 v96, v96
    v_exp_f32 v97, v97
    v_exp_f32 v98, v98
    v_exp_f32 v99, v99
    s_nop 0
    v_add_f32 v54, v48, v49
    v_add_f32 v54, v54, v50
    v_add_f32 v54, v54, v51
    v_add_f32 v54, v54, v56
    v_add_f32 v54, v54, v57
    v_add_f32 v54, v54, v58
    v_add_f32 v54, v54, v59
    v_add_f32 v54, v54, v96
    v_add_f32 v54, v54, v97
    v_add_f32 v54, v54, v98
    v_add_f32 v54, v54, v99
    v_mov_b32 v53, v54
    s_nop 1
    v_permlane32_swap_b32 v54, v53
    s_nop 1
    v_add_f32 v54, v54, v53
    v_mov_b32 v53, v54
    s_nop 1
    v_permlane16_swap_b32 v54, v53
    s_nop 1
    v_add_f32 v54, v54, v53
    v_rcp_f32 v54, v54
    s_nop 0
    v_mul_f32 v48, v48, v54
    v_mul_f32 v49, v49, v54
    v_mul_f32 v50, v50, v54
    v_mul_f32 v51, v51, v54
    v_mul_f32 v56, v56, v54
    v_mul_f32 v57, v57, v54
    v_mul_f32 v58, v58, v54
    v_mul_f32 v59, v59, v54
    v_mul_f32 v96, v96, v54
    v_mul_f32 v97, v97, v54
    v_mul_f32 v98, v98, v54
    v_mul_f32 v99, v99, v54
    v_cvt_pk_bf16_f32 v120, v48, v49
    v_cvt_pk_bf16_f32 v121, v50, v51
    v_cvt_pk_bf16_f32 v122, v56, v57
    v_cvt_pk_bf16_f32 v123, v58, v59
    v_cvt_pk_bf16_f32 v132, v96, v97
    v_cvt_pk_bf16_f32 v133, v98, v99
    v_mov_b32 v52, v132
    v_mov_b32 v53, v133
    s_nop 1
    v_permlane32_swap_b32 v132, v52
    v_permlane32_swap_b32 v133, v53
    s_nop 1
    v_cndmask_b32 v132, v132, v52, s[84:85]
    v_cndmask_b32 v133, v133, v53, s[84:85]
    s_waitcnt vmcnt(0)
    v_pk_add_f32 v[64:65], v[64:65], v[68:69]
    v_pk_add_f32 v[66:67], v[66:67], v[70:71]
    v_pk_add_f32 v[72:73], v[72:73], v[76:77]
    v_pk_add_f32 v[74:75], v[74:75], v[78:79]
    v_pk_add_f32 v[104:105], v[104:105], v[108:109]
    v_pk_add_f32 v[106:107], v[106:107], v[110:111]
    v_cndmask_b32 v64, v10, v64, s[60:61]
    v_cndmask_b32 v72, v10, v72, s[70:71]
    v_cndmask_b32 v65, v10, v65, s[62:63]
    v_cndmask_b32 v73, v10, v73, s[72:73]
    v_cndmask_b32 v66, v10, v66, s[64:65]
    v_cndmask_b32 v74, v10, v74, s[74:75]
    v_cndmask_b32 v67, v10, v67, s[66:67]
    v_cndmask_b32 v75, v10, v75, s[76:77]
    v_cndmask_b32 v104, v10, v104, s[82:83]
    v_cndmask_b32 v105, v10, v105, s[82:83]
    v_cndmask_b32 v106, v10, v106, s[82:83]
    v_cndmask_b32 v107, v10, v107, s[82:83]
    v_max3_f32 v68, v64, v65, v66
    v_max3_f32 v68, v68, v67, v72
    v_max3_f32 v68, v68, v73, v74
    v_max3_f32 v68, v68, v75, v104
    v_max3_f32 v68, v68, v105, v106
    v_max_f32 v68, v68, v107
    v_mov_b32 v69, v68
    s_nop 1
    v_permlane32_swap_b32 v68, v69
    s_nop 1
    v_max_f32 v68, v68, v69
    v_mov_b32 v69, v68
    s_nop 1
    v_permlane16_swap_b32 v68, v69
    s_nop 1
    v_max_f32 v68, v68, v69
    v_mul_f32 v68, s49, v68
    v_fma_f32 v64, v64, s49, -v68
    v_fma_f32 v65, v65, s49, -v68
    v_fma_f32 v66, v66, s49, -v68
    v_fma_f32 v67, v67, s49, -v68
    v_fma_f32 v72, v72, s49, -v68
    v_fma_f32 v73, v73, s49, -v68
    v_fma_f32 v74, v74, s49, -v68
    v_fma_f32 v75, v75, s49, -v68
    v_fma_f32 v104, v104, s49, -v68
    v_fma_f32 v105, v105, s49, -v68
    v_fma_f32 v106, v106, s49, -v68
    v_fma_f32 v107, v107, s49, -v68
    v_exp_f32 v64, v64
    v_exp_f32 v65, v65
    v_exp_f32 v66, v66
    v_exp_f32 v67, v67
    v_exp_f32 v72, v72
    v_exp_f32 v73, v73
    v_exp_f32 v74, v74
    v_exp_f32 v75, v75
    v_exp_f32 v104, v104
    v_exp_f32 v105, v105
    v_exp_f32 v106, v106
    v_exp_f32 v107, v107
    s_nop 0
    v_add_f32 v70, v64, v65
    v_add_f32 v70, v70, v66
    v_add_f32 v70, v70, v67
    v_add_f32 v70, v70, v72
    v_add_f32 v70, v70, v73
    v_add_f32 v70, v70, v74
    v_add_f32 v70, v70, v75
    v_add_f32 v70, v70, v104
    v_add_f32 v70, v70, v105
    v_add_f32 v70, v70, v106
    v_add_f32 v70, v70, v107
    v_mov_b32 v69, v70
    s_nop 1
    v_permlane32_swap_b32 v70, v69
    s_nop 1
    v_add_f32 v70, v70, v69
    v_mov_b32 v69, v70
    s_nop 1
    v_permlane16_swap_b32 v70, v69
    s_nop 1
    v_add_f32 v70, v70, v69
    v_rcp_f32 v70, v70
    s_nop 0
    v_mul_f32 v64, v64, v70
    v_mul_f32 v65, v65, v70
    v_mul_f32 v66, v66, v70
    v_mul_f32 v67, v67, v70
    v_mul_f32 v72, v72, v70
    v_mul_f32 v73, v73, v70
    v_mul_f32 v74, v74, v70
    v_mul_f32 v75, v75, v70
    v_mul_f32 v104, v104, v70
    v_mul_f32 v105, v105, v70
    v_mul_f32 v106, v106, v70
    v_mul_f32 v107, v107, v70
    v_cvt_pk_bf16_f32 v124, v64, v65
    v_cvt_pk_bf16_f32 v125, v66, v67
    v_cvt_pk_bf16_f32 v126, v72, v73
    v_cvt_pk_bf16_f32 v127, v74, v75
    v_cvt_pk_bf16_f32 v134, v104, v105
    v_cvt_pk_bf16_f32 v135, v106, v107
    v_mov_b32 v68, v134
    v_mov_b32 v69, v135
    s_nop 1
    v_permlane32_swap_b32 v134, v68
    v_permlane32_swap_b32 v135, v69
    s_nop 1
    v_cndmask_b32 v134, v134, v68, s[84:85]
    v_cndmask_b32 v135, v135, v69, s[84:85]
    v_cndmask_b32 v136, v128, v132, s[80:81]
    v_cndmask_b32 v137, v129, v133, s[80:81]
    v_cndmask_b32 v138, v130, v134, s[80:81]
    v_cndmask_b32 v139, v131, v135, s[80:81]
    s_lshl_b32 s38, s20, 2
    s_add_u32 s38, s38, s18
    s_mul_i32 s38, s38, 28672
    s_add_u32 s38, s38, 0x479d000
    s_add_u32 s28, s16, s38
    s_addc_u32 s29, s17, 0
    global_load_dwordx4 v[16:19], v4, s[28:29] offset:0
    global_load_dwordx4 v[20:23], v4, s[28:29] offset:1024
    global_load_dwordx4 v[24:27], v4, s[28:29] offset:2048
    global_load_dwordx4 v[28:31], v4, s[28:29] offset:3072
    s_add_u32 s28, s28, 4096
    s_addc_u32 s29, s29, 0
    global_load_dwordx4 v[32:35], v4, s[28:29] offset:0
    global_load_dwordx4 v[36:39], v4, s[28:29] offset:1024
    global_load_dwordx4 v[40:43], v4, s[28:29] offset:2048
    global_load_dwordx4 v[44:47], v4, s[28:29] offset:3072
    s_add_u32 s28, s28, 4096
    s_addc_u32 s29, s29, 0
    global_load_dwordx4 v[48:51], v4, s[28:29] offset:0
    global_load_dwordx4 v[52:55], v4, s[28:29] offset:1024
    global_load_dwordx4 v[56:59], v4, s[28:29] offset:2048
    global_load_dwordx4 v[60:63], v4, s[28:29] offset:3072
    s_add_u32 s28, s28, 4096
    s_addc_u32 s29, s29, 0
    global_load_dwordx4 v[64:67], v4, s[28:29] offset:0
    global_load_dwordx4 v[68:71], v4, s[28:29] offset:1024
    global_load_dwordx4 v[72:75], v4, s[28:29] offset:2048
    global_load_dwordx4 v[76:79], v4, s[28:29] offset:3072
    s_add_u32 s28, s28, 4096
    s_addc_u32 s29, s29, 0
    global_load_dwordx4 v[80:83], v4, s[28:29] offset:0
    s_add_u32 s26, s26, 4096
    s_addc_u32 s27, s27, 0
    global_load_dwordx4 v[84:87], v4, s[26:27] offset:0
    global_load_dwordx4 v[88:91], v13, s[26:27] offset:0
    global_load_dwordx4 v[92:95], v14, s[26:27] offset:0
    v_mfma_f32_16x16x32_bf16 a[0:3], a[112:115], v[112:115], 0
    v_mfma_f32_16x16x32_bf16 a[0:3], a[116:119], v[116:119], a[0:3]
    v_mfma_f32_16x16x32_bf16 a[0:3], a[120:123], v[120:123], a[0:3]
    v_mfma_f32_16x16x32_bf16 a[0:3], a[124:127], v[124:127], a[0:3]
    s_waitcnt vmcnt(19)
    v_mfma_f32_16x16x32_bf16 a[0:3], v[16:19], v[136:139], a[0:3]
    global_load_dwordx4 v[96:99], v15, s[26:27] offset:0
    v_mfma_f32_16x16x32_bf16 a[4:7], a[128:131], v[112:115], 0
    v_mfma_f32_16x16x32_bf16 a[4:7], a[132:135], v[116:119], a[4:7]
    v_mfma_f32_16x16x32_bf16 a[4:7], a[136:139], v[120:123], a[4:7]
    v_mfma_f32_16x16x32_bf16 a[4:7], a[140:143], v[124:127], a[4:7]
    s_waitcnt vmcnt(19)
    v_mfma_f32_16x16x32_bf16 a[4:7], v[20:23], v[136:139], a[4:7]
    global_load_dwordx4 v[100:103], v4, s[28:29] offset:1024
    v_mfma_f32_16x16x32_bf16 a[8:11], a[144:147], v[112:115], 0
    v_mfma_f32_16x16x32_bf16 a[8:11], a[148:151], v[116:119], a[8:11]
    v_mfma_f32_16x16x32_bf16 a[8:11], a[152:155], v[120:123], a[8:11]
    v_mfma_f32_16x16x32_bf16 a[8:11], a[156:159], v[124:127], a[8:11]
    s_waitcnt vmcnt(19)
    v_mfma_f32_16x16x32_bf16 a[8:11], v[24:27], v[136:139], a[8:11]
    global_load_dwordx4 v[104:107], v4, s[26:27] offset:1024
    v_mfma_f32_16x16x32_bf16 a[12:15], a[160:163], v[112:115], 0
    v_mfma_f32_16x16x32_bf16 a[12:15], a[164:167], v[116:119], a[12:15]
    v_mfma_f32_16x16x32_bf16 a[12:15], a[168:171], v[120:123], a[12:15]
    v_mfma_f32_16x16x32_bf16 a[12:15], a[172:175], v[124:127], a[12:15]
    s_waitcnt vmcnt(19)
    v_mfma_f32_16x16x32_bf16 a[12:15], v[28:31], v[136:139], a[12:15]
    global_load_dwordx4 v[108:111], v13, s[26:27] offset:1024
    v_mfma_f32_16x16x32_bf16 a[16:19], a[176:179], v[112:115], 0
    v_mfma_f32_16x16x32_bf16 a[16:19], a[180:183], v[116:119], a[16:19]
    v_mfma_f32_16x16x32_bf16 a[16:19], a[184:187], v[120:123], a[16:19]
    v_mfma_f32_16x16x32_bf16 a[16:19], a[188:191], v[124:127], a[16:19]
    s_waitcnt vmcnt(19)
    v_mfma_f32_16x16x32_bf16 a[16:19], v[32:35], v[136:139], a[16:19]
    global_load_dwordx4 v[16:19], v14, s[26:27] offset:1024
    v_mfma_f32_16x16x32_bf16 a[20:23], a[192:195], v[112:115], 0
    v_mfma_f32_16x16x32_bf16 a[20:23], a[196:199], v[116:119], a[20:23]
    v_mfma_f32_16x16x32_bf16 a[20:23], a[200:203], v[120:123], a[20:23]
    v_mfma_f32_16x16x32_bf16 a[20:23], a[204:207], v[124:127], a[20:23]
    s_waitcnt vmcnt(19)
    v_mfma_f32_16x16x32_bf16 a[20:23], v[36:39], v[136:139], a[20:23]
    global_load_dwordx4 v[20:23], v15, s[26:27] offset:1024
    v_mfma_f32_16x16x32_bf16 a[24:27], a[208:211], v[112:115], 0
    v_mfma_f32_16x16x32_bf16 a[24:27], a[212:215], v[116:119], a[24:27]
    v_mfma_f32_16x16x32_bf16 a[24:27], a[216:219], v[120:123], a[24:27]
    v_mfma_f32_16x16x32_bf16 a[24:27], a[220:223], v[124:127], a[24:27]
    s_waitcnt vmcnt(19)
    v_mfma_f32_16x16x32_bf16 a[24:27], v[40:43], v[136:139], a[24:27]
    global_load_dwordx4 v[24:27], v4, s[28:29] offset:2048
    v_mfma_f32_16x16x32_bf16 a[28:31], a[224:227], v[112:115], 0
    v_mfma_f32_16x16x32_bf16 a[28:31], a[228:231], v[116:119], a[28:31]
    v_mfma_f32_16x16x32_bf16 a[28:31], a[232:235], v[120:123], a[28:31]
    v_mfma_f32_16x16x32_bf16 a[28:31], a[236:239], v[124:127], a[28:31]
    s_waitcnt vmcnt(19)
    v_mfma_f32_16x16x32_bf16 a[28:31], v[44:47], v[136:139], a[28:31]
    global_load_dwordx4 v[28:31], v4, s[26:27] offset:2048
    v_mfma_f32_16x16x32_bf16 a[32:35], a[240:243], v[112:115], 0
    v_mfma_f32_16x16x32_bf16 a[32:35], a[244:247], v[116:119], a[32:35]
    v_mfma_f32_16x16x32_bf16 a[32:35], a[248:251], v[120:123], a[32:35]
    v_mfma_f32_16x16x32_bf16 a[32:35], a[252:255], v[124:127], a[32:35]
    s_waitcnt vmcnt(19)
    v_mfma_f32_16x16x32_bf16 a[32:35], v[48:51], v[136:139], a[32:35]
    global_load_dwordx4 v[32:35], v13, s[26:27] offset:2048
    v_mfma_f32_16x16x32_bf16 a[36:39], v[144:147], v[112:115], 0
    v_mfma_f32_16x16x32_bf16 a[36:39], v[148:151], v[116:119], a[36:39]
    v_mfma_f32_16x16x32_bf16 a[36:39], v[152:155], v[120:123], a[36:39]
    v_mfma_f32_16x16x32_bf16 a[36:39], v[156:159], v[124:127], a[36:39]
    s_waitcnt vmcnt(19)
    v_mfma_f32_16x16x32_bf16 a[36:39], v[52:55], v[136:139], a[36:39]
    global_load_dwordx4 v[36:39], v14, s[26:27] offset:2048
    v_mfma_f32_16x16x32_bf16 a[40:43], v[160:163], v[112:115], 0
    v_mfma_f32_16x16x32_bf16 a[40:43], v[164:167], v[116:119], a[40:43]
    v_mfma_f32_16x16x32_bf16 a[40:43], v[168:171], v[120:123], a[40:43]
    v_mfma_f32_16x16x32_bf16 a[40:43], v[172:175], v[124:127], a[40:43]
    s_waitcnt vmcnt(19)
    v_mfma_f32_16x16x32_bf16 a[40:43], v[56:59], v[136:139], a[40:43]
    global_load_dwordx4 v[40:43], v15, s[26:27] offset:2048
    v_mfma_f32_16x16x32_bf16 a[44:47], v[176:179], v[112:115], 0
    v_mfma_f32_16x16x32_bf16 a[44:47], v[180:183], v[116:119], a[44:47]
    v_mfma_f32_16x16x32_bf16 a[44:47], v[184:187], v[120:123], a[44:47]
    v_mfma_f32_16x16x32_bf16 a[44:47], v[188:191], v[124:127], a[44:47]
    s_waitcnt vmcnt(19)
    v_mfma_f32_16x16x32_bf16 a[44:47], v[60:63], v[136:139], a[44:47]
    global_load_dwordx4 v[44:47], v4, s[28:29] offset:3072
    v_mfma_f32_16x16x32_bf16 a[48:51], v[192:195], v[112:115], 0
    v_mfma_f32_16x16x32_bf16 a[48:51], v[196:199], v[116:119], a[48:51]
    v_mfma_f32_16x16x32_bf16 a[48:51], v[200:203], v[120:123], a[48:51]
    v_mfma_f32_16x16x32_bf16 a[48:51], v[204:207], v[124:127], a[48:51]
    s_waitcnt vmcnt(19)
    v_mfma_f32_16x16x32_bf16 a[48:51], v[64:67], v[136:139], a[48:51]
    global_load_dwordx4 v[48:51], v4, s[26:27] offset:3072
    v_mfma_f32_16x16x32_bf16 a[52:55], v[208:211], v[112:115], 0
    v_mfma_f32_16x16x32_bf16 a[52:55], v[212:215], v[116:119], a[52:55]
    v_mfma_f32_16x16x32_bf16 a[52:55], v[216:219], v[120:123], a[52:55]
    v_mfma_f32_16x16x32_bf16 a[52:55], v[220:223], v[124:127], a[52:55]
    s_waitcnt vmcnt(19)
    v_mfma_f32_16x16x32_bf16 a[52:55], v[68:71], v[136:139], a[52:55]
    global_load_dwordx4 v[52:55], v13, s[26:27] offset:3072
    v_mfma_f32_16x16x32_bf16 a[56:59], v[224:227], v[112:115], 0
    v_mfma_f32_16x16x32_bf16 a[56:59], v[228:231], v[116:119], a[56:59]
    v_mfma_f32_16x16x32_bf16 a[56:59], v[232:235], v[120:123], a[56:59]
    v_mfma_f32_16x16x32_bf16 a[56:59], v[236:239], v[124:127], a[56:59]
    s_waitcnt vmcnt(19)
    v_mfma_f32_16x16x32_bf16 a[56:59], v[72:75], v[136:139], a[56:59]
    global_load_dwordx4 v[56:59], v14, s[26:27] offset:3072
    v_mfma_f32_16x16x32_bf16 a[60:63], v[240:243], v[112:115], 0
    v_mfma_f32_16x16x32_bf16 a[60:63], v[244:247], v[116:119], a[60:63]
    v_mfma_f32_16x16x32_bf16 a[60:63], v[248:251], v[120:123], a[60:63]
    v_mfma_f32_16x16x32_bf16 a[60:63], v[252:255], v[124:127], a[60:63]
    s_waitcnt vmcnt(19)
    v_mfma_f32_16x16x32_bf16 a[60:63], v[76:79], v[136:139], a[60:63]
    global_load_dwordx4 v[60:63], v15, s[26:27] offset:3072
    s_waitcnt vmcnt(18)
    v_mfma_f32_16x16x32_bf16 a[64:67], v[84:87], v[112:115], 0
    s_waitcnt vmcnt(17)
    v_mfma_f32_16x16x32_bf16 a[64:67], v[88:91], v[116:119], a[64:67]
    s_waitcnt vmcnt(16)
    v_mfma_f32_16x16x32_bf16 a[64:67], v[92:95], v[120:123], a[64:67]
    s_waitcnt vmcnt(15)
    v_mfma_f32_16x16x32_bf16 a[64:67], v[96:99], v[124:127], a[64:67]
    s_waitcnt vmcnt(19)
    v_mfma_f32_16x16x32_bf16 a[64:67], v[80:83], v[136:139], a[64:67]
    s_add_u32 s28, s28, 4096
    s_addc_u32 s29, s29, 0
    global_load_dwordx4 v[64:67], v4, s[28:29] offset:0
    s_add_u32 s26, s26, 4096
    s_addc_u32 s27, s27, 0
    global_load_dwordx4 v[68:71], v4, s[26:27] offset:0
    global_load_dwordx4 v[72:75], v13, s[26:27] offset:0
    global_load_dwordx4 v[76:79], v14, s[26:27] offset:0
    global_load_dwordx4 v[80:83], v15, s[26:27] offset:0
    s_waitcnt vmcnt(18)
    v_mfma_f32_16x16x32_bf16 a[68:71], v[104:107], v[112:115], 0
    s_waitcnt vmcnt(17)
    v_mfma_f32_16x16x32_bf16 a[68:71], v[108:111], v[116:119], a[68:71]
    s_waitcnt vmcnt(16)
    v_mfma_f32_16x16x32_bf16 a[68:71], v[16:19], v[120:123], a[68:71]
    s_waitcnt vmcnt(15)
    v_mfma_f32_16x16x32_bf16 a[68:71], v[20:23], v[124:127], a[68:71]
    s_waitcnt vmcnt(19)
    v_mfma_f32_16x16x32_bf16 a[68:71], v[100:103], v[136:139], a[68:71]
    global_load_dwordx4 v[84:87], v4, s[28:29] offset:1024
    global_load_dwordx4 v[88:91], v4, s[26:27] offset:1024
    global_load_dwordx4 v[92:95], v13, s[26:27] offset:1024
    global_load_dwordx4 v[96:99], v14, s[26:27] offset:1024
    global_load_dwordx4 v[100:103], v15, s[26:27] offset:1024
    s_waitcnt vmcnt(18)
    v_mfma_f32_16x16x32_bf16 a[72:75], v[28:31], v[112:115], 0
    s_waitcnt vmcnt(17)
    v_mfma_f32_16x16x32_bf16 a[72:75], v[32:35], v[116:119], a[72:75]
    s_waitcnt vmcnt(16)
    v_mfma_f32_16x16x32_bf16 a[72:75], v[36:39], v[120:123], a[72:75]
    s_waitcnt vmcnt(15)
    v_mfma_f32_16x16x32_bf16 a[72:75], v[40:43], v[124:127], a[72:75]
    s_waitcnt vmcnt(19)
    v_mfma_f32_16x16x32_bf16 a[72:75], v[24:27], v[136:139], a[72:75]
    global_load_dwordx4 v[104:107], v4, s[28:29] offset:2048
    global_load_dwordx4 v[108:111], v4, s[26:27] offset:2048
    global_load_dwordx4 v[16:19], v13, s[26:27] offset:2048
    global_load_dwordx4 v[20:23], v14, s[26:27] offset:2048
    global_load_dwordx4 v[24:27], v15, s[26:27] offset:2048
    s_waitcnt vmcnt(18)
    v_mfma_f32_16x16x32_bf16 a[76:79], v[48:51], v[112:115], 0
    s_waitcnt vmcnt(17)
    v_mfma_f32_16x16x32_bf16 a[76:79], v[52:55], v[116:119], a[76:79]
    s_waitcnt vmcnt(16)
    v_mfma_f32_16x16x32_bf16 a[76:79], v[56:59], v[120:123], a[76:79]
    s_waitcnt vmcnt(15)
    v_mfma_f32_16x16x32_bf16 a[76:79], v[60:63], v[124:127], a[76:79]
    s_waitcnt vmcnt(19)
    v_mfma_f32_16x16x32_bf16 a[76:79], v[44:47], v[136:139], a[76:79]
    global_load_dwordx4 v[28:31], v4, s[28:29] offset:3072
    global_load_dwordx4 v[32:35], v4, s[26:27] offset:3072
    global_load_dwordx4 v[36:39], v13, s[26:27] offset:3072
    global_load_dwordx4 v[40:43], v14, s[26:27] offset:3072
    global_load_dwordx4 v[44:47], v15, s[26:27] offset:3072
    s_waitcnt vmcnt(18)
    v_mfma_f32_16x16x32_bf16 a[80:83], v[68:71], v[112:115], 0
    s_waitcnt vmcnt(17)
    v_mfma_f32_16x16x32_bf16 a[80:83], v[72:75], v[116:119], a[80:83]
    s_waitcnt vmcnt(16)
    v_mfma_f32_16x16x32_bf16 a[80:83], v[76:79], v[120:123], a[80:83]
    s_waitcnt vmcnt(15)
    v_mfma_f32_16x16x32_bf16 a[80:83], v[80:83], v[124:127], a[80:83]
    s_waitcnt vmcnt(19)
    v_mfma_f32_16x16x32_bf16 a[80:83], v[64:67], v[136:139], a[80:83]
    s_add_u32 s28, s28, 4096
    s_addc_u32 s29, s29, 0
    global_load_dwordx4 v[48:51], v4, s[28:29] offset:0
    s_add_u32 s26, s26, 4096
    s_addc_u32 s27, s27, 0
    global_load_dwordx4 v[52:55], v4, s[26:27] offset:0
    global_load_dwordx4 v[56:59], v13, s[26:27] offset:0
    global_load_dwordx4 v[60:63], v14, s[26:27] offset:0
    global_load_dwordx4 v[64:67], v15, s[26:27] offset:0
    s_waitcnt vmcnt(18)
    v_mfma_f32_16x16x32_bf16 a[84:87], v[88:91], v[112:115], 0
    s_waitcnt vmcnt(17)
    v_mfma_f32_16x16x32_bf16 a[84:87], v[92:95], v[116:119], a[84:87]
    s_waitcnt vmcnt(16)
    v_mfma_f32_16x16x32_bf16 a[84:87], v[96:99], v[120:123], a[84:87]
    s_waitcnt vmcnt(15)
    v_mfma_f32_16x16x32_bf16 a[84:87], v[100:103], v[124:127], a[84:87]
    s_waitcnt vmcnt(19)
    v_mfma_f32_16x16x32_bf16 a[84:87], v[84:87], v[136:139], a[84:87]
    global_load_dwordx4 v[68:71], v4, s[28:29] offset:1024
    global_load_dwordx4 v[72:75], v4, s[26:27] offset:1024
    global_load_dwordx4 v[76:79], v13, s[26:27] offset:1024
    global_load_dwordx4 v[80:83], v14, s[26:27] offset:1024
    global_load_dwordx4 v[84:87], v15, s[26:27] offset:1024
    s_waitcnt vmcnt(18)
    v_mfma_f32_16x16x32_bf16 a[88:91], v[108:111], v[112:115], 0
    s_waitcnt vmcnt(17)
    v_mfma_f32_16x16x32_bf16 a[88:91], v[16:19], v[116:119], a[88:91]
    s_waitcnt vmcnt(16)
    v_mfma_f32_16x16x32_bf16 a[88:91], v[20:23], v[120:123], a[88:91]
    s_waitcnt vmcnt(15)
    v_mfma_f32_16x16x32_bf16 a[88:91], v[24:27], v[124:127], a[88:91]
    s_waitcnt vmcnt(19)
    v_mfma_f32_16x16x32_bf16 a[88:91], v[104:107], v[136:139], a[88:91]
    global_load_dwordx4 v[88:91], v4, s[28:29] offset:2048
    global_load_dwordx4 v[92:95], v4, s[26:27] offset:2048
    global_load_dwordx4 v[96:99], v13, s[26:27] offset:2048
    global_load_dwordx4 v[100:103], v14, s[26:27] offset:2048
    global_load_dwordx4 v[104:107], v15, s[26:27] offset:2048
    s_waitcnt vmcnt(18)
    v_mfma_f32_16x16x32_bf16 a[92:95], v[32:35], v[112:115], 0
    s_waitcnt vmcnt(17)
    v_mfma_f32_16x16x32_bf16 a[92:95], v[36:39], v[116:119], a[92:95]
    s_waitcnt vmcnt(16)
    v_mfma_f32_16x16x32_bf16 a[92:95], v[40:43], v[120:123], a[92:95]
    s_waitcnt vmcnt(15)
    v_mfma_f32_16x16x32_bf16 a[92:95], v[44:47], v[124:127], a[92:95]
    s_waitcnt vmcnt(19)
    v_mfma_f32_16x16x32_bf16 a[92:95], v[28:31], v[136:139], a[92:95]
    global_load_dwordx4 v[108:111], v4, s[28:29] offset:3072
    global_load_dwordx4 v[16:19], v4, s[26:27] offset:3072
    global_load_dwordx4 v[20:23], v13, s[26:27] offset:3072
    global_load_dwordx4 v[24:27], v14, s[26:27] offset:3072
    global_load_dwordx4 v[28:31], v15, s[26:27] offset:3072
    s_waitcnt vmcnt(18)
    v_mfma_f32_16x16x32_bf16 a[96:99], v[52:55], v[112:115], 0
    s_waitcnt vmcnt(17)
    v_mfma_f32_16x16x32_bf16 a[96:99], v[56:59], v[116:119], a[96:99]
    s_waitcnt vmcnt(16)
    v_mfma_f32_16x16x32_bf16 a[96:99], v[60:63], v[120:123], a[96:99]
    s_waitcnt vmcnt(15)
    v_mfma_f32_16x16x32_bf16 a[96:99], v[64:67], v[124:127], a[96:99]
    s_waitcnt vmcnt(19)
    v_mfma_f32_16x16x32_bf16 a[96:99], v[48:51], v[136:139], a[96:99]
    s_waitcnt vmcnt(13)
    v_mfma_f32_16x16x32_bf16 a[100:103], v[72:75], v[112:115], 0
    s_waitcnt vmcnt(12)
    v_mfma_f32_16x16x32_bf16 a[100:103], v[76:79], v[116:119], a[100:103]
    s_waitcnt vmcnt(11)
    v_mfma_f32_16x16x32_bf16 a[100:103], v[80:83], v[120:123], a[100:103]
    s_waitcnt vmcnt(10)
    v_mfma_f32_16x16x32_bf16 a[100:103], v[84:87], v[124:127], a[100:103]
    s_waitcnt vmcnt(14)
    v_mfma_f32_16x16x32_bf16 a[100:103], v[68:71], v[136:139], a[100:103]
    s_waitcnt vmcnt(8)
    v_mfma_f32_16x16x32_bf16 a[104:107], v[92:95], v[112:115], 0
    s_waitcnt vmcnt(7)
    v_mfma_f32_16x16x32_bf16 a[104:107], v[96:99], v[116:119], a[104:107]
    s_waitcnt vmcnt(6)
    v_mfma_f32_16x16x32_bf16 a[104:107], v[100:103], v[120:123], a[104:107]
    s_waitcnt vmcnt(5)
    v_mfma_f32_16x16x32_bf16 a[104:107], v[104:107], v[124:127], a[104:107]
    s_waitcnt vmcnt(9)
    v_mfma_f32_16x16x32_bf16 a[104:107], v[88:91], v[136:139], a[104:107]
    s_waitcnt vmcnt(3)
    v_mfma_f32_16x16x32_bf16 a[108:111], v[16:19], v[112:115], 0
    s_waitcnt vmcnt(2)
    v_mfma_f32_16x16x32_bf16 a[108:111], v[20:23], v[116:119], a[108:111]
    s_waitcnt vmcnt(1)
    v_mfma_f32_16x16x32_bf16 a[108:111], v[24:27], v[120:123], a[108:111]
    s_waitcnt vmcnt(0)
    v_mfma_f32_16x16x32_bf16 a[108:111], v[28:31], v[124:127], a[108:111]
    s_waitcnt vmcnt(4)
    v_mfma_f32_16x16x32_bf16 a[108:111], v[108:111], v[136:139], a[108:111]
    s_nop 7
    s_mul_i32 s38, s18, 28672
    v_add_u32 v8, s38, v4
    ds_write_b128 v8, a[0:3] offset:0
    ds_write_b128 v8, a[4:7] offset:1024
    ds_write_b128 v8, a[8:11] offset:2048
    ds_write_b128 v8, a[12:15] offset:3072
    ds_write_b128 v8, a[16:19] offset:4096
    ds_write_b128 v8, a[20:23] offset:5120
    ds_write_b128 v8, a[24:27] offset:6144
    ds_write_b128 v8, a[28:31] offset:7168
    ds_write_b128 v8, a[32:35] offset:8192
    ds_write_b128 v8, a[36:39] offset:9216
    ds_write_b128 v8, a[40:43] offset:10240
    ds_write_b128 v8, a[44:47] offset:11264
    ds_write_b128 v8, a[48:51] offset:12288
    ds_write_b128 v8, a[52:55] offset:13312
    ds_write_b128 v8, a[56:59] offset:14336
    ds_write_b128 v8, a[60:63] offset:15360
    ds_write_b128 v8, a[64:67] offset:16384
    ds_write_b128 v8, a[68:71] offset:17408
    ds_write_b128 v8, a[72:75] offset:18432
    ds_write_b128 v8, a[76:79] offset:19456
    ds_write_b128 v8, a[80:83] offset:20480
    ds_write_b128 v8, a[84:87] offset:21504
    ds_write_b128 v8, a[88:91] offset:22528
    ds_write_b128 v8, a[92:95] offset:23552
    ds_write_b128 v8, a[96:99] offset:24576
    ds_write_b128 v8, a[100:103] offset:25600
    ds_write_b128 v8, a[104:107] offset:26624
    ds_write_b128 v8, a[108:111] offset:27648
    s_waitcnt lgkmcnt(0)
    s_barrier
    s_lshl_b32 s38, s18, 3
    s_mul_i32 s39, s18, 6
    s_add_u32 s39, s39, 4
    s_cmp_lt_u32 s18, 2
    s_cselect_b32 s40, s38, s39
    s_lshl_b32 s38, s40, 10
    v_add_u32 v8, s38, v4
    v_add_u32 v7, 57344, v8
    s_mul_i32 s38, s2, 14336
    s_lshl_b32 s39, s40, 5
    s_add_u32 s38, s38, s39
    v_mul_u32_u24 v9, 896, v3
    v_lshl_add_u32 v9, v2, 3, v9
    v_add_u32 v9, s38, v9
    s_mul_i32 s38, s2, 28
    s_add_u32 s38, s38, s40
    s_lshl_b32 s38, s38, 9
    s_add_u32 s38, s38, 0x5a9d000
    s_add_u32 s24, s16, s38
    s_addc_u32 s25, s17, 0
    s_mul_i32 s38, s2, 14
    s_lshr_b32 s39, s40, 1
    s_add_u32 s38, s38, s39
    s_lshl_b32 s38, s38, 10
    s_add_u32 s38, s38, 0x5c5d000
    s_add_u32 s26, s16, s38
    s_addc_u32 s27, s17, 0
    v_lshlrev_b32 v6, 3, v1
    s_lshl_b32 s38, s18, 6
    s_add_u32 s38, s38, 114688
    v_lshl_add_u32 v11, v3, 2, s38
    v_lshlrev_b32 v12, 2, v3
    v_add_u32 v12, 114688, v12
    s_cmp_ge_u32 s18, 2
    s_cbranch_scc1 .chain_kernel_t696
    global_load_dwordx2 v[128:129], v9, s[4:5] offset:0
    global_load_dwordx2 v[130:131], v9, s[4:5] offset:32
    global_load_dwordx2 v[132:133], v9, s[4:5] offset:64
    global_load_dwordx2 v[134:135], v9, s[4:5] offset:96
    global_load_dwordx2 v[136:137], v9, s[4:5] offset:128
    global_load_dwordx2 v[138:139], v9, s[4:5] offset:160
    global_load_dwordx2 v[140:141], v9, s[4:5] offset:192
    global_load_dwordx2 v[142:143], v9, s[4:5] offset:224
    ds_read_b128 v[64:67], v8 offset:0
    ds_read_b128 v[68:71], v8 offset:28672
    ds_read_b128 v[72:75], v7 offset:0
    ds_read_b128 v[76:79], v7 offset:28672
    s_waitcnt lgkmcnt(0)
    v_pk_add_f32 v[64:65], v[64:65], v[68:69]
    v_pk_add_f32 v[66:67], v[66:67], v[70:71]
    v_pk_add_f32 v[72:73], v[72:73], v[76:77]
    v_pk_add_f32 v[74:75], v[74:75], v[78:79]
    v_pk_add_f32 v[16:17], v[64:65], v[72:73]
    v_pk_add_f32 v[18:19], v[66:67], v[74:75]
    ds_read_b128 v[64:67], v8 offset:1024
    ds_read_b128 v[68:71], v8 offset:29696
    ds_read_b128 v[72:75], v7 offset:1024
    ds_read_b128 v[76:79], v7 offset:29696
    s_waitcnt lgkmcnt(0)
    v_pk_add_f32 v[64:65], v[64:65], v[68:69]
    v_pk_add_f32 v[66:67], v[66:67], v[70:71]
    v_pk_add_f32 v[72:73], v[72:73], v[76:77]
    v_pk_add_f32 v[74:75], v[74:75], v[78:79]
    v_pk_add_f32 v[20:21], v[64:65], v[72:73]
    v_pk_add_f32 v[22:23], v[66:67], v[74:75]
    ds_read_b128 v[64:67], v8 offset:2048
    ds_read_b128 v[68:71], v8 offset:30720
    ds_read_b128 v[72:75], v7 offset:2048
    ds_read_b128 v[76:79], v7 offset:30720
    s_waitcnt lgkmcnt(0)
    v_pk_add_f32 v[64:65], v[64:65], v[68:69]
    v_pk_add_f32 v[66:67], v[66:67], v[70:71]
    v_pk_add_f32 v[72:73], v[72:73], v[76:77]
    v_pk_add_f32 v[74:75], v[74:75], v[78:79]
    v_pk_add_f32 v[24:25], v[64:65], v[72:73]
    v_pk_add_f32 v[26:27], v[66:67], v[74:75]
    ds_read_b128 v[64:67], v8 offset:3072
    ds_read_b128 v[68:71], v8 offset:31744
    ds_read_b128 v[72:75], v7 offset:3072
    ds_read_b128 v[76:79], v7 offset:31744
    s_waitcnt lgkmcnt(0)
    v_pk_add_f32 v[64:65], v[64:65], v[68:69]
    v_pk_add_f32 v[66:67], v[66:67], v[70:71]
    v_pk_add_f32 v[72:73], v[72:73], v[76:77]
    v_pk_add_f32 v[74:75], v[74:75], v[78:79]
    v_pk_add_f32 v[28:29], v[64:65], v[72:73]
    v_pk_add_f32 v[30:31], v[66:67], v[74:75]
    ds_read_b128 v[64:67], v8 offset:4096
    ds_read_b128 v[68:71], v8 offset:32768
    ds_read_b128 v[72:75], v7 offset:4096
    ds_read_b128 v[76:79], v7 offset:32768
    s_waitcnt lgkmcnt(0)
    v_pk_add_f32 v[64:65], v[64:65], v[68:69]
    v_pk_add_f32 v[66:67], v[66:67], v[70:71]
    v_pk_add_f32 v[72:73], v[72:73], v[76:77]
    v_pk_add_f32 v[74:75], v[74:75], v[78:79]
    v_pk_add_f32 v[32:33], v[64:65], v[72:73]
    v_pk_add_f32 v[34:35], v[66:67], v[74:75]
    ds_read_b128 v[64:67], v8 offset:5120
    ds_read_b128 v[68:71], v8 offset:33792
    ds_read_b128 v[72:75], v7 offset:5120
    ds_read_b128 v[76:79], v7 offset:33792
    s_waitcnt lgkmcnt(0)
    v_pk_add_f32 v[64:65], v[64:65], v[68:69]
    v_pk_add_f32 v[66:67], v[66:67], v[70:71]
    v_pk_add_f32 v[72:73], v[72:73], v[76:77]
    v_pk_add_f32 v[74:75], v[74:75], v[78:79]
    v_pk_add_f32 v[36:37], v[64:65], v[72:73]
    v_pk_add_f32 v[38:39], v[66:67], v[74:75]
    ds_read_b128 v[64:67], v8 offset:6144
    ds_read_b128 v[68:71], v8 offset:34816
    ds_read_b128 v[72:75], v7 offset:6144
    ds_read_b128 v[76:79], v7 offset:34816
    s_waitcnt lgkmcnt(0)
    v_pk_add_f32 v[64:65], v[64:65], v[68:69]
    v_pk_add_f32 v[66:67], v[66:67], v[70:71]
    v_pk_add_f32 v[72:73], v[72:73], v[76:77]
    v_pk_add_f32 v[74:75], v[74:75], v[78:79]
    v_pk_add_f32 v[40:41], v[64:65], v[72:73]
    v_pk_add_f32 v[42:43], v[66:67], v[74:75]
    ds_read_b128 v[64:67], v8 offset:7168
    ds_read_b128 v[68:71], v8 offset:35840
    ds_read_b128 v[72:75], v7 offset:7168
    ds_read_b128 v[76:79], v7 offset:35840
    s_waitcnt lgkmcnt(0)
    v_pk_add_f32 v[64:65], v[64:65], v[68:69]
    v_pk_add_f32 v[66:67], v[66:67], v[70:71]
    v_pk_add_f32 v[72:73], v[72:73], v[76:77]
    v_pk_add_f32 v[74:75], v[74:75], v[78:79]
    v_pk_add_f32 v[44:45], v[64:65], v[72:73]
    v_pk_add_f32 v[46:47], v[66:67], v[74:75]
    s_waitcnt vmcnt(0)
    v_cvt_pk_bf16_f32 v16, v16, v16
    v_lshlrev_b32 v16, 16, v16
    v_lshlrev_b32 v64, 16, v128
    v_add_f32 v16, v16, v64
    v_cvt_pk_bf16_f32 v16, v16, v16
    v_lshlrev_b32 v16, 16, v16
    v_cvt_pk_bf16_f32 v17, v17, v17
    v_lshlrev_b32 v17, 16, v17
    v_and_b32 v64, 0xffff0000, v128
    v_add_f32 v17, v17, v64
    v_cvt_pk_bf16_f32 v17, v17, v17
    v_lshlrev_b32 v17, 16, v17
    v_cvt_pk_bf16_f32 v18, v18, v18
    v_lshlrev_b32 v18, 16, v18
    v_lshlrev_b32 v64, 16, v129
    v_add_f32 v18, v18, v64
    v_cvt_pk_bf16_f32 v18, v18, v18
    v_lshlrev_b32 v18, 16, v18
    v_cvt_pk_bf16_f32 v19, v19, v19
    v_lshlrev_b32 v19, 16, v19
    v_and_b32 v64, 0xffff0000, v129
    v_add_f32 v19, v19, v64
    v_cvt_pk_bf16_f32 v19, v19, v19
    v_lshlrev_b32 v19, 16, v19
    v_cvt_pk_bf16_f32 v66, v16, v17
    v_cvt_pk_bf16_f32 v67, v18, v19
    global_store_dwordx2 v6, v[66:67], s[24:25] offset:0 sc1
    s_nop 1
    v_cvt_pk_bf16_f32 v20, v20, v20
    v_lshlrev_b32 v20, 16, v20
    v_lshlrev_b32 v64, 16, v130
    v_add_f32 v20, v20, v64
    v_cvt_pk_bf16_f32 v20, v20, v20
    v_lshlrev_b32 v20, 16, v20
    v_cvt_pk_bf16_f32 v21, v21, v21
    v_lshlrev_b32 v21, 16, v21
    v_and_b32 v64, 0xffff0000, v130
    v_add_f32 v21, v21, v64
    v_cvt_pk_bf16_f32 v21, v21, v21
    v_lshlrev_b32 v21, 16, v21
    v_cvt_pk_bf16_f32 v22, v22, v22
    v_lshlrev_b32 v22, 16, v22
    v_lshlrev_b32 v64, 16, v131
    v_add_f32 v22, v22, v64
    v_cvt_pk_bf16_f32 v22, v22, v22
    v_lshlrev_b32 v22, 16, v22
    v_cvt_pk_bf16_f32 v23, v23, v23
    v_lshlrev_b32 v23, 16, v23
    v_and_b32 v64, 0xffff0000, v131
    v_add_f32 v23, v23, v64
    v_cvt_pk_bf16_f32 v23, v23, v23
    v_lshlrev_b32 v23, 16, v23
    v_cvt_pk_bf16_f32 v66, v20, v21
    v_cvt_pk_bf16_f32 v67, v22, v23
    global_store_dwordx2 v6, v[66:67], s[24:25] offset:512 sc1
    s_nop 1
    v_cvt_pk_bf16_f32 v24, v24, v24
    v_lshlrev_b32 v24, 16, v24
    v_lshlrev_b32 v64, 16, v132
    v_add_f32 v24, v24, v64
    v_cvt_pk_bf16_f32 v24, v24, v24
    v_lshlrev_b32 v24, 16, v24
    v_cvt_pk_bf16_f32 v25, v25, v25
    v_lshlrev_b32 v25, 16, v25
    v_and_b32 v64, 0xffff0000, v132
    v_add_f32 v25, v25, v64
    v_cvt_pk_bf16_f32 v25, v25, v25
    v_lshlrev_b32 v25, 16, v25
    v_cvt_pk_bf16_f32 v26, v26, v26
    v_lshlrev_b32 v26, 16, v26
    v_lshlrev_b32 v64, 16, v133
    v_add_f32 v26, v26, v64
    v_cvt_pk_bf16_f32 v26, v26, v26
    v_lshlrev_b32 v26, 16, v26
    v_cvt_pk_bf16_f32 v27, v27, v27
    v_lshlrev_b32 v27, 16, v27
    v_and_b32 v64, 0xffff0000, v133
    v_add_f32 v27, v27, v64
    v_cvt_pk_bf16_f32 v27, v27, v27
    v_lshlrev_b32 v27, 16, v27
    v_cvt_pk_bf16_f32 v66, v24, v25
    v_cvt_pk_bf16_f32 v67, v26, v27
    global_store_dwordx2 v6, v[66:67], s[24:25] offset:1024 sc1
    s_nop 1
    v_cvt_pk_bf16_f32 v28, v28, v28
    v_lshlrev_b32 v28, 16, v28
    v_lshlrev_b32 v64, 16, v134
    v_add_f32 v28, v28, v64
    v_cvt_pk_bf16_f32 v28, v28, v28
    v_lshlrev_b32 v28, 16, v28
    v_cvt_pk_bf16_f32 v29, v29, v29
    v_lshlrev_b32 v29, 16, v29
    v_and_b32 v64, 0xffff0000, v134
    v_add_f32 v29, v29, v64
    v_cvt_pk_bf16_f32 v29, v29, v29
    v_lshlrev_b32 v29, 16, v29
    v_cvt_pk_bf16_f32 v30, v30, v30
    v_lshlrev_b32 v30, 16, v30
    v_lshlrev_b32 v64, 16, v135
    v_add_f32 v30, v30, v64
    v_cvt_pk_bf16_f32 v30, v30, v30
    v_lshlrev_b32 v30, 16, v30
    v_cvt_pk_bf16_f32 v31, v31, v31
    v_lshlrev_b32 v31, 16, v31
    v_and_b32 v64, 0xffff0000, v135
    v_add_f32 v31, v31, v64
    v_cvt_pk_bf16_f32 v31, v31, v31
    v_lshlrev_b32 v31, 16, v31
    v_cvt_pk_bf16_f32 v66, v28, v29
    v_cvt_pk_bf16_f32 v67, v30, v31
    global_store_dwordx2 v6, v[66:67], s[24:25] offset:1536 sc1
    s_nop 1
    v_cvt_pk_bf16_f32 v32, v32, v32
    v_lshlrev_b32 v32, 16, v32
    v_lshlrev_b32 v64, 16, v136
    v_add_f32 v32, v32, v64
    v_cvt_pk_bf16_f32 v32, v32, v32
    v_lshlrev_b32 v32, 16, v32
    v_cvt_pk_bf16_f32 v33, v33, v33
    v_lshlrev_b32 v33, 16, v33
    v_and_b32 v64, 0xffff0000, v136
    v_add_f32 v33, v33, v64
    v_cvt_pk_bf16_f32 v33, v33, v33
    v_lshlrev_b32 v33, 16, v33
    v_cvt_pk_bf16_f32 v34, v34, v34
    v_lshlrev_b32 v34, 16, v34
    v_lshlrev_b32 v64, 16, v137
    v_add_f32 v34, v34, v64
    v_cvt_pk_bf16_f32 v34, v34, v34
    v_lshlrev_b32 v34, 16, v34
    v_cvt_pk_bf16_f32 v35, v35, v35
    v_lshlrev_b32 v35, 16, v35
    v_and_b32 v64, 0xffff0000, v137
    v_add_f32 v35, v35, v64
    v_cvt_pk_bf16_f32 v35, v35, v35
    v_lshlrev_b32 v35, 16, v35
    v_cvt_pk_bf16_f32 v66, v32, v33
    v_cvt_pk_bf16_f32 v67, v34, v35
    global_store_dwordx2 v6, v[66:67], s[24:25] offset:2048 sc1
    s_nop 1
    v_cvt_pk_bf16_f32 v36, v36, v36
    v_lshlrev_b32 v36, 16, v36
    v_lshlrev_b32 v64, 16, v138
    v_add_f32 v36, v36, v64
    v_cvt_pk_bf16_f32 v36, v36, v36
    v_lshlrev_b32 v36, 16, v36
    v_cvt_pk_bf16_f32 v37, v37, v37
    v_lshlrev_b32 v37, 16, v37
    v_and_b32 v64, 0xffff0000, v138
    v_add_f32 v37, v37, v64
    v_cvt_pk_bf16_f32 v37, v37, v37
    v_lshlrev_b32 v37, 16, v37
    v_cvt_pk_bf16_f32 v38, v38, v38
    v_lshlrev_b32 v38, 16, v38
    v_lshlrev_b32 v64, 16, v139
    v_add_f32 v38, v38, v64
    v_cvt_pk_bf16_f32 v38, v38, v38
    v_lshlrev_b32 v38, 16, v38
    v_cvt_pk_bf16_f32 v39, v39, v39
    v_lshlrev_b32 v39, 16, v39
    v_and_b32 v64, 0xffff0000, v139
    v_add_f32 v39, v39, v64
    v_cvt_pk_bf16_f32 v39, v39, v39
    v_lshlrev_b32 v39, 16, v39
    v_cvt_pk_bf16_f32 v66, v36, v37
    v_cvt_pk_bf16_f32 v67, v38, v39
    global_store_dwordx2 v6, v[66:67], s[24:25] offset:2560 sc1
    s_nop 1
    v_cvt_pk_bf16_f32 v40, v40, v40
    v_lshlrev_b32 v40, 16, v40
    v_lshlrev_b32 v64, 16, v140
    v_add_f32 v40, v40, v64
    v_cvt_pk_bf16_f32 v40, v40, v40
    v_lshlrev_b32 v40, 16, v40
    v_cvt_pk_bf16_f32 v41, v41, v41
    v_lshlrev_b32 v41, 16, v41
    v_and_b32 v64, 0xffff0000, v140
    v_add_f32 v41, v41, v64
    v_cvt_pk_bf16_f32 v41, v41, v41
    v_lshlrev_b32 v41, 16, v41
    v_cvt_pk_bf16_f32 v42, v42, v42
    v_lshlrev_b32 v42, 16, v42
    v_lshlrev_b32 v64, 16, v141
    v_add_f32 v42, v42, v64
    v_cvt_pk_bf16_f32 v42, v42, v42
    v_lshlrev_b32 v42, 16, v42
    v_cvt_pk_bf16_f32 v43, v43, v43
    v_lshlrev_b32 v43, 16, v43
    v_and_b32 v64, 0xffff0000, v141
    v_add_f32 v43, v43, v64
    v_cvt_pk_bf16_f32 v43, v43, v43
    v_lshlrev_b32 v43, 16, v43
    v_cvt_pk_bf16_f32 v66, v40, v41
    v_cvt_pk_bf16_f32 v67, v42, v43
    global_store_dwordx2 v6, v[66:67], s[24:25] offset:3072 sc1
    s_nop 1
    v_cvt_pk_bf16_f32 v44, v44, v44
    v_lshlrev_b32 v44, 16, v44
    v_lshlrev_b32 v64, 16, v142
    v_add_f32 v44, v44, v64
    v_cvt_pk_bf16_f32 v44, v44, v44
    v_lshlrev_b32 v44, 16, v44
    v_cvt_pk_bf16_f32 v45, v45, v45
    v_lshlrev_b32 v45, 16, v45
    v_and_b32 v64, 0xffff0000, v142
    v_add_f32 v45, v45, v64
    v_cvt_pk_bf16_f32 v45, v45, v45
    v_lshlrev_b32 v45, 16, v45
    v_cvt_pk_bf16_f32 v46, v46, v46
    v_lshlrev_b32 v46, 16, v46
    v_lshlrev_b32 v64, 16, v143
    v_add_f32 v46, v46, v64
    v_cvt_pk_bf16_f32 v46, v46, v46
    v_lshlrev_b32 v46, 16, v46
    v_cvt_pk_bf16_f32 v47, v47, v47
    v_lshlrev_b32 v47, 16, v47
    v_and_b32 v64, 0xffff0000, v143
    v_add_f32 v47, v47, v64
    v_cvt_pk_bf16_f32 v47, v47, v47
    v_lshlrev_b32 v47, 16, v47
    v_cvt_pk_bf16_f32 v66, v44, v45
    v_cvt_pk_bf16_f32 v67, v46, v47
    global_store_dwordx2 v6, v[66:67], s[24:25] offset:3584 sc1
    s_nop 1
    v_add_f32 v48, v16, v17
    v_add_f32 v48, v48, v18
    v_add_f32 v48, v48, v19
    v_add_f32 v48, v48, v20
    v_add_f32 v48, v48, v21
    v_add_f32 v48, v48, v22
    v_add_f32 v48, v48, v23
    v_add_f32 v48, v48, v24
    v_add_f32 v48, v48, v25
    v_add_f32 v48, v48, v26
    v_add_f32 v48, v48, v27
    v_add_f32 v48, v48, v28
    v_add_f32 v48, v48, v29
    v_add_f32 v48, v48, v30
    v_add_f32 v48, v48, v31
    v_add_f32 v48, v48, v32
    v_add_f32 v48, v48, v33
    v_add_f32 v48, v48, v34
    v_add_f32 v48, v48, v35
    v_add_f32 v48, v48, v36
    v_add_f32 v48, v48, v37
    v_add_f32 v48, v48, v38
    v_add_f32 v48, v48, v39
    v_add_f32 v48, v48, v40
    v_add_f32 v48, v48, v41
    v_add_f32 v48, v48, v42
    v_add_f32 v48, v48, v43
    v_add_f32 v48, v48, v44
    v_add_f32 v48, v48, v45
    v_add_f32 v48, v48, v46
    v_add_f32 v48, v48, v47
    v_mov_b32 v49, v48
    s_nop 1
    v_permlane32_swap_b32 v48, v49
    s_nop 1
    v_add_f32 v48, v48, v49
    v_mov_b32 v49, v48
    s_nop 1
    v_permlane16_swap_b32 v48, v49
    s_nop 1
    v_add_f32 v48, v48, v49
    ds_write_b32 v11, v48
    s_waitcnt lgkmcnt(0)
    s_barrier
    ds_read_b32 v64, v12 offset:0
    ds_read_b32 v65, v12 offset:64
    ds_read_b32 v66, v12 offset:128
    ds_read_b32 v67, v12 offset:192
    s_waitcnt lgkmcnt(0)
    v_add_f32 v48, v64, v65
    v_add_f32 v49, v66, v67
    v_add_f32 v48, v48, v49
    v_mul_f32 v48, 0x3b124925, v48
    v_sub_f32 v49, v16, v48
    v_mul_f32 v50, v49, v49
    v_sub_f32 v49, v17, v48
    v_fmac_f32 v50, v49, v49
    v_sub_f32 v49, v18, v48
    v_fmac_f32 v50, v49, v49
    v_sub_f32 v49, v19, v48
    v_fmac_f32 v50, v49, v49
    v_sub_f32 v49, v20, v48
    v_fmac_f32 v50, v49, v49
    v_sub_f32 v49, v21, v48
    v_fmac_f32 v50, v49, v49
    v_sub_f32 v49, v22, v48
    v_fmac_f32 v50, v49, v49
    v_sub_f32 v49, v23, v48
    v_fmac_f32 v50, v49, v49
    v_sub_f32 v49, v24, v48
    v_fmac_f32 v50, v49, v49
    v_sub_f32 v49, v25, v48
    v_fmac_f32 v50, v49, v49
    v_sub_f32 v49, v26, v48
    v_fmac_f32 v50, v49, v49
    v_sub_f32 v49, v27, v48
    v_fmac_f32 v50, v49, v49
    v_sub_f32 v49, v28, v48
    v_fmac_f32 v50, v49, v49
    v_sub_f32 v49, v29, v48
    v_fmac_f32 v50, v49, v49
    v_sub_f32 v49, v30, v48
    v_fmac_f32 v50, v49, v49
    v_sub_f32 v49, v31, v48
    v_fmac_f32 v50, v49, v49
    v_sub_f32 v49, v32, v48
    v_fmac_f32 v50, v49, v49
    v_sub_f32 v49, v33, v48
    v_fmac_f32 v50, v49, v49
    v_sub_f32 v49, v34, v48
    v_fmac_f32 v50, v49, v49
    v_sub_f32 v49, v35, v48
    v_fmac_f32 v50, v49, v49
    v_sub_f32 v49, v36, v48
    v_fmac_f32 v50, v49, v49
    v_sub_f32 v49, v37, v48
    v_fmac_f32 v50, v49, v49
    v_sub_f32 v49, v38, v48
    v_fmac_f32 v50, v49, v49
    v_sub_f32 v49, v39, v48
    v_fmac_f32 v50, v49, v49
    v_sub_f32 v49, v40, v48
    v_fmac_f32 v50, v49, v49
    v_sub_f32 v49, v41, v48
    v_fmac_f32 v50, v49, v49
    v_sub_f32 v49, v42, v48
    v_fmac_f32 v50, v49, v49
    v_sub_f32 v49, v43, v48
    v_fmac_f32 v50, v49, v49
    v_sub_f32 v49, v44, v48
    v_fmac_f32 v50, v49, v49
    v_sub_f32 v49, v45, v48
    v_fmac_f32 v50, v49, v49
    v_sub_f32 v49, v46, v48
    v_fmac_f32 v50, v49, v49
    v_sub_f32 v49, v47, v48
    v_fmac_f32 v50, v49, v49
    v_mov_b32 v49, v50
    s_nop 1
    v_permlane32_swap_b32 v50, v49
    s_nop 1
    v_add_f32 v50, v50, v49
    v_mov_b32 v49, v50
    s_nop 1
    v_permlane16_swap_b32 v50, v49
    s_nop 1
    v_add_f32 v50, v50, v49
    ds_write_b32 v11, v50 offset:256
    s_waitcnt lgkmcnt(0)
    s_barrier
    ds_read_b32 v64, v12 offset:256
    ds_read_b32 v65, v12 offset:320
    ds_read_b32 v66, v12 offset:384
    ds_read_b32 v67, v12 offset:448
    s_waitcnt lgkmcnt(0)
    v_add_f32 v50, v64, v65
    v_add_f32 v49, v66, v67
    v_add_f32 v50, v50, v49
    v_mul_f32 v50, 0x3b124925, v50
    v_cvt_pk_bf16_f32 v50, v50, v50
    v_lshlrev_b32 v50, 16, v50
    v_cvt_pk_bf16_f32 v48, v48, v48
    v_lshlrev_b32 v48, 16, v48
    v_add_f32 v50, 0x3727c5ac, v50
    v_cvt_pk_bf16_f32 v50, v50, v50
    v_lshlrev_b32 v50, 16, v50
    v_sqrt_f32 v50, v50
    s_nop 0
    v_cvt_pk_bf16_f32 v50, v50, v50
    v_lshlrev_b32 v50, 16, v50
    v_rcp_f32 v51, v50
    s_nop 0
    v_sub_f32 v16, v16, v48
    v_cvt_pk_bf16_f32 v16, v16, v16
    v_lshlrev_b32 v16, 16, v16
    v_mul_f32 v49, v16, v51
    v_fma_f32 v52, -v49, v50, v16
    v_fma_f32 v16, v52, v51, v49
    v_sub_f32 v17, v17, v48
    v_cvt_pk_bf16_f32 v17, v17, v17
    v_lshlrev_b32 v17, 16, v17
    v_mul_f32 v49, v17, v51
    v_fma_f32 v52, -v49, v50, v17
    v_fma_f32 v17, v52, v51, v49
    v_sub_f32 v18, v18, v48
    v_cvt_pk_bf16_f32 v18, v18, v18
    v_lshlrev_b32 v18, 16, v18
    v_mul_f32 v49, v18, v51
    v_fma_f32 v52, -v49, v50, v18
    v_fma_f32 v18, v52, v51, v49
    v_sub_f32 v19, v19, v48
    v_cvt_pk_bf16_f32 v19, v19, v19
    v_lshlrev_b32 v19, 16, v19
    v_mul_f32 v49, v19, v51
    v_fma_f32 v52, -v49, v50, v19
    v_fma_f32 v19, v52, v51, v49
    v_sub_f32 v20, v20, v48
    v_cvt_pk_bf16_f32 v20, v20, v20
    v_lshlrev_b32 v20, 16, v20
    v_mul_f32 v49, v20, v51
    v_fma_f32 v52, -v49, v50, v20
    v_fma_f32 v20, v52, v51, v49
    v_sub_f32 v21, v21, v48
    v_cvt_pk_bf16_f32 v21, v21, v21
    v_lshlrev_b32 v21, 16, v21
    v_mul_f32 v49, v21, v51
    v_fma_f32 v52, -v49, v50, v21
    v_fma_f32 v21, v52, v51, v49
    v_sub_f32 v22, v22, v48
    v_cvt_pk_bf16_f32 v22, v22, v22
    v_lshlrev_b32 v22, 16, v22
    v_mul_f32 v49, v22, v51
    v_fma_f32 v52, -v49, v50, v22
    v_fma_f32 v22, v52, v51, v49
    v_sub_f32 v23, v23, v48
    v_cvt_pk_bf16_f32 v23, v23, v23
    v_lshlrev_b32 v23, 16, v23
    v_mul_f32 v49, v23, v51
    v_fma_f32 v52, -v49, v50, v23
    v_fma_f32 v23, v52, v51, v49
    v_sub_f32 v24, v24, v48
    v_cvt_pk_bf16_f32 v24, v24, v24
    v_lshlrev_b32 v24, 16, v24
    v_mul_f32 v49, v24, v51
    v_fma_f32 v52, -v49, v50, v24
    v_fma_f32 v24, v52, v51, v49
    v_sub_f32 v25, v25, v48
    v_cvt_pk_bf16_f32 v25, v25, v25
    v_lshlrev_b32 v25, 16, v25
    v_mul_f32 v49, v25, v51
    v_fma_f32 v52, -v49, v50, v25
    v_fma_f32 v25, v52, v51, v49
    v_sub_f32 v26, v26, v48
    v_cvt_pk_bf16_f32 v26, v26, v26
    v_lshlrev_b32 v26, 16, v26
    v_mul_f32 v49, v26, v51
    v_fma_f32 v52, -v49, v50, v26
    v_fma_f32 v26, v52, v51, v49
    v_sub_f32 v27, v27, v48
    v_cvt_pk_bf16_f32 v27, v27, v27
    v_lshlrev_b32 v27, 16, v27
    v_mul_f32 v49, v27, v51
    v_fma_f32 v52, -v49, v50, v27
    v_fma_f32 v27, v52, v51, v49
    v_sub_f32 v28, v28, v48
    v_cvt_pk_bf16_f32 v28, v28, v28
    v_lshlrev_b32 v28, 16, v28
    v_mul_f32 v49, v28, v51
    v_fma_f32 v52, -v49, v50, v28
    v_fma_f32 v28, v52, v51, v49
    v_sub_f32 v29, v29, v48
    v_cvt_pk_bf16_f32 v29, v29, v29
    v_lshlrev_b32 v29, 16, v29
    v_mul_f32 v49, v29, v51
    v_fma_f32 v52, -v49, v50, v29
    v_fma_f32 v29, v52, v51, v49
    v_sub_f32 v30, v30, v48
    v_cvt_pk_bf16_f32 v30, v30, v30
    v_lshlrev_b32 v30, 16, v30
    v_mul_f32 v49, v30, v51
    v_fma_f32 v52, -v49, v50, v30
    v_fma_f32 v30, v52, v51, v49
    v_sub_f32 v31, v31, v48
    v_cvt_pk_bf16_f32 v31, v31, v31
    v_lshlrev_b32 v31, 16, v31
    v_mul_f32 v49, v31, v51
    v_fma_f32 v52, -v49, v50, v31
    v_fma_f32 v31, v52, v51, v49
    v_sub_f32 v32, v32, v48
    v_cvt_pk_bf16_f32 v32, v32, v32
    v_lshlrev_b32 v32, 16, v32
    v_mul_f32 v49, v32, v51
    v_fma_f32 v52, -v49, v50, v32
    v_fma_f32 v32, v52, v51, v49
    v_sub_f32 v33, v33, v48
    v_cvt_pk_bf16_f32 v33, v33, v33
    v_lshlrev_b32 v33, 16, v33
    v_mul_f32 v49, v33, v51
    v_fma_f32 v52, -v49, v50, v33
    v_fma_f32 v33, v52, v51, v49
    v_sub_f32 v34, v34, v48
    v_cvt_pk_bf16_f32 v34, v34, v34
    v_lshlrev_b32 v34, 16, v34
    v_mul_f32 v49, v34, v51
    v_fma_f32 v52, -v49, v50, v34
    v_fma_f32 v34, v52, v51, v49
    v_sub_f32 v35, v35, v48
    v_cvt_pk_bf16_f32 v35, v35, v35
    v_lshlrev_b32 v35, 16, v35
    v_mul_f32 v49, v35, v51
    v_fma_f32 v52, -v49, v50, v35
    v_fma_f32 v35, v52, v51, v49
    v_sub_f32 v36, v36, v48
    v_cvt_pk_bf16_f32 v36, v36, v36
    v_lshlrev_b32 v36, 16, v36
    v_mul_f32 v49, v36, v51
    v_fma_f32 v52, -v49, v50, v36
    v_fma_f32 v36, v52, v51, v49
    v_sub_f32 v37, v37, v48
    v_cvt_pk_bf16_f32 v37, v37, v37
    v_lshlrev_b32 v37, 16, v37
    v_mul_f32 v49, v37, v51
    v_fma_f32 v52, -v49, v50, v37
    v_fma_f32 v37, v52, v51, v49
    v_sub_f32 v38, v38, v48
    v_cvt_pk_bf16_f32 v38, v38, v38
    v_lshlrev_b32 v38, 16, v38
    v_mul_f32 v49, v38, v51
    v_fma_f32 v52, -v49, v50, v38
    v_fma_f32 v38, v52, v51, v49
    v_sub_f32 v39, v39, v48
    v_cvt_pk_bf16_f32 v39, v39, v39
    v_lshlrev_b32 v39, 16, v39
    v_mul_f32 v49, v39, v51
    v_fma_f32 v52, -v49, v50, v39
    v_fma_f32 v39, v52, v51, v49
    v_sub_f32 v40, v40, v48
    v_cvt_pk_bf16_f32 v40, v40, v40
    v_lshlrev_b32 v40, 16, v40
    v_mul_f32 v49, v40, v51
    v_fma_f32 v52, -v49, v50, v40
    v_fma_f32 v40, v52, v51, v49
    v_sub_f32 v41, v41, v48
    v_cvt_pk_bf16_f32 v41, v41, v41
    v_lshlrev_b32 v41, 16, v41
    v_mul_f32 v49, v41, v51
    v_fma_f32 v52, -v49, v50, v41
    v_fma_f32 v41, v52, v51, v49
    v_sub_f32 v42, v42, v48
    v_cvt_pk_bf16_f32 v42, v42, v42
    v_lshlrev_b32 v42, 16, v42
    v_mul_f32 v49, v42, v51
    v_fma_f32 v52, -v49, v50, v42
    v_fma_f32 v42, v52, v51, v49
    v_sub_f32 v43, v43, v48
    v_cvt_pk_bf16_f32 v43, v43, v43
    v_lshlrev_b32 v43, 16, v43
    v_mul_f32 v49, v43, v51
    v_fma_f32 v52, -v49, v50, v43
    v_fma_f32 v43, v52, v51, v49
    v_sub_f32 v44, v44, v48
    v_cvt_pk_bf16_f32 v44, v44, v44
    v_lshlrev_b32 v44, 16, v44
    v_mul_f32 v49, v44, v51
    v_fma_f32 v52, -v49, v50, v44
    v_fma_f32 v44, v52, v51, v49
    v_sub_f32 v45, v45, v48
    v_cvt_pk_bf16_f32 v45, v45, v45
    v_lshlrev_b32 v45, 16, v45
    v_mul_f32 v49, v45, v51
    v_fma_f32 v52, -v49, v50, v45
    v_fma_f32 v45, v52, v51, v49
    v_sub_f32 v46, v46, v48
    v_cvt_pk_bf16_f32 v46, v46, v46
    v_lshlrev_b32 v46, 16, v46
    v_mul_f32 v49, v46, v51
    v_fma_f32 v52, -v49, v50, v46
    v_fma_f32 v46, v52, v51, v49
    v_sub_f32 v47, v47, v48
    v_cvt_pk_bf16_f32 v47, v47, v47
    v_lshlrev_b32 v47, 16, v47
    v_mul_f32 v49, v47, v51
    v_fma_f32 v52, -v49, v50, v47
    v_fma_f32 v47, v52, v51, v49
    v_cvt_pk_bf16_f32 v64, v16, v17
    v_cvt_pk_bf16_f32 v65, v18, v19
    v_cvt_pk_bf16_f32 v66, v20, v21
    v_cvt_pk_bf16_f32 v67, v22, v23
    global_store_dwordx4 v4, v[64:67], s[26:27] offset:0 sc1
    v_cvt_pk_bf16_f32 v68, v24, v25
    v_cvt_pk_bf16_f32 v69, v26, v27
    v_cvt_pk_bf16_f32 v70, v28, v29
    v_cvt_pk_bf16_f32 v71, v30, v31
    global_store_dwordx4 v4, v[68:71], s[26:27] offset:1024 sc1
    v_cvt_pk_bf16_f32 v72, v32, v33
    v_cvt_pk_bf16_f32 v73, v34, v35
    v_cvt_pk_bf16_f32 v74, v36, v37
    v_cvt_pk_bf16_f32 v75, v38, v39
    global_store_dwordx4 v4, v[72:75], s[26:27] offset:2048 sc1
    v_cvt_pk_bf16_f32 v76, v40, v41
    v_cvt_pk_bf16_f32 v77, v42, v43
    v_cvt_pk_bf16_f32 v78, v44, v45
    v_cvt_pk_bf16_f32 v79, v46, v47
    global_store_dwordx4 v4, v[76:79], s[26:27] offset:3072 sc1
    s_branch .chain_kernel_d97
.chain_kernel_t696:
    global_load_dwordx2 v[128:129], v9, s[4:5] offset:0
    global_load_dwordx2 v[130:131], v9, s[4:5] offset:32
    global_load_dwordx2 v[132:133], v9, s[4:5] offset:64
    global_load_dwordx2 v[134:135], v9, s[4:5] offset:96
    global_load_dwordx2 v[136:137], v9, s[4:5] offset:128
    global_load_dwordx2 v[138:139], v9, s[4:5] offset:160
    ds_read_b128 v[64:67], v8 offset:0
    ds_read_b128 v[68:71], v8 offset:28672
    ds_read_b128 v[72:75], v7 offset:0
    ds_read_b128 v[76:79], v7 offset:28672
    s_waitcnt lgkmcnt(0)
    v_pk_add_f32 v[64:65], v[64:65], v[68:69]
    v_pk_add_f32 v[66:67], v[66:67], v[70:71]
    v_pk_add_f32 v[72:73], v[72:73], v[76:77]
    v_pk_add_f32 v[74:75], v[74:75], v[78:79]
    v_pk_add_f32 v[16:17], v[64:65], v[72:73]
    v_pk_add_f32 v[18:19], v[66:67], v[74:75]
    ds_read_b128 v[64:67], v8 offset:1024
    ds_read_b128 v[68:71], v8 offset:29696
    ds_read_b128 v[72:75], v7 offset:1024
    ds_read_b128 v[76:79], v7 offset:29696
    s_waitcnt lgkmcnt(0)
    v_pk_add_f32 v[64:65], v[64:65], v[68:69]
    v_pk_add_f32 v[66:67], v[66:67], v[70:71]
    v_pk_add_f32 v[72:73], v[72:73], v[76:77]
    v_pk_add_f32 v[74:75], v[74:75], v[78:79]
    v_pk_add_f32 v[20:21], v[64:65], v[72:73]
    v_pk_add_f32 v[22:23], v[66:67], v[74:75]
    ds_read_b128 v[64:67], v8 offset:2048
    ds_read_b128 v[68:71], v8 offset:30720
    ds_read_b128 v[72:75], v7 offset:2048
    ds_read_b128 v[76:79], v7 offset:30720
    s_waitcnt lgkmcnt(0)
    v_pk_add_f32 v[64:65], v[64:65], v[68:69]
    v_pk_add_f32 v[66:67], v[66:67], v[70:71]
    v_pk_add_f32 v[72:73], v[72:73], v[76:77]
    v_pk_add_f32 v[74:75], v[74:75], v[78:79]
    v_pk_add_f32 v[24:25], v[64:65], v[72:73]
    v_pk_add_f32 v[26:27], v[66:67], v[74:75]
    ds_read_b128 v[64:67], v8 offset:3072
    ds_read_b128 v[68:71], v8 offset:31744
    ds_read_b128 v[72:75], v7 offset:3072
    ds_read_b128 v[76:79], v7 offset:31744
    s_waitcnt lgkmcnt(0)
    v_pk_add_f32 v[64:65], v[64:65], v[68:69]
    v_pk_add_f32 v[66:67], v[66:67], v[70:71]
    v_pk_add_f32 v[72:73], v[72:73], v[76:77]
    v_pk_add_f32 v[74:75], v[74:75], v[78:79]
    v_pk_add_f32 v[28:29], v[64:65], v[72:73]
    v_pk_add_f32 v[30:31], v[66:67], v[74:75]
    ds_read_b128 v[64:67], v8 offset:4096
    ds_read_b128 v[68:71], v8 offset:32768
    ds_read_b128 v[72:75], v7 offset:4096
    ds_read_b128 v[76:79], v7 offset:32768
    s_waitcnt lgkmcnt(0)
    v_pk_add_f32 v[64:65], v[64:65], v[68:69]
    v_pk_add_f32 v[66:67], v[66:67], v[70:71]
    v_pk_add_f32 v[72:73], v[72:73], v[76:77]
    v_pk_add_f32 v[74:75], v[74:75], v[78:79]
    v_pk_add_f32 v[32:33], v[64:65], v[72:73]
    v_pk_add_f32 v[34:35], v[66:67], v[74:75]
    ds_read_b128 v[64:67], v8 offset:5120
    ds_read_b128 v[68:71], v8 offset:33792
    ds_read_b128 v[72:75], v7 offset:5120
    ds_read_b128 v[76:79], v7 offset:33792
    s_waitcnt lgkmcnt(0)
    v_pk_add_f32 v[64:65], v[64:65], v[68:69]
    v_pk_add_f32 v[66:67], v[66:67], v[70:71]
    v_pk_add_f32 v[72:73], v[72:73], v[76:77]
    v_pk_add_f32 v[74:75], v[74:75], v[78:79]
    v_pk_add_f32 v[36:37], v[64:65], v[72:73]
    v_pk_add_f32 v[38:39], v[66:67], v[74:75]
    s_waitcnt vmcnt(0)
    v_cvt_pk_bf16_f32 v16, v16, v16
    v_lshlrev_b32 v16, 16, v16
    v_lshlrev_b32 v64, 16, v128
    v_add_f32 v16, v16, v64
    v_cvt_pk_bf16_f32 v16, v16, v16
    v_lshlrev_b32 v16, 16, v16
    v_cvt_pk_bf16_f32 v17, v17, v17
    v_lshlrev_b32 v17, 16, v17
    v_and_b32 v64, 0xffff0000, v128
    v_add_f32 v17, v17, v64
    v_cvt_pk_bf16_f32 v17, v17, v17
    v_lshlrev_b32 v17, 16, v17
    v_cvt_pk_bf16_f32 v18, v18, v18
    v_lshlrev_b32 v18, 16, v18
    v_lshlrev_b32 v64, 16, v129
    v_add_f32 v18, v18, v64
    v_cvt_pk_bf16_f32 v18, v18, v18
    v_lshlrev_b32 v18, 16, v18
    v_cvt_pk_bf16_f32 v19, v19, v19
    v_lshlrev_b32 v19, 16, v19
    v_and_b32 v64, 0xffff0000, v129
    v_add_f32 v19, v19, v64
    v_cvt_pk_bf16_f32 v19, v19, v19
    v_lshlrev_b32 v19, 16, v19
    v_cvt_pk_bf16_f32 v66, v16, v17
    v_cvt_pk_bf16_f32 v67, v18, v19
    global_store_dwordx2 v6, v[66:67], s[24:25] offset:0 sc1
    s_nop 1
    v_cvt_pk_bf16_f32 v20, v20, v20
    v_lshlrev_b32 v20, 16, v20
    v_lshlrev_b32 v64, 16, v130
    v_add_f32 v20, v20, v64
    v_cvt_pk_bf16_f32 v20, v20, v20
    v_lshlrev_b32 v20, 16, v20
    v_cvt_pk_bf16_f32 v21, v21, v21
    v_lshlrev_b32 v21, 16, v21
    v_and_b32 v64, 0xffff0000, v130
    v_add_f32 v21, v21, v64
    v_cvt_pk_bf16_f32 v21, v21, v21
    v_lshlrev_b32 v21, 16, v21
    v_cvt_pk_bf16_f32 v22, v22, v22
    v_lshlrev_b32 v22, 16, v22
    v_lshlrev_b32 v64, 16, v131
    v_add_f32 v22, v22, v64
    v_cvt_pk_bf16_f32 v22, v22, v22
    v_lshlrev_b32 v22, 16, v22
    v_cvt_pk_bf16_f32 v23, v23, v23
    v_lshlrev_b32 v23, 16, v23
    v_and_b32 v64, 0xffff0000, v131
    v_add_f32 v23, v23, v64
    v_cvt_pk_bf16_f32 v23, v23, v23
    v_lshlrev_b32 v23, 16, v23
    v_cvt_pk_bf16_f32 v66, v20, v21
    v_cvt_pk_bf16_f32 v67, v22, v23
    global_store_dwordx2 v6, v[66:67], s[24:25] offset:512 sc1
    s_nop 1
    v_cvt_pk_bf16_f32 v24, v24, v24
    v_lshlrev_b32 v24, 16, v24
    v_lshlrev_b32 v64, 16, v132
    v_add_f32 v24, v24, v64
    v_cvt_pk_bf16_f32 v24, v24, v24
    v_lshlrev_b32 v24, 16, v24
    v_cvt_pk_bf16_f32 v25, v25, v25
    v_lshlrev_b32 v25, 16, v25
    v_and_b32 v64, 0xffff0000, v132
    v_add_f32 v25, v25, v64
    v_cvt_pk_bf16_f32 v25, v25, v25
    v_lshlrev_b32 v25, 16, v25
    v_cvt_pk_bf16_f32 v26, v26, v26
    v_lshlrev_b32 v26, 16, v26
    v_lshlrev_b32 v64, 16, v133
    v_add_f32 v26, v26, v64
    v_cvt_pk_bf16_f32 v26, v26, v26
    v_lshlrev_b32 v26, 16, v26
    v_cvt_pk_bf16_f32 v27, v27, v27
    v_lshlrev_b32 v27, 16, v27
    v_and_b32 v64, 0xffff0000, v133
    v_add_f32 v27, v27, v64
    v_cvt_pk_bf16_f32 v27, v27, v27
    v_lshlrev_b32 v27, 16, v27
    v_cvt_pk_bf16_f32 v66, v24, v25
    v_cvt_pk_bf16_f32 v67, v26, v27
    global_store_dwordx2 v6, v[66:67], s[24:25] offset:1024 sc1
    s_nop 1
    v_cvt_pk_bf16_f32 v28, v28, v28
    v_lshlrev_b32 v28, 16, v28
    v_lshlrev_b32 v64, 16, v134
    v_add_f32 v28, v28, v64
    v_cvt_pk_bf16_f32 v28, v28, v28
    v_lshlrev_b32 v28, 16, v28
    v_cvt_pk_bf16_f32 v29, v29, v29
    v_lshlrev_b32 v29, 16, v29
    v_and_b32 v64, 0xffff0000, v134
    v_add_f32 v29, v29, v64
    v_cvt_pk_bf16_f32 v29, v29, v29
    v_lshlrev_b32 v29, 16, v29
    v_cvt_pk_bf16_f32 v30, v30, v30
    v_lshlrev_b32 v30, 16, v30
    v_lshlrev_b32 v64, 16, v135
    v_add_f32 v30, v30, v64
    v_cvt_pk_bf16_f32 v30, v30, v30
    v_lshlrev_b32 v30, 16, v30
    v_cvt_pk_bf16_f32 v31, v31, v31
    v_lshlrev_b32 v31, 16, v31
    v_and_b32 v64, 0xffff0000, v135
    v_add_f32 v31, v31, v64
    v_cvt_pk_bf16_f32 v31, v31, v31
    v_lshlrev_b32 v31, 16, v31
    v_cvt_pk_bf16_f32 v66, v28, v29
    v_cvt_pk_bf16_f32 v67, v30, v31
    global_store_dwordx2 v6, v[66:67], s[24:25] offset:1536 sc1
    s_nop 1
    v_cvt_pk_bf16_f32 v32, v32, v32
    v_lshlrev_b32 v32, 16, v32
    v_lshlrev_b32 v64, 16, v136
    v_add_f32 v32, v32, v64
    v_cvt_pk_bf16_f32 v32, v32, v32
    v_lshlrev_b32 v32, 16, v32
    v_cvt_pk_bf16_f32 v33, v33, v33
    v_lshlrev_b32 v33, 16, v33
    v_and_b32 v64, 0xffff0000, v136
    v_add_f32 v33, v33, v64
    v_cvt_pk_bf16_f32 v33, v33, v33
    v_lshlrev_b32 v33, 16, v33
    v_cvt_pk_bf16_f32 v34, v34, v34
    v_lshlrev_b32 v34, 16, v34
    v_lshlrev_b32 v64, 16, v137
    v_add_f32 v34, v34, v64
    v_cvt_pk_bf16_f32 v34, v34, v34
    v_lshlrev_b32 v34, 16, v34
    v_cvt_pk_bf16_f32 v35, v35, v35
    v_lshlrev_b32 v35, 16, v35
    v_and_b32 v64, 0xffff0000, v137
    v_add_f32 v35, v35, v64
    v_cvt_pk_bf16_f32 v35, v35, v35
    v_lshlrev_b32 v35, 16, v35
    v_cvt_pk_bf16_f32 v66, v32, v33
    v_cvt_pk_bf16_f32 v67, v34, v35
    global_store_dwordx2 v6, v[66:67], s[24:25] offset:2048 sc1
    s_nop 1
    v_cvt_pk_bf16_f32 v36, v36, v36
    v_lshlrev_b32 v36, 16, v36
    v_lshlrev_b32 v64, 16, v138
    v_add_f32 v36, v36, v64
    v_cvt_pk_bf16_f32 v36, v36, v36
    v_lshlrev_b32 v36, 16, v36
    v_cvt_pk_bf16_f32 v37, v37, v37
    v_lshlrev_b32 v37, 16, v37
    v_and_b32 v64, 0xffff0000, v138
    v_add_f32 v37, v37, v64
    v_cvt_pk_bf16_f32 v37, v37, v37
    v_lshlrev_b32 v37, 16, v37
    v_cvt_pk_bf16_f32 v38, v38, v38
    v_lshlrev_b32 v38, 16, v38
    v_lshlrev_b32 v64, 16, v139
    v_add_f32 v38, v38, v64
    v_cvt_pk_bf16_f32 v38, v38, v38
    v_lshlrev_b32 v38, 16, v38
    v_cvt_pk_bf16_f32 v39, v39, v39
    v_lshlrev_b32 v39, 16, v39
    v_and_b32 v64, 0xffff0000, v139
    v_add_f32 v39, v39, v64
    v_cvt_pk_bf16_f32 v39, v39, v39
    v_lshlrev_b32 v39, 16, v39
    v_cvt_pk_bf16_f32 v66, v36, v37
    v_cvt_pk_bf16_f32 v67, v38, v39
    global_store_dwordx2 v6, v[66:67], s[24:25] offset:2560 sc1
    s_nop 1
    v_add_f32 v48, v16, v17
    v_add_f32 v48, v48, v18
    v_add_f32 v48, v48, v19
    v_add_f32 v48, v48, v20
    v_add_f32 v48, v48, v21
    v_add_f32 v48, v48, v22
    v_add_f32 v48, v48, v23
    v_add_f32 v48, v48, v24
    v_add_f32 v48, v48, v25
    v_add_f32 v48, v48, v26
    v_add_f32 v48, v48, v27
    v_add_f32 v48, v48, v28
    v_add_f32 v48, v48, v29
    v_add_f32 v48, v48, v30
    v_add_f32 v48, v48, v31
    v_add_f32 v48, v48, v32
    v_add_f32 v48, v48, v33
    v_add_f32 v48, v48, v34
    v_add_f32 v48, v48, v35
    v_add_f32 v48, v48, v36
    v_add_f32 v48, v48, v37
    v_add_f32 v48, v48, v38
    v_add_f32 v48, v48, v39
    v_mov_b32 v49, v48
    s_nop 1
    v_permlane32_swap_b32 v48, v49
    s_nop 1
    v_add_f32 v48, v48, v49
    v_mov_b32 v49, v48
    s_nop 1
    v_permlane16_swap_b32 v48, v49
    s_nop 1
    v_add_f32 v48, v48, v49
    ds_write_b32 v11, v48
    s_waitcnt lgkmcnt(0)
    s_barrier
    ds_read_b32 v64, v12 offset:0
    ds_read_b32 v65, v12 offset:64
    ds_read_b32 v66, v12 offset:128
    ds_read_b32 v67, v12 offset:192
    s_waitcnt lgkmcnt(0)
    v_add_f32 v48, v64, v65
    v_add_f32 v49, v66, v67
    v_add_f32 v48, v48, v49
    v_mul_f32 v48, 0x3b124925, v48
    v_sub_f32 v49, v16, v48
    v_mul_f32 v50, v49, v49
    v_sub_f32 v49, v17, v48
    v_fmac_f32 v50, v49, v49
    v_sub_f32 v49, v18, v48
    v_fmac_f32 v50, v49, v49
    v_sub_f32 v49, v19, v48
    v_fmac_f32 v50, v49, v49
    v_sub_f32 v49, v20, v48
    v_fmac_f32 v50, v49, v49
    v_sub_f32 v49, v21, v48
    v_fmac_f32 v50, v49, v49
    v_sub_f32 v49, v22, v48
    v_fmac_f32 v50, v49, v49
    v_sub_f32 v49, v23, v48
    v_fmac_f32 v50, v49, v49
    v_sub_f32 v49, v24, v48
    v_fmac_f32 v50, v49, v49
    v_sub_f32 v49, v25, v48
    v_fmac_f32 v50, v49, v49
    v_sub_f32 v49, v26, v48
    v_fmac_f32 v50, v49, v49
    v_sub_f32 v49, v27, v48
    v_fmac_f32 v50, v49, v49
    v_sub_f32 v49, v28, v48
    v_fmac_f32 v50, v49, v49
    v_sub_f32 v49, v29, v48
    v_fmac_f32 v50, v49, v49
    v_sub_f32 v49, v30, v48
    v_fmac_f32 v50, v49, v49
    v_sub_f32 v49, v31, v48
    v_fmac_f32 v50, v49, v49
    v_sub_f32 v49, v32, v48
    v_fmac_f32 v50, v49, v49
    v_sub_f32 v49, v33, v48
    v_fmac_f32 v50, v49, v49
    v_sub_f32 v49, v34, v48
    v_fmac_f32 v50, v49, v49
    v_sub_f32 v49, v35, v48
    v_fmac_f32 v50, v49, v49
    v_sub_f32 v49, v36, v48
    v_fmac_f32 v50, v49, v49
    v_sub_f32 v49, v37, v48
    v_fmac_f32 v50, v49, v49
    v_sub_f32 v49, v38, v48
    v_fmac_f32 v50, v49, v49
    v_sub_f32 v49, v39, v48
    v_fmac_f32 v50, v49, v49
    v_mov_b32 v49, v50
    s_nop 1
    v_permlane32_swap_b32 v50, v49
    s_nop 1
    v_add_f32 v50, v50, v49
    v_mov_b32 v49, v50
    s_nop 1
    v_permlane16_swap_b32 v50, v49
    s_nop 1
    v_add_f32 v50, v50, v49
    ds_write_b32 v11, v50 offset:256
    s_waitcnt lgkmcnt(0)
    s_barrier
    ds_read_b32 v64, v12 offset:256
    ds_read_b32 v65, v12 offset:320
    ds_read_b32 v66, v12 offset:384
    ds_read_b32 v67, v12 offset:448
    s_waitcnt lgkmcnt(0)
    v_add_f32 v50, v64, v65
    v_add_f32 v49, v66, v67
    v_add_f32 v50, v50, v49
    v_mul_f32 v50, 0x3b124925, v50
    v_cvt_pk_bf16_f32 v50, v50, v50
    v_lshlrev_b32 v50, 16, v50
    v_cvt_pk_bf16_f32 v48, v48, v48
    v_lshlrev_b32 v48, 16, v48
    v_add_f32 v50, 0x3727c5ac, v50
    v_cvt_pk_bf16_f32 v50, v50, v50
    v_lshlrev_b32 v50, 16, v50
    v_sqrt_f32 v50, v50
    s_nop 0
    v_cvt_pk_bf16_f32 v50, v50, v50
    v_lshlrev_b32 v50, 16, v50
    v_rcp_f32 v51, v50
    s_nop 0
    v_sub_f32 v16, v16, v48
    v_cvt_pk_bf16_f32 v16, v16, v16
    v_lshlrev_b32 v16, 16, v16
    v_mul_f32 v49, v16, v51
    v_fma_f32 v52, -v49, v50, v16
    v_fma_f32 v16, v52, v51, v49
    v_sub_f32 v17, v17, v48
    v_cvt_pk_bf16_f32 v17, v17, v17
    v_lshlrev_b32 v17, 16, v17
    v_mul_f32 v49, v17, v51
    v_fma_f32 v52, -v49, v50, v17
    v_fma_f32 v17, v52, v51, v49
    v_sub_f32 v18, v18, v48
    v_cvt_pk_bf16_f32 v18, v18, v18
    v_lshlrev_b32 v18, 16, v18
    v_mul_f32 v49, v18, v51
    v_fma_f32 v52, -v49, v50, v18
    v_fma_f32 v18, v52, v51, v49
    v_sub_f32 v19, v19, v48
    v_cvt_pk_bf16_f32 v19, v19, v19
    v_lshlrev_b32 v19, 16, v19
    v_mul_f32 v49, v19, v51
    v_fma_f32 v52, -v49, v50, v19
    v_fma_f32 v19, v52, v51, v49
    v_sub_f32 v20, v20, v48
    v_cvt_pk_bf16_f32 v20, v20, v20
    v_lshlrev_b32 v20, 16, v20
    v_mul_f32 v49, v20, v51
    v_fma_f32 v52, -v49, v50, v20
    v_fma_f32 v20, v52, v51, v49
    v_sub_f32 v21, v21, v48
    v_cvt_pk_bf16_f32 v21, v21, v21
    v_lshlrev_b32 v21, 16, v21
    v_mul_f32 v49, v21, v51
    v_fma_f32 v52, -v49, v50, v21
    v_fma_f32 v21, v52, v51, v49
    v_sub_f32 v22, v22, v48
    v_cvt_pk_bf16_f32 v22, v22, v22
    v_lshlrev_b32 v22, 16, v22
    v_mul_f32 v49, v22, v51
    v_fma_f32 v52, -v49, v50, v22
    v_fma_f32 v22, v52, v51, v49
    v_sub_f32 v23, v23, v48
    v_cvt_pk_bf16_f32 v23, v23, v23
    v_lshlrev_b32 v23, 16, v23
    v_mul_f32 v49, v23, v51
    v_fma_f32 v52, -v49, v50, v23
    v_fma_f32 v23, v52, v51, v49
    v_sub_f32 v24, v24, v48
    v_cvt_pk_bf16_f32 v24, v24, v24
    v_lshlrev_b32 v24, 16, v24
    v_mul_f32 v49, v24, v51
    v_fma_f32 v52, -v49, v50, v24
    v_fma_f32 v24, v52, v51, v49
    v_sub_f32 v25, v25, v48
    v_cvt_pk_bf16_f32 v25, v25, v25
    v_lshlrev_b32 v25, 16, v25
    v_mul_f32 v49, v25, v51
    v_fma_f32 v52, -v49, v50, v25
    v_fma_f32 v25, v52, v51, v49
    v_sub_f32 v26, v26, v48
    v_cvt_pk_bf16_f32 v26, v26, v26
    v_lshlrev_b32 v26, 16, v26
    v_mul_f32 v49, v26, v51
    v_fma_f32 v52, -v49, v50, v26
    v_fma_f32 v26, v52, v51, v49
    v_sub_f32 v27, v27, v48
    v_cvt_pk_bf16_f32 v27, v27, v27
    v_lshlrev_b32 v27, 16, v27
    v_mul_f32 v49, v27, v51
    v_fma_f32 v52, -v49, v50, v27
    v_fma_f32 v27, v52, v51, v49
    v_sub_f32 v28, v28, v48
    v_cvt_pk_bf16_f32 v28, v28, v28
    v_lshlrev_b32 v28, 16, v28
    v_mul_f32 v49, v28, v51
    v_fma_f32 v52, -v49, v50, v28
    v_fma_f32 v28, v52, v51, v49
    v_sub_f32 v29, v29, v48
    v_cvt_pk_bf16_f32 v29, v29, v29
    v_lshlrev_b32 v29, 16, v29
    v_mul_f32 v49, v29, v51
    v_fma_f32 v52, -v49, v50, v29
    v_fma_f32 v29, v52, v51, v49
    v_sub_f32 v30, v30, v48
    v_cvt_pk_bf16_f32 v30, v30, v30
    v_lshlrev_b32 v30, 16, v30
    v_mul_f32 v49, v30, v51
    v_fma_f32 v52, -v49, v50, v30
    v_fma_f32 v30, v52, v51, v49
    v_sub_f32 v31, v31, v48
    v_cvt_pk_bf16_f32 v31, v31, v31
    v_lshlrev_b32 v31, 16, v31
    v_mul_f32 v49, v31, v51
    v_fma_f32 v52, -v49, v50, v31
    v_fma_f32 v31, v52, v51, v49
    v_sub_f32 v32, v32, v48
    v_cvt_pk_bf16_f32 v32, v32, v32
    v_lshlrev_b32 v32, 16, v32
    v_mul_f32 v49, v32, v51
    v_fma_f32 v52, -v49, v50, v32
    v_fma_f32 v32, v52, v51, v49
    v_sub_f32 v33, v33, v48
    v_cvt_pk_bf16_f32 v33, v33, v33
    v_lshlrev_b32 v33, 16, v33
    v_mul_f32 v49, v33, v51
    v_fma_f32 v52, -v49, v50, v33
    v_fma_f32 v33, v52, v51, v49
    v_sub_f32 v34, v34, v48
    v_cvt_pk_bf16_f32 v34, v34, v34
    v_lshlrev_b32 v34, 16, v34
    v_mul_f32 v49, v34, v51
    v_fma_f32 v52, -v49, v50, v34
    v_fma_f32 v34, v52, v51, v49
    v_sub_f32 v35, v35, v48
    v_cvt_pk_bf16_f32 v35, v35, v35
    v_lshlrev_b32 v35, 16, v35
    v_mul_f32 v49, v35, v51
    v_fma_f32 v52, -v49, v50, v35
    v_fma_f32 v35, v52, v51, v49
    v_sub_f32 v36, v36, v48
    v_cvt_pk_bf16_f32 v36, v36, v36
    v_lshlrev_b32 v36, 16, v36
    v_mul_f32 v49, v36, v51
    v_fma_f32 v52, -v49, v50, v36
    v_fma_f32 v36, v52, v51, v49
    v_sub_f32 v37, v37, v48
    v_cvt_pk_bf16_f32 v37, v37, v37
    v_lshlrev_b32 v37, 16, v37
    v_mul_f32 v49, v37, v51
    v_fma_f32 v52, -v49, v50, v37
    v_fma_f32 v37, v52, v51, v49
    v_sub_f32 v38, v38, v48
    v_cvt_pk_bf16_f32 v38, v38, v38
    v_lshlrev_b32 v38, 16, v38
    v_mul_f32 v49, v38, v51
    v_fma_f32 v52, -v49, v50, v38
    v_fma_f32 v38, v52, v51, v49
    v_sub_f32 v39, v39, v48
    v_cvt_pk_bf16_f32 v39, v39, v39
    v_lshlrev_b32 v39, 16, v39
    v_mul_f32 v49, v39, v51
    v_fma_f32 v52, -v49, v50, v39
    v_fma_f32 v39, v52, v51, v49
    v_cvt_pk_bf16_f32 v64, v16, v17
    v_cvt_pk_bf16_f32 v65, v18, v19
    v_cvt_pk_bf16_f32 v66, v20, v21
    v_cvt_pk_bf16_f32 v67, v22, v23
    global_store_dwordx4 v4, v[64:67], s[26:27] offset:0 sc1
    v_cvt_pk_bf16_f32 v68, v24, v25
    v_cvt_pk_bf16_f32 v69, v26, v27
    v_cvt_pk_bf16_f32 v70, v28, v29
    v_cvt_pk_bf16_f32 v71, v30, v31
    global_store_dwordx4 v4, v[68:71], s[26:27] offset:1024 sc1
    v_cvt_pk_bf16_f32 v72, v32, v33
    v_cvt_pk_bf16_f32 v73, v34, v35
    v_cvt_pk_bf16_f32 v74, v36, v37
    v_cvt_pk_bf16_f32 v75, v38, v39
    global_store_dwordx4 v4, v[72:75], s[26:27] offset:2048 sc1
.chain_kernel_d97:
    s_branch .chain_kernel_fin79
.chain_kernel_ty76:
    v_lshrrev_b32 v2, 6, v0
    v_and_b32 v1, 63, v0
    s_nop 0
    v_readfirstlane_b32 s18, v2
    v_lshrrev_b32 v2, 4, v1
    v_and_b32 v3, 15, v1
    s_lshr_b32 s20, s2, 6
    s_and_b32 s21, s2, 63
    s_lshl_b32 s22, s20, 2
    s_add_u32 s22, s22, s18
    v_lshlrev_b32 v4, 4, v1
    s_waitcnt lgkmcnt(0)
    s_mul_i32 s38, s22, 28672
    s_add_u32 s38, s38, 0xfc1000
    s_add_u32 s24, s16, s38
    s_addc_u32 s25, s17, 0
    global_load_dwordx4 a[0:3], v4, s[24:25] offset:0
    global_load_dwordx4 a[4:7], v4, s[24:25] offset:1024
    global_load_dwordx4 a[8:11], v4, s[24:25] offset:2048
    global_load_dwordx4 a[12:15], v4, s[24:25] offset:3072
    s_add_u32 s24, s24, 4096
    s_addc_u32 s25, s25, 0
    global_load_dwordx4 a[16:19], v4, s[24:25] offset:0
    global_load_dwordx4 a[20:23], v4, s[24:25] offset:1024
    global_load_dwordx4 a[24:27], v4, s[24:25] offset:2048
    global_load_dwordx4 a[28:31], v4, s[24:25] offset:3072
    s_add_u32 s24, s24, 4096
    s_addc_u32 s25, s25, 0
    global_load_dwordx4 a[32:35], v4, s[24:25] offset:0
    global_load_dwordx4 a[36:39], v4, s[24:25] offset:1024
    global_load_dwordx4 a[40:43], v4, s[24:25] offset:2048
    global_load_dwordx4 a[44:47], v4, s[24:25] offset:3072
    s_add_u32 s24, s24, 4096
    s_addc_u32 s25, s25, 0
    global_load_dwordx4 a[48:51], v4, s[24:25] offset:0
    global_load_dwordx4 a[52:55], v4, s[24:25] offset:1024
    global_load_dwordx4 a[56:59], v4, s[24:25] offset:2048
    global_load_dwordx4 a[60:63], v4, s[24:25] offset:3072
    s_add_u32 s24, s24, 4096
    s_addc_u32 s25, s25, 0
    global_load_dwordx4 a[64:67], v4, s[24:25] offset:0
    global_load_dwordx4 a[68:71], v4, s[24:25] offset:1024
    global_load_dwordx4 a[72:75], v4, s[24:25] offset:2048
    global_load_dwordx4 a[76:79], v4, s[24:25] offset:3072
    s_add_u32 s24, s24, 4096
    s_addc_u32 s25, s25, 0
    global_load_dwordx4 a[80:83], v4, s[24:25] offset:0
    global_load_dwordx4 a[84:87], v4, s[24:25] offset:1024
    global_load_dwordx4 a[88:91], v4, s[24:25] offset:2048
    global_load_dwordx4 a[92:95], v4, s[24:25] offset:3072
    s_add_u32 s24, s24, 4096
    s_addc_u32 s25, s25, 0
    global_load_dwordx4 a[96:99], v4, s[24:25] offset:0
    global_load_dwordx4 a[100:103], v4, s[24:25] offset:1024
    global_load_dwordx4 a[104:107], v4, s[24:25] offset:2048
    global_load_dwordx4 a[108:111], v4, s[24:25] offset:3072
    s_mul_i32 s38, s22, 28672
    s_add_u32 s38, s38, 0x1149000
    s_add_u32 s24, s16, s38
    s_addc_u32 s25, s17, 0
    global_load_dwordx4 a[112:115], v4, s[24:25] offset:0
    global_load_dwordx4 a[116:119], v4, s[24:25] offset:1024
    global_load_dwordx4 a[120:123], v4, s[24:25] offset:2048
    global_load_dwordx4 a[124:127], v4, s[24:25] offset:3072
    s_add_u32 s24, s24, 4096
    s_addc_u32 s25, s25, 0
    global_load_dwordx4 a[128:131], v4, s[24:25] offset:0
    global_load_dwordx4 a[132:135], v4, s[24:25] offset:1024
    global_load_dwordx4 a[136:139], v4, s[24:25] offset:2048
    global_load_dwordx4 a[140:143], v4, s[24:25] offset:3072
    s_add_u32 s24, s24, 4096
    s_addc_u32 s25, s25, 0
    global_load_dwordx4 a[144:147], v4, s[24:25] offset:0
    global_load_dwordx4 a[148:151], v4, s[24:25] offset:1024
    global_load_dwordx4 a[152:155], v4, s[24:25] offset:2048
    global_load_dwordx4 a[156:159], v4, s[24:25] offset:3072
    s_add_u32 s24, s24, 4096
    s_addc_u32 s25, s25, 0
    global_load_dwordx4 a[160:163], v4, s[24:25] offset:0
    global_load_dwordx4 a[164:167], v4, s[24:25] offset:1024
    global_load_dwordx4 a[168:171], v4, s[24:25] offset:2048
    global_load_dwordx4 a[172:175], v4, s[24:25] offset:3072
    s_add_u32 s24, s24, 4096
    s_addc_u32 s25, s25, 0
    global_load_dwordx4 a[176:179], v4, s[24:25] offset:0
    global_load_dwordx4 a[180:183], v4, s[24:25] offset:1024
    global_load_dwordx4 a[184:187], v4, s[24:25] offset:2048
    global_load_dwordx4 a[188:191], v4, s[24:25] offset:3072
    s_add_u32 s24, s24, 4096
    s_addc_u32 s25, s25, 0
    global_load_dwordx4 a[192:195], v4, s[24:25] offset:0
    global_load_dwordx4 a[196:199], v4, s[24:25] offset:1024
    global_load_dwordx4 a[200:203], v4, s[24:25] offset:2048
    global_load_dwordx4 a[204:207], v4, s[24:25] offset:3072
    s_add_u32 s24, s24, 4096
    s_addc_u32 s25, s25, 0
    global_load_dwordx4 a[208:211], v4, s[24:25] offset:0
    global_load_dwordx4 a[212:215], v4, s[24:25] offset:1024
    global_load_dwordx4 a[216:219], v4, s[24:25] offset:2048
    global_load_dwordx4 a[220:223], v4, s[24:25] offset:3072
    s_cmp_lg_u32 s18, 0
    s_cbranch_scc1 .chain_kernel_dpx98
    s_and_b32 s88, s85, 63
    s_lshl_b32 s88, s88, 2
    s_add_u32 s88, s88, 576
    s_mov_b64 exec, 1
    s_add_u32 s46, s16, 0x0
    s_addc_u32 s47, s17, 0
    v_mov_b32 v8, v10
    v_mov_b32 v9, v11
    v_mov_b32 v10, s88
    s_mov_b32 s45, 0
.chain_kernel_wc99:
    global_load_dword v11, v10, s[46:47] sc1
    s_waitcnt vmcnt(0)
    v_readfirstlane_b32 s38, v11
    s_nop 3
    s_cmp_ge_u32 s38, 2
    s_cbranch_scc1 .chain_kernel_wcd100
    s_sleep 14
    s_add_u32 s45, s45, 1
    s_cmp_lt_u32 s45, 1048576
    s_cbranch_scc1 .chain_kernel_wc99
    s_branch .chain_kernel_end1
.chain_kernel_wcd100:
    v_mov_b32 v10, v8
    v_mov_b32 v11, v9
    s_mov_b64 exec, -1
.chain_kernel_dpx98:
    s_barrier
    s_mul_i32 s38, s21, 28672
    s_add_u32 s38, s38, 0x5c5d000
    s_add_u32 s26, s16, s38
    s_addc_u32 s27, s17, 0
    s_lshl_b32 s38, s21, 1
    s_mul_i32 s38, s38, 56
    s_add_u32 s38, s38, s22
    s_lshl_b32 s38, s38, 10
    s_add_u32 s38, s38, 0x5e1d000
    s_add_u32 s28, s16, s38
    s_addc_u32 s29, s17, 0
    global_load_dwordx4 v[16:19], v4, s[26:27] offset:0
    global_load_dwordx4 v[20:23], v4, s[26:27] offset:1024
    global_load_dwordx4 v[24:27], v4, s[26:27] offset:2048
    global_load_dwordx4 v[28:31], v4, s[26:27] offset:3072
    s_add_u32 s26, s26, 4096
    s_addc_u32 s27, s27, 0
    global_load_dwordx4 v[32:35], v4, s[26:27] offset:0
    global_load_dwordx4 v[36:39], v4, s[26:27] offset:1024
    global_load_dwordx4 v[40:43], v4, s[26:27] offset:2048
    global_load_dwordx4 v[44:47], v4, s[26:27] offset:3072
    s_add_u32 s26, s26, 4096
    s_addc_u32 s27, s27, 0
    global_load_dwordx4 v[48:51], v4, s[26:27] offset:0
    global_load_dwordx4 v[52:55], v4, s[26:27] offset:1024
    global_load_dwordx4 v[56:59], v4, s[26:27] offset:2048
    global_load_dwordx4 v[60:63], v4, s[26:27] offset:3072
    s_add_u32 s26, s26, 4096
    s_addc_u32 s27, s27, 0
    global_load_dwordx4 v[64:67], v4, s[26:27] offset:0
    global_load_dwordx4 v[68:71], v4, s[26:27] offset:1024
    global_load_dwordx4 v[72:75], v4, s[26:27] offset:2048
    global_load_dwordx4 v[76:79], v4, s[26:27] offset:3072
    s_add_u32 s26, s26, 4096
    s_addc_u32 s27, s27, 0
    global_load_dwordx4 v[80:83], v4, s[26:27] offset:0
    global_load_dwordx4 v[84:87], v4, s[26:27] offset:1024
    global_load_dwordx4 v[88:91], v4, s[26:27] offset:2048
    global_load_dwordx4 v[92:95], v4, s[26:27] offset:3072
    s_add_u32 s26, s26, 4096
    s_addc_u32 s27, s27, 0
    global_load_dwordx4 v[96:99], v4, s[26:27] offset:0
    global_load_dwordx4 v[100:103], v4, s[26:27] offset:1024
    global_load_dwordx4 v[104:107], v4, s[26:27] offset:2048
    global_load_dwordx4 v[108:111], v4, s[26:27] offset:3072
    s_add_u32 s26, s26, 4096
    s_addc_u32 s27, s27, 0
    global_load_dwordx4 v[112:115], v4, s[26:27] offset:0
    global_load_dwordx4 v[116:119], v4, s[26:27] offset:1024
    global_load_dwordx4 v[120:123], v4, s[26:27] offset:2048
    global_load_dwordx4 v[124:127], v4, s[26:27] offset:3072
    s_waitcnt vmcnt(27)
    v_mfma_f32_16x16x32_bf16 v[128:131], a[0:3], v[16:19], 0
    v_mfma_f32_16x16x32_bf16 v[132:135], a[56:59], v[16:19], 0
    v_mfma_f32_16x16x32_bf16 v[136:139], a[112:115], v[16:19], 0
    v_mfma_f32_16x16x32_bf16 v[140:143], a[168:171], v[16:19], 0
    s_waitcnt vmcnt(26)
    v_mfma_f32_16x16x32_bf16 v[128:131], a[4:7], v[20:23], v[128:131]
    v_mfma_f32_16x16x32_bf16 v[132:135], a[60:63], v[20:23], v[132:135]
    v_mfma_f32_16x16x32_bf16 v[136:139], a[116:119], v[20:23], v[136:139]
    v_mfma_f32_16x16x32_bf16 v[140:143], a[172:175], v[20:23], v[140:143]
    s_waitcnt vmcnt(25)
    v_mfma_f32_16x16x32_bf16 v[128:131], a[8:11], v[24:27], v[128:131]
    v_mfma_f32_16x16x32_bf16 v[132:135], a[64:67], v[24:27], v[132:135]
    v_mfma_f32_16x16x32_bf16 v[136:139], a[120:123], v[24:27], v[136:139]
    v_mfma_f32_16x16x32_bf16 v[140:143], a[176:179], v[24:27], v[140:143]
    s_waitcnt vmcnt(24)
    v_mfma_f32_16x16x32_bf16 v[128:131], a[12:15], v[28:31], v[128:131]
    v_mfma_f32_16x16x32_bf16 v[132:135], a[68:71], v[28:31], v[132:135]
    v_mfma_f32_16x16x32_bf16 v[136:139], a[124:127], v[28:31], v[136:139]
    v_mfma_f32_16x16x32_bf16 v[140:143], a[180:183], v[28:31], v[140:143]
    s_waitcnt vmcnt(23)
    v_mfma_f32_16x16x32_bf16 v[128:131], a[16:19], v[32:35], v[128:131]
    v_mfma_f32_16x16x32_bf16 v[132:135], a[72:75], v[32:35], v[132:135]
    v_mfma_f32_16x16x32_bf16 v[136:139], a[128:131], v[32:35], v[136:139]
    v_mfma_f32_16x16x32_bf16 v[140:143], a[184:187], v[32:35], v[140:143]
    s_waitcnt vmcnt(22)
    v_mfma_f32_16x16x32_bf16 v[128:131], a[20:23], v[36:39], v[128:131]
    v_mfma_f32_16x16x32_bf16 v[132:135], a[76:79], v[36:39], v[132:135]
    v_mfma_f32_16x16x32_bf16 v[136:139], a[132:135], v[36:39], v[136:139]
    v_mfma_f32_16x16x32_bf16 v[140:143], a[188:191], v[36:39], v[140:143]
    s_waitcnt vmcnt(21)
    v_mfma_f32_16x16x32_bf16 v[128:131], a[24:27], v[40:43], v[128:131]
    v_mfma_f32_16x16x32_bf16 v[132:135], a[80:83], v[40:43], v[132:135]
    v_mfma_f32_16x16x32_bf16 v[136:139], a[136:139], v[40:43], v[136:139]
    v_mfma_f32_16x16x32_bf16 v[140:143], a[192:195], v[40:43], v[140:143]
    s_waitcnt vmcnt(20)
    v_mfma_f32_16x16x32_bf16 v[128:131], a[28:31], v[44:47], v[128:131]
    v_mfma_f32_16x16x32_bf16 v[132:135], a[84:87], v[44:47], v[132:135]
    v_mfma_f32_16x16x32_bf16 v[136:139], a[140:143], v[44:47], v[136:139]
    v_mfma_f32_16x16x32_bf16 v[140:143], a[196:199], v[44:47], v[140:143]
    s_waitcnt vmcnt(19)
    v_mfma_f32_16x16x32_bf16 v[128:131], a[32:35], v[48:51], v[128:131]
    v_mfma_f32_16x16x32_bf16 v[132:135], a[88:91], v[48:51], v[132:135]
    v_mfma_f32_16x16x32_bf16 v[136:139], a[144:147], v[48:51], v[136:139]
    v_mfma_f32_16x16x32_bf16 v[140:143], a[200:203], v[48:51], v[140:143]
    s_waitcnt vmcnt(18)
    v_mfma_f32_16x16x32_bf16 v[128:131], a[36:39], v[52:55], v[128:131]
    v_mfma_f32_16x16x32_bf16 v[132:135], a[92:95], v[52:55], v[132:135]
    v_mfma_f32_16x16x32_bf16 v[136:139], a[148:151], v[52:55], v[136:139]
    v_mfma_f32_16x16x32_bf16 v[140:143], a[204:207], v[52:55], v[140:143]
    s_waitcnt vmcnt(17)
    v_mfma_f32_16x16x32_bf16 v[128:131], a[40:43], v[56:59], v[128:131]
    v_mfma_f32_16x16x32_bf16 v[132:135], a[96:99], v[56:59], v[132:135]
    v_mfma_f32_16x16x32_bf16 v[136:139], a[152:155], v[56:59], v[136:139]
    v_mfma_f32_16x16x32_bf16 v[140:143], a[208:211], v[56:59], v[140:143]
    s_waitcnt vmcnt(16)
    v_mfma_f32_16x16x32_bf16 v[128:131], a[44:47], v[60:63], v[128:131]
    v_mfma_f32_16x16x32_bf16 v[132:135], a[100:103], v[60:63], v[132:135]
    v_mfma_f32_16x16x32_bf16 v[136:139], a[156:159], v[60:63], v[136:139]
    v_mfma_f32_16x16x32_bf16 v[140:143], a[212:215], v[60:63], v[140:143]
    s_waitcnt vmcnt(15)
    v_mfma_f32_16x16x32_bf16 v[128:131], a[48:51], v[64:67], v[128:131]
    v_mfma_f32_16x16x32_bf16 v[132:135], a[104:107], v[64:67], v[132:135]
    v_mfma_f32_16x16x32_bf16 v[136:139], a[160:163], v[64:67], v[136:139]
    v_mfma_f32_16x16x32_bf16 v[140:143], a[216:219], v[64:67], v[140:143]
    s_waitcnt vmcnt(14)
    v_mfma_f32_16x16x32_bf16 v[128:131], a[52:55], v[68:71], v[128:131]
    v_mfma_f32_16x16x32_bf16 v[132:135], a[108:111], v[68:71], v[132:135]
    v_mfma_f32_16x16x32_bf16 v[136:139], a[164:167], v[68:71], v[136:139]
    v_mfma_f32_16x16x32_bf16 v[140:143], a[220:223], v[68:71], v[140:143]
    s_waitcnt vmcnt(13)
    v_mfma_f32_16x16x32_bf16 v[144:147], a[0:3], v[72:75], 0
    v_mfma_f32_16x16x32_bf16 v[148:151], a[56:59], v[72:75], 0
    v_mfma_f32_16x16x32_bf16 v[152:155], a[112:115], v[72:75], 0
    v_mfma_f32_16x16x32_bf16 v[156:159], a[168:171], v[72:75], 0
    s_waitcnt vmcnt(12)
    v_mfma_f32_16x16x32_bf16 v[144:147], a[4:7], v[76:79], v[144:147]
    v_mfma_f32_16x16x32_bf16 v[148:151], a[60:63], v[76:79], v[148:151]
    v_mfma_f32_16x16x32_bf16 v[152:155], a[116:119], v[76:79], v[152:155]
    v_mfma_f32_16x16x32_bf16 v[156:159], a[172:175], v[76:79], v[156:159]
    s_waitcnt vmcnt(11)
    v_mfma_f32_16x16x32_bf16 v[144:147], a[8:11], v[80:83], v[144:147]
    v_mfma_f32_16x16x32_bf16 v[148:151], a[64:67], v[80:83], v[148:151]
    v_mfma_f32_16x16x32_bf16 v[152:155], a[120:123], v[80:83], v[152:155]
    v_mfma_f32_16x16x32_bf16 v[156:159], a[176:179], v[80:83], v[156:159]
    s_waitcnt vmcnt(10)
    v_mfma_f32_16x16x32_bf16 v[144:147], a[12:15], v[84:87], v[144:147]
    v_mfma_f32_16x16x32_bf16 v[148:151], a[68:71], v[84:87], v[148:151]
    v_mfma_f32_16x16x32_bf16 v[152:155], a[124:127], v[84:87], v[152:155]
    v_mfma_f32_16x16x32_bf16 v[156:159], a[180:183], v[84:87], v[156:159]
    s_waitcnt vmcnt(9)
    v_mfma_f32_16x16x32_bf16 v[144:147], a[16:19], v[88:91], v[144:147]
    v_mfma_f32_16x16x32_bf16 v[148:151], a[72:75], v[88:91], v[148:151]
    v_mfma_f32_16x16x32_bf16 v[152:155], a[128:131], v[88:91], v[152:155]
    v_mfma_f32_16x16x32_bf16 v[156:159], a[184:187], v[88:91], v[156:159]
    s_waitcnt vmcnt(8)
    v_mfma_f32_16x16x32_bf16 v[144:147], a[20:23], v[92:95], v[144:147]
    v_mfma_f32_16x16x32_bf16 v[148:151], a[76:79], v[92:95], v[148:151]
    v_mfma_f32_16x16x32_bf16 v[152:155], a[132:135], v[92:95], v[152:155]
    v_mfma_f32_16x16x32_bf16 v[156:159], a[188:191], v[92:95], v[156:159]
    s_waitcnt vmcnt(7)
    v_mfma_f32_16x16x32_bf16 v[144:147], a[24:27], v[96:99], v[144:147]
    v_mfma_f32_16x16x32_bf16 v[148:151], a[80:83], v[96:99], v[148:151]
    v_mfma_f32_16x16x32_bf16 v[152:155], a[136:139], v[96:99], v[152:155]
    v_mfma_f32_16x16x32_bf16 v[156:159], a[192:195], v[96:99], v[156:159]
    s_waitcnt vmcnt(6)
    v_mfma_f32_16x16x32_bf16 v[144:147], a[28:31], v[100:103], v[144:147]
    v_mfma_f32_16x16x32_bf16 v[148:151], a[84:87], v[100:103], v[148:151]
    v_mfma_f32_16x16x32_bf16 v[152:155], a[140:143], v[100:103], v[152:155]
    v_mfma_f32_16x16x32_bf16 v[156:159], a[196:199], v[100:103], v[156:159]
    s_waitcnt vmcnt(5)
    v_mfma_f32_16x16x32_bf16 v[144:147], a[32:35], v[104:107], v[144:147]
    v_mfma_f32_16x16x32_bf16 v[148:151], a[88:91], v[104:107], v[148:151]
    v_mfma_f32_16x16x32_bf16 v[152:155], a[144:147], v[104:107], v[152:155]
    v_mfma_f32_16x16x32_bf16 v[156:159], a[200:203], v[104:107], v[156:159]
    s_waitcnt vmcnt(4)
    v_mfma_f32_16x16x32_bf16 v[144:147], a[36:39], v[108:111], v[144:147]
    v_mfma_f32_16x16x32_bf16 v[148:151], a[92:95], v[108:111], v[148:151]
    v_mfma_f32_16x16x32_bf16 v[152:155], a[148:151], v[108:111], v[152:155]
    v_mfma_f32_16x16x32_bf16 v[156:159], a[204:207], v[108:111], v[156:159]
    s_waitcnt vmcnt(3)
    v_mfma_f32_16x16x32_bf16 v[144:147], a[40:43], v[112:115], v[144:147]
    v_mfma_f32_16x16x32_bf16 v[148:151], a[96:99], v[112:115], v[148:151]
    v_mfma_f32_16x16x32_bf16 v[152:155], a[152:155], v[112:115], v[152:155]
    v_mfma_f32_16x16x32_bf16 v[156:159], a[208:211], v[112:115], v[156:159]
    s_waitcnt vmcnt(2)
    v_mfma_f32_16x16x32_bf16 v[144:147], a[44:47], v[116:119], v[144:147]
    v_mfma_f32_16x16x32_bf16 v[148:151], a[100:103], v[116:119], v[148:151]
    v_mfma_f32_16x16x32_bf16 v[152:155], a[156:159], v[116:119], v[152:155]
    v_mfma_f32_16x16x32_bf16 v[156:159], a[212:215], v[116:119], v[156:159]
    s_waitcnt vmcnt(1)
    v_mfma_f32_16x16x32_bf16 v[144:147], a[48:51], v[120:123], v[144:147]
    v_mfma_f32_16x16x32_bf16 v[148:151], a[104:107], v[120:123], v[148:151]
    v_mfma_f32_16x16x32_bf16 v[152:155], a[160:163], v[120:123], v[152:155]
    v_mfma_f32_16x16x32_bf16 v[156:159], a[216:219], v[120:123], v[156:159]
    s_waitcnt vmcnt(0)
    v_mfma_f32_16x16x32_bf16 v[144:147], a[52:55], v[124:127], v[144:147]
    v_mfma_f32_16x16x32_bf16 v[148:151], a[108:111], v[124:127], v[148:151]
    v_mfma_f32_16x16x32_bf16 v[152:155], a[164:167], v[124:127], v[152:155]
    v_mfma_f32_16x16x32_bf16 v[156:159], a[220:223], v[124:127], v[156:159]
    s_nop 7
    v_cvt_pk_bf16_f32 v128, v128, v128
    v_lshlrev_b32 v128, 16, v128
    v_cvt_pk_bf16_f32 v136, v136, v136
    v_lshlrev_b32 v136, 16, v136
    v_mul_f32 v128, v128, v136
    v_cvt_pk_bf16_f32 v129, v129, v129
    v_lshlrev_b32 v129, 16, v129
    v_cvt_pk_bf16_f32 v137, v137, v137
    v_lshlrev_b32 v137, 16, v137
    v_mul_f32 v129, v129, v137
    v_cvt_pk_bf16_f32 v130, v130, v130
    v_lshlrev_b32 v130, 16, v130
    v_cvt_pk_bf16_f32 v138, v138, v138
    v_lshlrev_b32 v138, 16, v138
    v_mul_f32 v130, v130, v138
    v_cvt_pk_bf16_f32 v131, v131, v131
    v_lshlrev_b32 v131, 16, v131
    v_cvt_pk_bf16_f32 v139, v139, v139
    v_lshlrev_b32 v139, 16, v139
    v_mul_f32 v131, v131, v139
    v_cvt_pk_bf16_f32 v132, v132, v132
    v_lshlrev_b32 v132, 16, v132
    v_cvt_pk_bf16_f32 v140, v140, v140
    v_lshlrev_b32 v140, 16, v140
    v_mul_f32 v132, v132, v140
    v_cvt_pk_bf16_f32 v133, v133, v133
    v_lshlrev_b32 v133, 16, v133
    v_cvt_pk_bf16_f32 v141, v141, v141
    v_lshlrev_b32 v141, 16, v141
    v_mul_f32 v133, v133, v141
    v_cvt_pk_bf16_f32 v134, v134, v134
    v_lshlrev_b32 v134, 16, v134
    v_cvt_pk_bf16_f32 v142, v142, v142
    v_lshlrev_b32 v142, 16, v142
    v_mul_f32 v134, v134, v142
    v_cvt_pk_bf16_f32 v135, v135, v135
    v_lshlrev_b32 v135, 16, v135
    v_cvt_pk_bf16_f32 v143, v143, v143
    v_lshlrev_b32 v143, 16, v143
    v_mul_f32 v135, v135, v143
    v_cvt_pk_bf16_f32 v160, v128, v129
    v_cvt_pk_bf16_f32 v161, v130, v131
    v_cvt_pk_bf16_f32 v162, v132, v133
    v_cvt_pk_bf16_f32 v163, v134, v135
    global_store_dwordx4 v4, v[160:163], s[28:29] sc1
    s_add_u32 s28, s28, 57344
    s_addc_u32 s29, s29, 0
    v_cvt_pk_bf16_f32 v144, v144, v144
    v_lshlrev_b32 v144, 16, v144
    v_cvt_pk_bf16_f32 v152, v152, v152
    v_lshlrev_b32 v152, 16, v152
    v_mul_f32 v144, v144, v152
    v_cvt_pk_bf16_f32 v145, v145, v145
    v_lshlrev_b32 v145, 16, v145
    v_cvt_pk_bf16_f32 v153, v153, v153
    v_lshlrev_b32 v153, 16, v153
    v_mul_f32 v145, v145, v153
    v_cvt_pk_bf16_f32 v146, v146, v146
    v_lshlrev_b32 v146, 16, v146
    v_cvt_pk_bf16_f32 v154, v154, v154
    v_lshlrev_b32 v154, 16, v154
    v_mul_f32 v146, v146, v154
    v_cvt_pk_bf16_f32 v147, v147, v147
    v_lshlrev_b32 v147, 16, v147
    v_cvt_pk_bf16_f32 v155, v155, v155
    v_lshlrev_b32 v155, 16, v155
    v_mul_f32 v147, v147, v155
    v_cvt_pk_bf16_f32 v148, v148, v148
    v_lshlrev_b32 v148, 16, v148
    v_cvt_pk_bf16_f32 v156, v156, v156
    v_lshlrev_b32 v156, 16, v156
    v_mul_f32 v148, v148, v156
    v_cvt_pk_bf16_f32 v149, v149, v149
    v_lshlrev_b32 v149, 16, v149
    v_cvt_pk_bf16_f32 v157, v157, v157
    v_lshlrev_b32 v157, 16, v157
    v_mul_f32 v149, v149, v157
    v_cvt_pk_bf16_f32 v150, v150, v150
    v_lshlrev_b32 v150, 16, v150
    v_cvt_pk_bf16_f32 v158, v158, v158
    v_lshlrev_b32 v158, 16, v158
    v_mul_f32 v150, v150, v158
    v_cvt_pk_bf16_f32 v151, v151, v151
    v_lshlrev_b32 v151, 16, v151
    v_cvt_pk_bf16_f32 v159, v159, v159
    v_lshlrev_b32 v159, 16, v159
    v_mul_f32 v151, v151, v159
    v_cvt_pk_bf16_f32 v164, v144, v145
    v_cvt_pk_bf16_f32 v165, v146, v147
    v_cvt_pk_bf16_f32 v166, v148, v149
    v_cvt_pk_bf16_f32 v167, v150, v151
    global_store_dwordx4 v4, v[164:167], s[28:29] sc1
    s_add_u32 s28, s28, 57344
    s_addc_u32 s29, s29, 0
    s_branch .chain_kernel_fin79
.chain_kernel_ty77:
    s_load_dwordx2 s[4:5], s[0:1], 88
    v_lshrrev_b32 v2, 6, v0
    v_and_b32 v1, 63, v0
    s_nop 0
    v_readfirstlane_b32 s18, v2
    v_lshrrev_b32 v2, 4, v1
    v_and_b32 v3, 15, v1
    s_lshr_b32 s20, s2, 6
    s_and_b32 s21, s2, 63
    v_lshlrev_b32 v4, 4, v1
    s_waitcnt lgkmcnt(0)
    s_mul_i32 s39, s18, 14
    s_mul_i32 s38, s20, 7
    s_mul_i32 s38, s38, 56
    s_add_u32 s38, s38, s39
    s_lshl_b32 s38, s38, 10
    s_add_u32 s38, s38, 0x12d1000
    s_add_u32 s24, s16, s38
    s_addc_u32 s25, s17, 0
    global_load_dwordx4 a[0:3], v4, s[24:25] offset:0
    global_load_dwordx4 a[4:7], v4, s[24:25] offset:1024
    global_load_dwordx4 a[8:11], v4, s[24:25] offset:2048
    global_load_dwordx4 a[12:15], v4, s[24:25] offset:3072
    s_add_u32 s24, s24, 4096
    s_addc_u32 s25, s25, 0
    global_load_dwordx4 a[16:19], v4, s[24:25] offset:0
    global_load_dwordx4 a[20:23], v4, s[24:25] offset:1024
    global_load_dwordx4 a[24:27], v4, s[24:25] offset:2048
    global_load_dwordx4 a[28:31], v4, s[24:25] offset:3072
    s_add_u32 s24, s24, 4096
    s_addc_u32 s25, s25, 0
    global_load_dwordx4 a[32:35], v4, s[24:25] offset:0
    global_load_dwordx4 a[36:39], v4, s[24:25] offset:1024
    global_load_dwordx4 a[40:43], v4, s[24:25] offset:2048
    global_load_dwordx4 a[44:47], v4, s[24:25] offset:3072
    s_add_u32 s24, s24, 4096
    s_addc_u32 s25, s25, 0
    global_load_dwordx4 a[48:51], v4, s[24:25] offset:0
    global_load_dwordx4 a[52:55], v4, s[24:25] offset:1024
    s_add_u32 s24, s24, 45056
    s_addc_u32 s25, s25, 0
    global_load_dwordx4 a[56:59], v4, s[24:25] offset:0
    global_load_dwordx4 a[60:63], v4, s[24:25] offset:1024
    global_load_dwordx4 a[64:67], v4, s[24:25] offset:2048
    global_load_dwordx4 a[68:71], v4, s[24:25] offset:3072
    s_add_u32 s24, s24, 4096
    s_addc_u32 s25, s25, 0
    global_load_dwordx4 a[72:75], v4, s[24:25] offset:0
    global_load_dwordx4 a[76:79], v4, s[24:25] offset:1024
    global_load_dwordx4 a[80:83], v4, s[24:25] offset:2048
    global_load_dwordx4 a[84:87], v4, s[24:25] offset:3072
    s_add_u32 s24, s24, 4096
    s_addc_u32 s25, s25, 0
    global_load_dwordx4 a[88:91], v4, s[24:25] offset:0
    global_load_dwordx4 a[92:95], v4, s[24:25] offset:1024
    global_load_dwordx4 a[96:99], v4, s[24:25] offset:2048
    global_load_dwordx4 a[100:103], v4, s[24:25] offset:3072
    s_add_u32 s24, s24, 4096
    s_addc_u32 s25, s25, 0
    global_load_dwordx4 a[104:107], v4, s[24:25] offset:0
    global_load_dwordx4 a[108:111], v4, s[24:25] offset:1024
    s_add_u32 s24, s24, 45056
    s_addc_u32 s25, s25, 0
    global_load_dwordx4 a[112:115], v4, s[24:25] offset:0
    global_load_dwordx4 a[116:119], v4, s[24:25] offset:1024
    global_load_dwordx4 a[120:123], v4, s[24:25] offset:2048
    global_load_dwordx4 a[124:127], v4, s[24:25] offset:3072
    s_add_u32 s24, s24, 4096
    s_addc_u32 s25, s25, 0
    global_load_dwordx4 a[128:131], v4, s[24:25] offset:0
    global_load_dwordx4 a[132:135], v4, s[24:25] offset:1024
    global_load_dwordx4 a[136:139], v4, s[24:25] offset:2048
    global_load_dwordx4 a[140:143], v4, s[24:25] offset:3072
    s_add_u32 s24, s24, 4096
    s_addc_u32 s25, s25, 0
    global_load_dwordx4 a[144:147], v4, s[24:25] offset:0
    global_load_dwordx4 a[148:151], v4, s[24:25] offset:1024
    global_load_dwordx4 a[152:155], v4, s[24:25] offset:2048
    global_load_dwordx4 a[156:159], v4, s[24:25] offset:3072
    s_add_u32 s24, s24, 4096
    s_addc_u32 s25, s25, 0
    global_load_dwordx4 a[160:163], v4, s[24:25] offset:0
    global_load_dwordx4 a[164:167], v4, s[24:25] offset:1024
    s_add_u32 s24, s24, 45056
    s_addc_u32 s25, s25, 0
    global_load_dwordx4 a[168:171], v4, s[24:25] offset:0
    global_load_dwordx4 a[172:175], v4, s[24:25] offset:1024
    global_load_dwordx4 a[176:179], v4, s[24:25] offset:2048
    global_load_dwordx4 a[180:183], v4, s[24:25] offset:3072
    s_add_u32 s24, s24, 4096
    s_addc_u32 s25, s25, 0
    global_load_dwordx4 a[184:187], v4, s[24:25] offset:0
    global_load_dwordx4 a[188:191], v4, s[24:25] offset:1024
    global_load_dwordx4 a[192:195], v4, s[24:25] offset:2048
    global_load_dwordx4 a[196:199], v4, s[24:25] offset:3072
    s_add_u32 s24, s24, 4096
    s_addc_u32 s25, s25, 0
    global_load_dwordx4 a[200:203], v4, s[24:25] offset:0
    global_load_dwordx4 a[204:207], v4, s[24:25] offset:1024
    global_load_dwordx4 a[208:211], v4, s[24:25] offset:2048
    global_load_dwordx4 a[212:215], v4, s[24:25] offset:3072
    s_add_u32 s24, s24, 4096
    s_addc_u32 s25, s25, 0
    global_load_dwordx4 a[216:219], v4, s[24:25] offset:0
    global_load_dwordx4 a[220:223], v4, s[24:25] offset:1024
    s_add_u32 s24, s24, 45056
    s_addc_u32 s25, s25, 0
    global_load_dwordx4 a[224:227], v4, s[24:25] offset:0
    global_load_dwordx4 a[228:231], v4, s[24:25] offset:1024
    global_load_dwordx4 a[232:235], v4, s[24:25] offset:2048
    global_load_dwordx4 a[236:239], v4, s[24:25] offset:3072
    s_add_u32 s24, s24, 4096
    s_addc_u32 s25, s25, 0
    global_load_dwordx4 a[240:243], v4, s[24:25] offset:0
    global_load_dwordx4 a[244:247], v4, s[24:25] offset:1024
    global_load_dwordx4 a[248:251], v4, s[24:25] offset:2048
    global_load_dwordx4 a[252:255], v4, s[24:25] offset:3072
    s_add_u32 s24, s24, 4096
    s_addc_u32 s25, s25, 0
    global_load_dwordx4 v[124:127], v4, s[24:25] offset:0
    global_load_dwordx4 v[128:131], v4, s[24:25] offset:1024
    global_load_dwordx4 v[132:135], v4, s[24:25] offset:2048
    global_load_dwordx4 v[136:139], v4, s[24:25] offset:3072
    s_add_u32 s24, s24, 4096
    s_addc_u32 s25, s25, 0
    global_load_dwordx4 v[140:143], v4, s[24:25] offset:0
    global_load_dwordx4 v[144:147], v4, s[24:25] offset:1024
    s_add_u32 s24, s24, 45056
    s_addc_u32 s25, s25, 0
    global_load_dwordx4 v[148:151], v4, s[24:25] offset:0
    global_load_dwordx4 v[152:155], v4, s[24:25] offset:1024
    global_load_dwordx4 v[156:159], v4, s[24:25] offset:2048
    global_load_dwordx4 v[160:163], v4, s[24:25] offset:3072
    s_add_u32 s24, s24, 4096
    s_addc_u32 s25, s25, 0
    global_load_dwordx4 v[164:167], v4, s[24:25] offset:0
    global_load_dwordx4 v[168:171], v4, s[24:25] offset:1024
    s_cmp_lg_u32 s18, 0
    s_cbranch_scc1 .chain_kernel_dpx101
    s_and_b32 s88, s85, 63
    s_lshl_b32 s88, s88, 2
    s_add_u32 s88, s88, 832
    s_mov_b64 exec, 1
    s_add_u32 s46, s16, 0x0
    s_addc_u32 s47, s17, 0
    v_mov_b32 v8, v10
    v_mov_b32 v9, v11
    v_mov_b32 v10, s88
    s_mov_b32 s45, 0
.chain_kernel_wc102:
    global_load_dword v11, v10, s[46:47] sc1
    s_waitcnt vmcnt(0)
    v_readfirstlane_b32 s38, v11
    s_nop 3
    s_cmp_ge_u32 s38, 14
    s_cbranch_scc1 .chain_kernel_wcd103
    s_sleep 14
    s_add_u32 s45, s45, 1
    s_cmp_lt_u32 s45, 1048576
    s_cbranch_scc1 .chain_kernel_wc102
    s_branch .chain_kernel_end1
.chain_kernel_wcd103:
    v_mov_b32 v10, v8
    v_mov_b32 v11, v9
    s_mov_b64 exec, -1
.chain_kernel_dpx101:
    s_barrier
    s_lshl_b32 s38, s21, 1
    s_mul_i32 s38, s38, 56
    s_add_u32 s38, s38, s39
    s_lshl_b32 s38, s38, 10
    s_add_u32 s38, s38, 0x5e1d000
    v_add_u32 v5, 57344, v4
    s_add_u32 s26, s16, s38
    s_addc_u32 s27, s17, 0
    global_load_dwordx4 v[12:15], v4, s[26:27] offset:0
    global_load_dwordx4 v[16:19], v5, s[26:27] offset:0
    global_load_dwordx4 v[20:23], v4, s[26:27] offset:1024
    global_load_dwordx4 v[24:27], v5, s[26:27] offset:1024
    global_load_dwordx4 v[28:31], v4, s[26:27] offset:2048
    global_load_dwordx4 v[32:35], v5, s[26:27] offset:2048
    global_load_dwordx4 v[36:39], v4, s[26:27] offset:3072
    global_load_dwordx4 v[40:43], v5, s[26:27] offset:3072
    s_add_u32 s26, s26, 4096
    s_addc_u32 s27, s27, 0
    global_load_dwordx4 v[44:47], v4, s[26:27] offset:0
    global_load_dwordx4 v[48:51], v5, s[26:27] offset:0
    global_load_dwordx4 v[52:55], v4, s[26:27] offset:1024
    global_load_dwordx4 v[56:59], v5, s[26:27] offset:1024
    global_load_dwordx4 v[60:63], v4, s[26:27] offset:2048
    global_load_dwordx4 v[64:67], v5, s[26:27] offset:2048
    global_load_dwordx4 v[68:71], v4, s[26:27] offset:3072
    global_load_dwordx4 v[72:75], v5, s[26:27] offset:3072
    s_add_u32 s26, s26, 4096
    s_addc_u32 s27, s27, 0
    global_load_dwordx4 v[76:79], v4, s[26:27] offset:0
    global_load_dwordx4 v[80:83], v5, s[26:27] offset:0
    global_load_dwordx4 v[84:87], v4, s[26:27] offset:1024
    global_load_dwordx4 v[88:91], v5, s[26:27] offset:1024
    global_load_dwordx4 v[92:95], v4, s[26:27] offset:2048
    global_load_dwordx4 v[96:99], v5, s[26:27] offset:2048
    global_load_dwordx4 v[100:103], v4, s[26:27] offset:3072
    global_load_dwordx4 v[104:107], v5, s[26:27] offset:3072
    s_add_u32 s26, s26, 4096
    s_addc_u32 s27, s27, 0
    global_load_dwordx4 v[108:111], v4, s[26:27] offset:0
    global_load_dwordx4 v[112:115], v5, s[26:27] offset:0
    global_load_dwordx4 v[116:119], v4, s[26:27] offset:1024
    global_load_dwordx4 v[120:123], v5, s[26:27] offset:1024
    s_waitcnt vmcnt(26)
    v_mfma_f32_16x16x32_bf16 v[188:191], a[0:3], v[12:15], 0
    v_mfma_f32_16x16x32_bf16 v[192:195], a[0:3], v[16:19], 0
    s_waitcnt vmcnt(24)
    v_mfma_f32_16x16x32_bf16 v[188:191], a[4:7], v[20:23], v[188:191]
    v_mfma_f32_16x16x32_bf16 v[192:195], a[4:7], v[24:27], v[192:195]
    s_waitcnt vmcnt(22)
    v_mfma_f32_16x16x32_bf16 v[188:191], a[8:11], v[28:31], v[188:191]
    v_mfma_f32_16x16x32_bf16 v[192:195], a[8:11], v[32:35], v[192:195]
    s_waitcnt vmcnt(20)
    v_mfma_f32_16x16x32_bf16 v[188:191], a[12:15], v[36:39], v[188:191]
    v_mfma_f32_16x16x32_bf16 v[192:195], a[12:15], v[40:43], v[192:195]
    s_waitcnt vmcnt(18)
    v_mfma_f32_16x16x32_bf16 v[188:191], a[16:19], v[44:47], v[188:191]
    v_mfma_f32_16x16x32_bf16 v[192:195], a[16:19], v[48:51], v[192:195]
    s_waitcnt vmcnt(16)
    v_mfma_f32_16x16x32_bf16 v[188:191], a[20:23], v[52:55], v[188:191]
    v_mfma_f32_16x16x32_bf16 v[192:195], a[20:23], v[56:59], v[192:195]
    s_waitcnt vmcnt(14)
    v_mfma_f32_16x16x32_bf16 v[188:191], a[24:27], v[60:63], v[188:191]
    v_mfma_f32_16x16x32_bf16 v[192:195], a[24:27], v[64:67], v[192:195]
    s_waitcnt vmcnt(12)
    v_mfma_f32_16x16x32_bf16 v[188:191], a[28:31], v[68:71], v[188:191]
    v_mfma_f32_16x16x32_bf16 v[192:195], a[28:31], v[72:75], v[192:195]
    s_waitcnt vmcnt(10)
    v_mfma_f32_16x16x32_bf16 v[188:191], a[32:35], v[76:79], v[188:191]
    v_mfma_f32_16x16x32_bf16 v[192:195], a[32:35], v[80:83], v[192:195]
    s_waitcnt vmcnt(8)
    v_mfma_f32_16x16x32_bf16 v[188:191], a[36:39], v[84:87], v[188:191]
    v_mfma_f32_16x16x32_bf16 v[192:195], a[36:39], v[88:91], v[192:195]
    s_waitcnt vmcnt(6)
    v_mfma_f32_16x16x32_bf16 v[188:191], a[40:43], v[92:95], v[188:191]
    v_mfma_f32_16x16x32_bf16 v[192:195], a[40:43], v[96:99], v[192:195]
    s_waitcnt vmcnt(4)
    v_mfma_f32_16x16x32_bf16 v[188:191], a[44:47], v[100:103], v[188:191]
    v_mfma_f32_16x16x32_bf16 v[192:195], a[44:47], v[104:107], v[192:195]
    s_waitcnt vmcnt(2)
    v_mfma_f32_16x16x32_bf16 v[188:191], a[48:51], v[108:111], v[188:191]
    v_mfma_f32_16x16x32_bf16 v[192:195], a[48:51], v[112:115], v[192:195]
    s_waitcnt vmcnt(0)
    v_mfma_f32_16x16x32_bf16 v[188:191], a[52:55], v[116:119], v[188:191]
    v_mfma_f32_16x16x32_bf16 v[192:195], a[52:55], v[120:123], v[192:195]
    s_waitcnt vmcnt(63)
    v_mfma_f32_16x16x32_bf16 v[196:199], a[56:59], v[12:15], 0
    v_mfma_f32_16x16x32_bf16 v[200:203], a[56:59], v[16:19], 0
    s_waitcnt vmcnt(63)
    v_mfma_f32_16x16x32_bf16 v[196:199], a[60:63], v[20:23], v[196:199]
    v_mfma_f32_16x16x32_bf16 v[200:203], a[60:63], v[24:27], v[200:203]
    s_waitcnt vmcnt(63)
    v_mfma_f32_16x16x32_bf16 v[196:199], a[64:67], v[28:31], v[196:199]
    v_mfma_f32_16x16x32_bf16 v[200:203], a[64:67], v[32:35], v[200:203]
    s_waitcnt vmcnt(63)
    v_mfma_f32_16x16x32_bf16 v[196:199], a[68:71], v[36:39], v[196:199]
    v_mfma_f32_16x16x32_bf16 v[200:203], a[68:71], v[40:43], v[200:203]
    s_waitcnt vmcnt(63)
    v_mfma_f32_16x16x32_bf16 v[196:199], a[72:75], v[44:47], v[196:199]
    v_mfma_f32_16x16x32_bf16 v[200:203], a[72:75], v[48:51], v[200:203]
    s_waitcnt vmcnt(63)
    v_mfma_f32_16x16x32_bf16 v[196:199], a[76:79], v[52:55], v[196:199]
    v_mfma_f32_16x16x32_bf16 v[200:203], a[76:79], v[56:59], v[200:203]
    s_waitcnt vmcnt(63)
    v_mfma_f32_16x16x32_bf16 v[196:199], a[80:83], v[60:63], v[196:199]
    v_mfma_f32_16x16x32_bf16 v[200:203], a[80:83], v[64:67], v[200:203]
    s_waitcnt vmcnt(63)
    v_mfma_f32_16x16x32_bf16 v[196:199], a[84:87], v[68:71], v[196:199]
    v_mfma_f32_16x16x32_bf16 v[200:203], a[84:87], v[72:75], v[200:203]
    s_waitcnt vmcnt(63)
    v_mfma_f32_16x16x32_bf16 v[196:199], a[88:91], v[76:79], v[196:199]
    v_mfma_f32_16x16x32_bf16 v[200:203], a[88:91], v[80:83], v[200:203]
    s_waitcnt vmcnt(63)
    v_mfma_f32_16x16x32_bf16 v[196:199], a[92:95], v[84:87], v[196:199]
    v_mfma_f32_16x16x32_bf16 v[200:203], a[92:95], v[88:91], v[200:203]
    s_waitcnt vmcnt(63)
    v_mfma_f32_16x16x32_bf16 v[196:199], a[96:99], v[92:95], v[196:199]
    v_mfma_f32_16x16x32_bf16 v[200:203], a[96:99], v[96:99], v[200:203]
    s_waitcnt vmcnt(63)
    v_mfma_f32_16x16x32_bf16 v[196:199], a[100:103], v[100:103], v[196:199]
    v_mfma_f32_16x16x32_bf16 v[200:203], a[100:103], v[104:107], v[200:203]
    s_waitcnt vmcnt(63)
    v_mfma_f32_16x16x32_bf16 v[196:199], a[104:107], v[108:111], v[196:199]
    v_mfma_f32_16x16x32_bf16 v[200:203], a[104:107], v[112:115], v[200:203]
    s_waitcnt vmcnt(63)
    v_mfma_f32_16x16x32_bf16 v[196:199], a[108:111], v[116:119], v[196:199]
    v_mfma_f32_16x16x32_bf16 v[200:203], a[108:111], v[120:123], v[200:203]
    s_waitcnt vmcnt(63)
    v_mfma_f32_16x16x32_bf16 v[204:207], a[112:115], v[12:15], 0
    v_mfma_f32_16x16x32_bf16 v[208:211], a[112:115], v[16:19], 0
    s_waitcnt vmcnt(63)
    v_mfma_f32_16x16x32_bf16 v[204:207], a[116:119], v[20:23], v[204:207]
    v_mfma_f32_16x16x32_bf16 v[208:211], a[116:119], v[24:27], v[208:211]
    s_waitcnt vmcnt(63)
    v_mfma_f32_16x16x32_bf16 v[204:207], a[120:123], v[28:31], v[204:207]
    v_mfma_f32_16x16x32_bf16 v[208:211], a[120:123], v[32:35], v[208:211]
    s_waitcnt vmcnt(63)
    v_mfma_f32_16x16x32_bf16 v[204:207], a[124:127], v[36:39], v[204:207]
    v_mfma_f32_16x16x32_bf16 v[208:211], a[124:127], v[40:43], v[208:211]
    s_waitcnt vmcnt(63)
    v_mfma_f32_16x16x32_bf16 v[204:207], a[128:131], v[44:47], v[204:207]
    v_mfma_f32_16x16x32_bf16 v[208:211], a[128:131], v[48:51], v[208:211]
    s_waitcnt vmcnt(63)
    v_mfma_f32_16x16x32_bf16 v[204:207], a[132:135], v[52:55], v[204:207]
    v_mfma_f32_16x16x32_bf16 v[208:211], a[132:135], v[56:59], v[208:211]
    s_waitcnt vmcnt(63)
    v_mfma_f32_16x16x32_bf16 v[204:207], a[136:139], v[60:63], v[204:207]
    v_mfma_f32_16x16x32_bf16 v[208:211], a[136:139], v[64:67], v[208:211]
    s_waitcnt vmcnt(63)
    v_mfma_f32_16x16x32_bf16 v[204:207], a[140:143], v[68:71], v[204:207]
    v_mfma_f32_16x16x32_bf16 v[208:211], a[140:143], v[72:75], v[208:211]
    s_waitcnt vmcnt(63)
    v_mfma_f32_16x16x32_bf16 v[204:207], a[144:147], v[76:79], v[204:207]
    v_mfma_f32_16x16x32_bf16 v[208:211], a[144:147], v[80:83], v[208:211]
    s_waitcnt vmcnt(63)
    v_mfma_f32_16x16x32_bf16 v[204:207], a[148:151], v[84:87], v[204:207]
    v_mfma_f32_16x16x32_bf16 v[208:211], a[148:151], v[88:91], v[208:211]
    s_waitcnt vmcnt(63)
    v_mfma_f32_16x16x32_bf16 v[204:207], a[152:155], v[92:95], v[204:207]
    v_mfma_f32_16x16x32_bf16 v[208:211], a[152:155], v[96:99], v[208:211]
    s_waitcnt vmcnt(63)
    v_mfma_f32_16x16x32_bf16 v[204:207], a[156:159], v[100:103], v[204:207]
    v_mfma_f32_16x16x32_bf16 v[208:211], a[156:159], v[104:107], v[208:211]
    s_waitcnt vmcnt(63)
    v_mfma_f32_16x16x32_bf16 v[204:207], a[160:163], v[108:111], v[204:207]
    v_mfma_f32_16x16x32_bf16 v[208:211], a[160:163], v[112:115], v[208:211]
    s_waitcnt vmcnt(62)
    v_mfma_f32_16x16x32_bf16 v[204:207], a[164:167], v[116:119], v[204:207]
    v_mfma_f32_16x16x32_bf16 v[208:211], a[164:167], v[120:123], v[208:211]
    s_waitcnt vmcnt(61)
    v_mfma_f32_16x16x32_bf16 v[212:215], a[168:171], v[12:15], 0
    v_mfma_f32_16x16x32_bf16 v[216:219], a[168:171], v[16:19], 0
    s_waitcnt vmcnt(60)
    v_mfma_f32_16x16x32_bf16 v[212:215], a[172:175], v[20:23], v[212:215]
    v_mfma_f32_16x16x32_bf16 v[216:219], a[172:175], v[24:27], v[216:219]
    s_waitcnt vmcnt(59)
    v_mfma_f32_16x16x32_bf16 v[212:215], a[176:179], v[28:31], v[212:215]
    v_mfma_f32_16x16x32_bf16 v[216:219], a[176:179], v[32:35], v[216:219]
    s_waitcnt vmcnt(58)
    v_mfma_f32_16x16x32_bf16 v[212:215], a[180:183], v[36:39], v[212:215]
    v_mfma_f32_16x16x32_bf16 v[216:219], a[180:183], v[40:43], v[216:219]
    s_waitcnt vmcnt(57)
    v_mfma_f32_16x16x32_bf16 v[212:215], a[184:187], v[44:47], v[212:215]
    v_mfma_f32_16x16x32_bf16 v[216:219], a[184:187], v[48:51], v[216:219]
    s_waitcnt vmcnt(56)
    v_mfma_f32_16x16x32_bf16 v[212:215], a[188:191], v[52:55], v[212:215]
    v_mfma_f32_16x16x32_bf16 v[216:219], a[188:191], v[56:59], v[216:219]
    s_waitcnt vmcnt(55)
    v_mfma_f32_16x16x32_bf16 v[212:215], a[192:195], v[60:63], v[212:215]
    v_mfma_f32_16x16x32_bf16 v[216:219], a[192:195], v[64:67], v[216:219]
    s_waitcnt vmcnt(54)
    v_mfma_f32_16x16x32_bf16 v[212:215], a[196:199], v[68:71], v[212:215]
    v_mfma_f32_16x16x32_bf16 v[216:219], a[196:199], v[72:75], v[216:219]
    s_waitcnt vmcnt(53)
    v_mfma_f32_16x16x32_bf16 v[212:215], a[200:203], v[76:79], v[212:215]
    v_mfma_f32_16x16x32_bf16 v[216:219], a[200:203], v[80:83], v[216:219]
    s_waitcnt vmcnt(52)
    v_mfma_f32_16x16x32_bf16 v[212:215], a[204:207], v[84:87], v[212:215]
    v_mfma_f32_16x16x32_bf16 v[216:219], a[204:207], v[88:91], v[216:219]
    s_waitcnt vmcnt(51)
    v_mfma_f32_16x16x32_bf16 v[212:215], a[208:211], v[92:95], v[212:215]
    v_mfma_f32_16x16x32_bf16 v[216:219], a[208:211], v[96:99], v[216:219]
    s_waitcnt vmcnt(50)
    v_mfma_f32_16x16x32_bf16 v[212:215], a[212:215], v[100:103], v[212:215]
    v_mfma_f32_16x16x32_bf16 v[216:219], a[212:215], v[104:107], v[216:219]
    s_waitcnt vmcnt(49)
    v_mfma_f32_16x16x32_bf16 v[212:215], a[216:219], v[108:111], v[212:215]
    v_mfma_f32_16x16x32_bf16 v[216:219], a[216:219], v[112:115], v[216:219]
    s_waitcnt vmcnt(48)
    v_mfma_f32_16x16x32_bf16 v[212:215], a[220:223], v[116:119], v[212:215]
    v_mfma_f32_16x16x32_bf16 v[216:219], a[220:223], v[120:123], v[216:219]
    s_waitcnt vmcnt(47)
    v_mfma_f32_16x16x32_bf16 v[220:223], a[224:227], v[12:15], 0
    v_mfma_f32_16x16x32_bf16 v[224:227], a[224:227], v[16:19], 0
    s_waitcnt vmcnt(46)
    v_mfma_f32_16x16x32_bf16 v[220:223], a[228:231], v[20:23], v[220:223]
    v_mfma_f32_16x16x32_bf16 v[224:227], a[228:231], v[24:27], v[224:227]
    s_waitcnt vmcnt(45)
    v_mfma_f32_16x16x32_bf16 v[220:223], a[232:235], v[28:31], v[220:223]
    v_mfma_f32_16x16x32_bf16 v[224:227], a[232:235], v[32:35], v[224:227]
    s_waitcnt vmcnt(44)
    v_mfma_f32_16x16x32_bf16 v[220:223], a[236:239], v[36:39], v[220:223]
    v_mfma_f32_16x16x32_bf16 v[224:227], a[236:239], v[40:43], v[224:227]
    s_waitcnt vmcnt(43)
    v_mfma_f32_16x16x32_bf16 v[220:223], a[240:243], v[44:47], v[220:223]
    v_mfma_f32_16x16x32_bf16 v[224:227], a[240:243], v[48:51], v[224:227]
    s_waitcnt vmcnt(42)
    v_mfma_f32_16x16x32_bf16 v[220:223], a[244:247], v[52:55], v[220:223]
    v_mfma_f32_16x16x32_bf16 v[224:227], a[244:247], v[56:59], v[224:227]
    s_waitcnt vmcnt(41)
    v_mfma_f32_16x16x32_bf16 v[220:223], a[248:251], v[60:63], v[220:223]
    v_mfma_f32_16x16x32_bf16 v[224:227], a[248:251], v[64:67], v[224:227]
    s_waitcnt vmcnt(40)
    v_mfma_f32_16x16x32_bf16 v[220:223], a[252:255], v[68:71], v[220:223]
    v_mfma_f32_16x16x32_bf16 v[224:227], a[252:255], v[72:75], v[224:227]
    global_load_dwordx4 v[172:175], v4, s[24:25] offset:2048
    global_load_dwordx4 v[176:179], v4, s[24:25] offset:3072
    s_waitcnt vmcnt(41)
    v_mfma_f32_16x16x32_bf16 v[220:223], v[124:127], v[76:79], v[220:223]
    v_mfma_f32_16x16x32_bf16 v[224:227], v[124:127], v[80:83], v[224:227]
    s_add_u32 s24, s24, 4096
    s_addc_u32 s25, s25, 0
    global_load_dwordx4 v[180:183], v4, s[24:25] offset:0
    s_waitcnt vmcnt(41)
    v_mfma_f32_16x16x32_bf16 v[220:223], v[128:131], v[84:87], v[220:223]
    v_mfma_f32_16x16x32_bf16 v[224:227], v[128:131], v[88:91], v[224:227]
    global_load_dwordx4 v[184:187], v4, s[24:25] offset:1024
    s_waitcnt vmcnt(41)
    v_mfma_f32_16x16x32_bf16 v[220:223], v[132:135], v[92:95], v[220:223]
    v_mfma_f32_16x16x32_bf16 v[224:227], v[132:135], v[96:99], v[224:227]
    global_load_dwordx4 v[124:127], v4, s[24:25] offset:2048
    s_waitcnt vmcnt(41)
    v_mfma_f32_16x16x32_bf16 v[220:223], v[136:139], v[100:103], v[220:223]
    v_mfma_f32_16x16x32_bf16 v[224:227], v[136:139], v[104:107], v[224:227]
    global_load_dwordx4 v[128:131], v4, s[24:25] offset:3072
    s_waitcnt vmcnt(41)
    v_mfma_f32_16x16x32_bf16 v[220:223], v[140:143], v[108:111], v[220:223]
    v_mfma_f32_16x16x32_bf16 v[224:227], v[140:143], v[112:115], v[224:227]
    s_add_u32 s24, s24, 4096
    s_addc_u32 s25, s25, 0
    global_load_dwordx4 v[132:135], v4, s[24:25] offset:0
    s_waitcnt vmcnt(41)
    v_mfma_f32_16x16x32_bf16 v[220:223], v[144:147], v[116:119], v[220:223]
    v_mfma_f32_16x16x32_bf16 v[224:227], v[144:147], v[120:123], v[224:227]
    global_load_dwordx4 v[136:139], v4, s[24:25] offset:1024
    s_waitcnt vmcnt(41)
    v_mfma_f32_16x16x32_bf16 v[228:231], v[148:151], v[12:15], 0
    v_mfma_f32_16x16x32_bf16 v[232:235], v[148:151], v[16:19], 0
    s_add_u32 s24, s24, 45056
    s_addc_u32 s25, s25, 0
    global_load_dwordx4 v[140:143], v4, s[24:25] offset:0
    s_waitcnt vmcnt(41)
    v_mfma_f32_16x16x32_bf16 v[228:231], v[152:155], v[20:23], v[228:231]
    v_mfma_f32_16x16x32_bf16 v[232:235], v[152:155], v[24:27], v[232:235]
    global_load_dwordx4 v[144:147], v4, s[24:25] offset:1024
    s_waitcnt vmcnt(41)
    v_mfma_f32_16x16x32_bf16 v[228:231], v[156:159], v[28:31], v[228:231]
    v_mfma_f32_16x16x32_bf16 v[232:235], v[156:159], v[32:35], v[232:235]
    global_load_dwordx4 v[148:151], v4, s[24:25] offset:2048
    s_waitcnt vmcnt(41)
    v_mfma_f32_16x16x32_bf16 v[228:231], v[160:163], v[36:39], v[228:231]
    v_mfma_f32_16x16x32_bf16 v[232:235], v[160:163], v[40:43], v[232:235]
    global_load_dwordx4 v[152:155], v4, s[24:25] offset:3072
    s_waitcnt vmcnt(41)
    v_mfma_f32_16x16x32_bf16 v[228:231], v[164:167], v[44:47], v[228:231]
    v_mfma_f32_16x16x32_bf16 v[232:235], v[164:167], v[48:51], v[232:235]
    s_add_u32 s24, s24, 4096
    s_addc_u32 s25, s25, 0
    global_load_dwordx4 v[156:159], v4, s[24:25] offset:0
    s_waitcnt vmcnt(41)
    v_mfma_f32_16x16x32_bf16 v[228:231], v[168:171], v[52:55], v[228:231]
    v_mfma_f32_16x16x32_bf16 v[232:235], v[168:171], v[56:59], v[232:235]
    global_load_dwordx4 v[160:163], v4, s[24:25] offset:1024
    s_waitcnt vmcnt(13)
    v_mfma_f32_16x16x32_bf16 v[228:231], v[172:175], v[60:63], v[228:231]
    v_mfma_f32_16x16x32_bf16 v[232:235], v[172:175], v[64:67], v[232:235]
    global_load_dwordx4 v[164:167], v4, s[24:25] offset:2048
    s_waitcnt vmcnt(13)
    v_mfma_f32_16x16x32_bf16 v[228:231], v[176:179], v[68:71], v[228:231]
    v_mfma_f32_16x16x32_bf16 v[232:235], v[176:179], v[72:75], v[232:235]
    global_load_dwordx4 v[168:171], v4, s[24:25] offset:3072
    s_waitcnt vmcnt(13)
    v_mfma_f32_16x16x32_bf16 v[228:231], v[180:183], v[76:79], v[228:231]
    v_mfma_f32_16x16x32_bf16 v[232:235], v[180:183], v[80:83], v[232:235]
    s_add_u32 s24, s24, 4096
    s_addc_u32 s25, s25, 0
    global_load_dwordx4 v[172:175], v4, s[24:25] offset:0
    s_waitcnt vmcnt(13)
    v_mfma_f32_16x16x32_bf16 v[228:231], v[184:187], v[84:87], v[228:231]
    v_mfma_f32_16x16x32_bf16 v[232:235], v[184:187], v[88:91], v[232:235]
    global_load_dwordx4 v[176:179], v4, s[24:25] offset:1024
    s_waitcnt vmcnt(13)
    v_mfma_f32_16x16x32_bf16 v[228:231], v[124:127], v[92:95], v[228:231]
    v_mfma_f32_16x16x32_bf16 v[232:235], v[124:127], v[96:99], v[232:235]
    global_load_dwordx4 v[180:183], v4, s[24:25] offset:2048
    s_waitcnt vmcnt(13)
    v_mfma_f32_16x16x32_bf16 v[228:231], v[128:131], v[100:103], v[228:231]
    v_mfma_f32_16x16x32_bf16 v[232:235], v[128:131], v[104:107], v[232:235]
    global_load_dwordx4 v[184:187], v4, s[24:25] offset:3072
    s_waitcnt vmcnt(13)
    v_mfma_f32_16x16x32_bf16 v[228:231], v[132:135], v[108:111], v[228:231]
    v_mfma_f32_16x16x32_bf16 v[232:235], v[132:135], v[112:115], v[232:235]
    s_add_u32 s24, s24, 4096
    s_addc_u32 s25, s25, 0
    global_load_dwordx4 v[124:127], v4, s[24:25] offset:0
    s_waitcnt vmcnt(13)
    v_mfma_f32_16x16x32_bf16 v[228:231], v[136:139], v[116:119], v[228:231]
    v_mfma_f32_16x16x32_bf16 v[232:235], v[136:139], v[120:123], v[232:235]
    global_load_dwordx4 v[128:131], v4, s[24:25] offset:1024
    s_waitcnt vmcnt(13)
    v_mfma_f32_16x16x32_bf16 v[236:239], v[140:143], v[12:15], 0
    v_mfma_f32_16x16x32_bf16 v[240:243], v[140:143], v[16:19], 0
    s_waitcnt vmcnt(12)
    v_mfma_f32_16x16x32_bf16 v[236:239], v[144:147], v[20:23], v[236:239]
    v_mfma_f32_16x16x32_bf16 v[240:243], v[144:147], v[24:27], v[240:243]
    s_waitcnt vmcnt(11)
    v_mfma_f32_16x16x32_bf16 v[236:239], v[148:151], v[28:31], v[236:239]
    v_mfma_f32_16x16x32_bf16 v[240:243], v[148:151], v[32:35], v[240:243]
    s_waitcnt vmcnt(10)
    v_mfma_f32_16x16x32_bf16 v[236:239], v[152:155], v[36:39], v[236:239]
    v_mfma_f32_16x16x32_bf16 v[240:243], v[152:155], v[40:43], v[240:243]
    s_waitcnt vmcnt(9)
    v_mfma_f32_16x16x32_bf16 v[236:239], v[156:159], v[44:47], v[236:239]
    v_mfma_f32_16x16x32_bf16 v[240:243], v[156:159], v[48:51], v[240:243]
    s_waitcnt vmcnt(8)
    v_mfma_f32_16x16x32_bf16 v[236:239], v[160:163], v[52:55], v[236:239]
    v_mfma_f32_16x16x32_bf16 v[240:243], v[160:163], v[56:59], v[240:243]
    s_waitcnt vmcnt(7)
    v_mfma_f32_16x16x32_bf16 v[236:239], v[164:167], v[60:63], v[236:239]
    v_mfma_f32_16x16x32_bf16 v[240:243], v[164:167], v[64:67], v[240:243]
    s_waitcnt vmcnt(6)
    v_mfma_f32_16x16x32_bf16 v[236:239], v[168:171], v[68:71], v[236:239]
    v_mfma_f32_16x16x32_bf16 v[240:243], v[168:171], v[72:75], v[240:243]
    s_waitcnt vmcnt(5)
    v_mfma_f32_16x16x32_bf16 v[236:239], v[172:175], v[76:79], v[236:239]
    v_mfma_f32_16x16x32_bf16 v[240:243], v[172:175], v[80:83], v[240:243]
    s_waitcnt vmcnt(4)
    v_mfma_f32_16x16x32_bf16 v[236:239], v[176:179], v[84:87], v[236:239]
    v_mfma_f32_16x16x32_bf16 v[240:243], v[176:179], v[88:91], v[240:243]
    s_waitcnt vmcnt(3)
    v_mfma_f32_16x16x32_bf16 v[236:239], v[180:183], v[92:95], v[236:239]
    v_mfma_f32_16x16x32_bf16 v[240:243], v[180:183], v[96:99], v[240:243]
    s_waitcnt vmcnt(2)
    v_mfma_f32_16x16x32_bf16 v[236:239], v[184:187], v[100:103], v[236:239]
    v_mfma_f32_16x16x32_bf16 v[240:243], v[184:187], v[104:107], v[240:243]
    s_waitcnt vmcnt(1)
    v_mfma_f32_16x16x32_bf16 v[236:239], v[124:127], v[108:111], v[236:239]
    v_mfma_f32_16x16x32_bf16 v[240:243], v[124:127], v[112:115], v[240:243]
    s_waitcnt vmcnt(0)
    v_mfma_f32_16x16x32_bf16 v[236:239], v[128:131], v[116:119], v[236:239]
    v_mfma_f32_16x16x32_bf16 v[240:243], v[128:131], v[120:123], v[240:243]
    s_nop 7
    s_mul_i32 s38, s18, 14336
    v_add_u32 v8, s38, v4
    ds_write_b128 v8, v[188:191] offset:0
    ds_write_b128 v8, v[192:195] offset:1024
    ds_write_b128 v8, v[196:199] offset:2048
    ds_write_b128 v8, v[200:203] offset:3072
    ds_write_b128 v8, v[204:207] offset:4096
    ds_write_b128 v8, v[208:211] offset:5120
    ds_write_b128 v8, v[212:215] offset:6144
    ds_write_b128 v8, v[216:219] offset:7168
    ds_write_b128 v8, v[220:223] offset:8192
    ds_write_b128 v8, v[224:227] offset:9216
    ds_write_b128 v8, v[228:231] offset:10240
    ds_write_b128 v8, v[232:235] offset:11264
    ds_write_b128 v8, v[236:239] offset:12288
    ds_write_b128 v8, v[240:243] offset:13312
    s_waitcnt lgkmcnt(0)
    s_barrier
    s_lshl_b32 s38, s18, 10
    v_add_u32 v8, s38, v4
    ds_read_b128 v[16:19], v8 offset:0
    ds_read_b128 v[20:23], v8 offset:14336
    ds_read_b128 v[24:27], v8 offset:28672
    ds_read_b128 v[28:31], v8 offset:43008
    s_add_u32 s30, s18, 0
    s_lshr_b32 s31, s30, 1
    s_and_b32 s30, s30, 1
    s_mul_i32 s32, s20, 7
    s_add_u32 s31, s31, s32
    s_lshl_b32 s32, s21, 1
    s_add_u32 s30, s30, s32
    s_mul_i32 s32, s30, 28
    s_add_u32 s32, s32, s31
    s_lshl_b32 s32, s32, 9
    s_add_u32 s32, s32, 0x5a9d000
    s_add_u32 s34, s16, s32
    s_addc_u32 s35, s17, 0
    v_lshlrev_b32 v6, 3, v1
    global_load_dwordx2 v[40:41], v6, s[34:35]
    s_mul_i32 s32, s30, 14336
    s_lshl_b32 s33, s31, 5
    s_add_u32 s32, s32, s33
    v_mul_u32_u24 v9, 896, v3
    v_lshl_add_u32 v9, v2, 3, v9
    v_add_u32 v9, s32, v9
    s_waitcnt lgkmcnt(0)
    v_pk_add_f32 v[16:17], v[16:17], v[20:21]
    v_pk_add_f32 v[18:19], v[18:19], v[22:23]
    v_pk_add_f32 v[24:25], v[24:25], v[28:29]
    v_pk_add_f32 v[26:27], v[26:27], v[30:31]
    v_pk_add_f32 v[16:17], v[16:17], v[24:25]
    v_pk_add_f32 v[18:19], v[18:19], v[26:27]
    s_waitcnt vmcnt(0)
    v_cvt_pk_bf16_f32 v16, v16, v16
    v_lshlrev_b32 v16, 16, v16
    v_lshlrev_b32 v42, 16, v40
    v_add_f32 v16, v16, v42
    v_cvt_pk_bf16_f32 v17, v17, v17
    v_lshlrev_b32 v17, 16, v17
    v_and_b32 v42, 0xffff0000, v40
    v_add_f32 v17, v17, v42
    v_cvt_pk_bf16_f32 v18, v18, v18
    v_lshlrev_b32 v18, 16, v18
    v_lshlrev_b32 v42, 16, v41
    v_add_f32 v18, v18, v42
    v_cvt_pk_bf16_f32 v19, v19, v19
    v_lshlrev_b32 v19, 16, v19
    v_and_b32 v42, 0xffff0000, v41
    v_add_f32 v19, v19, v42
    v_cvt_pk_bf16_f32 v44, v16, v17
    v_cvt_pk_bf16_f32 v45, v18, v19
    global_store_dwordx2 v9, v[44:45], s[4:5]
    s_nop 1
.chain_kernel_sk104:
    ds_read_b128 v[16:19], v8 offset:4096
    ds_read_b128 v[20:23], v8 offset:18432
    ds_read_b128 v[24:27], v8 offset:32768
    ds_read_b128 v[28:31], v8 offset:47104
    s_add_u32 s30, s18, 4
    s_lshr_b32 s31, s30, 1
    s_and_b32 s30, s30, 1
    s_mul_i32 s32, s20, 7
    s_add_u32 s31, s31, s32
    s_lshl_b32 s32, s21, 1
    s_add_u32 s30, s30, s32
    s_mul_i32 s32, s30, 28
    s_add_u32 s32, s32, s31
    s_lshl_b32 s32, s32, 9
    s_add_u32 s32, s32, 0x5a9d000
    s_add_u32 s34, s16, s32
    s_addc_u32 s35, s17, 0
    v_lshlrev_b32 v6, 3, v1
    global_load_dwordx2 v[40:41], v6, s[34:35]
    s_mul_i32 s32, s30, 14336
    s_lshl_b32 s33, s31, 5
    s_add_u32 s32, s32, s33
    v_mul_u32_u24 v9, 896, v3
    v_lshl_add_u32 v9, v2, 3, v9
    v_add_u32 v9, s32, v9
    s_waitcnt lgkmcnt(0)
    v_pk_add_f32 v[16:17], v[16:17], v[20:21]
    v_pk_add_f32 v[18:19], v[18:19], v[22:23]
    v_pk_add_f32 v[24:25], v[24:25], v[28:29]
    v_pk_add_f32 v[26:27], v[26:27], v[30:31]
    v_pk_add_f32 v[16:17], v[16:17], v[24:25]
    v_pk_add_f32 v[18:19], v[18:19], v[26:27]
    s_waitcnt vmcnt(0)
    v_cvt_pk_bf16_f32 v16, v16, v16
    v_lshlrev_b32 v16, 16, v16
    v_lshlrev_b32 v42, 16, v40
    v_add_f32 v16, v16, v42
    v_cvt_pk_bf16_f32 v17, v17, v17
    v_lshlrev_b32 v17, 16, v17
    v_and_b32 v42, 0xffff0000, v40
    v_add_f32 v17, v17, v42
    v_cvt_pk_bf16_f32 v18, v18, v18
    v_lshlrev_b32 v18, 16, v18
    v_lshlrev_b32 v42, 16, v41
    v_add_f32 v18, v18, v42
    v_cvt_pk_bf16_f32 v19, v19, v19
    v_lshlrev_b32 v19, 16, v19
    v_and_b32 v42, 0xffff0000, v41
    v_add_f32 v19, v19, v42
    v_cvt_pk_bf16_f32 v44, v16, v17
    v_cvt_pk_bf16_f32 v45, v18, v19
    global_store_dwordx2 v9, v[44:45], s[4:5]
    s_nop 1
.chain_kernel_sk105:
    ds_read_b128 v[16:19], v8 offset:8192
    ds_read_b128 v[20:23], v8 offset:22528
    ds_read_b128 v[24:27], v8 offset:36864
    ds_read_b128 v[28:31], v8 offset:51200
    s_add_u32 s30, s18, 8
    s_lshr_b32 s31, s30, 1
    s_and_b32 s30, s30, 1
    s_mul_i32 s32, s20, 7
    s_add_u32 s31, s31, s32
    s_lshl_b32 s32, s21, 1
    s_add_u32 s30, s30, s32
    s_mul_i32 s32, s30, 28
    s_add_u32 s32, s32, s31
    s_lshl_b32 s32, s32, 9
    s_add_u32 s32, s32, 0x5a9d000
    s_add_u32 s34, s16, s32
    s_addc_u32 s35, s17, 0
    v_lshlrev_b32 v6, 3, v1
    global_load_dwordx2 v[40:41], v6, s[34:35]
    s_mul_i32 s32, s30, 14336
    s_lshl_b32 s33, s31, 5
    s_add_u32 s32, s32, s33
    v_mul_u32_u24 v9, 896, v3
    v_lshl_add_u32 v9, v2, 3, v9
    v_add_u32 v9, s32, v9
    s_waitcnt lgkmcnt(0)
    v_pk_add_f32 v[16:17], v[16:17], v[20:21]
    v_pk_add_f32 v[18:19], v[18:19], v[22:23]
    v_pk_add_f32 v[24:25], v[24:25], v[28:29]
    v_pk_add_f32 v[26:27], v[26:27], v[30:31]
    v_pk_add_f32 v[16:17], v[16:17], v[24:25]
    v_pk_add_f32 v[18:19], v[18:19], v[26:27]
    s_waitcnt vmcnt(0)
    v_cvt_pk_bf16_f32 v16, v16, v16
    v_lshlrev_b32 v16, 16, v16
    v_lshlrev_b32 v42, 16, v40
    v_add_f32 v16, v16, v42
    v_cvt_pk_bf16_f32 v17, v17, v17
    v_lshlrev_b32 v17, 16, v17
    v_and_b32 v42, 0xffff0000, v40
    v_add_f32 v17, v17, v42
    v_cvt_pk_bf16_f32 v18, v18, v18
    v_lshlrev_b32 v18, 16, v18
    v_lshlrev_b32 v42, 16, v41
    v_add_f32 v18, v18, v42
    v_cvt_pk_bf16_f32 v19, v19, v19
    v_lshlrev_b32 v19, 16, v19
    v_and_b32 v42, 0xffff0000, v41
    v_add_f32 v19, v19, v42
    v_cvt_pk_bf16_f32 v44, v16, v17
    v_cvt_pk_bf16_f32 v45, v18, v19
    global_store_dwordx2 v9, v[44:45], s[4:5]
    s_nop 1
.chain_kernel_sk106:
    s_cmp_ge_u32 s18, 2
    s_cbranch_scc1 .chain_kernel_sk107
    ds_read_b128 v[16:19], v8 offset:12288
    ds_read_b128 v[20:23], v8 offset:26624
    ds_read_b128 v[24:27], v8 offset:40960
    ds_read_b128 v[28:31], v8 offset:55296
    s_add_u32 s30, s18, 12
    s_lshr_b32 s31, s30, 1
    s_and_b32 s30, s30, 1
    s_mul_i32 s32, s20, 7
    s_add_u32 s31, s31, s32
    s_lshl_b32 s32, s21, 1
    s_add_u32 s30, s30, s32
    s_mul_i32 s32, s30, 28
    s_add_u32 s32, s32, s31
    s_lshl_b32 s32, s32, 9
    s_add_u32 s32, s32, 0x5a9d000
    s_add_u32 s34, s16, s32
    s_addc_u32 s35, s17, 0
    v_lshlrev_b32 v6, 3, v1
    global_load_dwordx2 v[40:41], v6, s[34:35]
    s_mul_i32 s32, s30, 14336
    s_lshl_b32 s33, s31, 5
    s_add_u32 s32, s32, s33
    v_mul_u32_u24 v9, 896, v3
    v_lshl_add_u32 v9, v2, 3, v9
    v_add_u32 v9, s32, v9
    s_waitcnt lgkmcnt(0)
    v_pk_add_f32 v[16:17], v[16:17], v[20:21]
    v_pk_add_f32 v[18:19], v[18:19], v[22:23]
    v_pk_add_f32 v[24:25], v[24:25], v[28:29]
    v_pk_add_f32 v[26:27], v[26:27], v[30:31]
    v_pk_add_f32 v[16:17], v[16:17], v[24:25]
    v_pk_add_f32 v[18:19], v[18:19], v[26:27]
    s_waitcnt vmcnt(0)
    v_cvt_pk_bf16_f32 v16, v16, v16
    v_lshlrev_b32 v16, 16, v16
    v_lshlrev_b32 v42, 16, v40
    v_add_f32 v16, v16, v42
    v_cvt_pk_bf16_f32 v17, v17, v17
    v_lshlrev_b32 v17, 16, v17
    v_and_b32 v42, 0xffff0000, v40
    v_add_f32 v17, v17, v42
    v_cvt_pk_bf16_f32 v18, v18, v18
    v_lshlrev_b32 v18, 16, v18
    v_lshlrev_b32 v42, 16, v41
    v_add_f32 v18, v18, v42
    v_cvt_pk_bf16_f32 v19, v19, v19
    v_lshlrev_b32 v19, 16, v19
    v_and_b32 v42, 0xffff0000, v41
    v_add_f32 v19, v19, v42
    v_cvt_pk_bf16_f32 v44, v16, v17
    v_cvt_pk_bf16_f32 v45, v18, v19
    global_store_dwordx2 v9, v[44:45], s[4:5]
    s_nop 1
.chain_kernel_sk107:
    s_branch .chain_kernel_fin79
.chain_kernel_ty78:
    s_lshr_b32 s21, s2, 4
    s_and_b32 s20, s2, 15
    s_mul_i32 s22, s21, 28672
    s_add_u32 s22, s22, 0x1000
    s_add_u32 s26, s16, s22
    s_addc_u32 s27, s17, 0
    v_add_u32 v5, 14336, v4
    global_load_dwordx4 v[8:11], v4, s[26:27] offset:0
    global_load_dwordx4 v[12:15], v5, s[26:27] offset:0
    global_load_dwordx4 v[16:19], v4, s[26:27] offset:1024
    global_load_dwordx4 v[20:23], v5, s[26:27] offset:1024
    global_load_dwordx4 v[24:27], v4, s[26:27] offset:2048
    global_load_dwordx4 v[28:31], v5, s[26:27] offset:2048
    global_load_dwordx4 v[32:35], v4, s[26:27] offset:3072
    global_load_dwordx4 v[36:39], v5, s[26:27] offset:3072
    s_mul_i32 s22, s20, 28
    s_mul_i32 s23, s18, 7
    s_add_u32 s22, s22, s23
    s_mul_i32 s22, s22, 14336
    s_add_u32 s22, s22, 0x2099000
    s_add_u32 s24, s16, s22
    s_addc_u32 s25, s17, 0
    s_add_u32 s40, s24, 0x0
    s_addc_u32 s41, s25, 0
    s_add_u32 s42, s24, 0x3800
    s_addc_u32 s43, s25, 0
    s_add_u32 s44, s24, 0x7000
    s_addc_u32 s45, s25, 0
    s_add_u32 s46, s24, 0xa800
    s_addc_u32 s47, s25, 0
    s_add_u32 s48, s24, 0xe000
    s_addc_u32 s49, s25, 0
    s_add_u32 s50, s24, 0x11800
    s_addc_u32 s51, s25, 0
    s_add_u32 s52, s24, 0x15000
    s_addc_u32 s53, s25, 0
    global_load_dwordx4 a[0:3], v4, s[40:41] offset:0
    global_load_dwordx4 a[56:59], v4, s[42:43] offset:0
    global_load_dwordx4 a[112:115], v4, s[44:45] offset:0
    global_load_dwordx4 a[168:171], v4, s[46:47] offset:0
    global_load_dwordx4 a[224:227], v4, s[48:49] offset:0
    global_load_dwordx4 v[144:147], v4, s[50:51] offset:0
    global_load_dwordx4 v[200:203], v4, s[52:53] offset:0
    global_load_dwordx4 a[4:7], v4, s[40:41] offset:1024
    global_load_dwordx4 a[60:63], v4, s[42:43] offset:1024
    global_load_dwordx4 a[116:119], v4, s[44:45] offset:1024
    global_load_dwordx4 a[172:175], v4, s[46:47] offset:1024
    global_load_dwordx4 a[228:231], v4, s[48:49] offset:1024
    global_load_dwordx4 v[148:151], v4, s[50:51] offset:1024
    global_load_dwordx4 v[204:207], v4, s[52:53] offset:1024
    global_load_dwordx4 a[8:11], v4, s[40:41] offset:2048
    global_load_dwordx4 a[64:67], v4, s[42:43] offset:2048
    global_load_dwordx4 a[120:123], v4, s[44:45] offset:2048
    global_load_dwordx4 a[176:179], v4, s[46:47] offset:2048
    global_load_dwordx4 a[232:235], v4, s[48:49] offset:2048
    global_load_dwordx4 v[152:155], v4, s[50:51] offset:2048
    global_load_dwordx4 v[208:211], v4, s[52:53] offset:2048
    global_load_dwordx4 a[12:15], v4, s[40:41] offset:3072
    global_load_dwordx4 a[68:71], v4, s[42:43] offset:3072
    global_load_dwordx4 a[124:127], v4, s[44:45] offset:3072
    global_load_dwordx4 a[180:183], v4, s[46:47] offset:3072
    global_load_dwordx4 a[236:239], v4, s[48:49] offset:3072
    global_load_dwordx4 v[156:159], v4, s[50:51] offset:3072
    global_load_dwordx4 v[212:215], v4, s[52:53] offset:3072
    s_add_u32 s40, s40, 4096
    s_addc_u32 s41, s41, 0
    global_load_dwordx4 a[16:19], v4, s[40:41] offset:0
    s_add_u32 s42, s42, 4096
    s_addc_u32 s43, s43, 0
    global_load_dwordx4 a[72:75], v4, s[42:43] offset:0
    s_add_u32 s44, s44, 4096
    s_addc_u32 s45, s45, 0
    global_load_dwordx4 a[128:131], v4, s[44:45] offset:0
    s_add_u32 s46, s46, 4096
    s_addc_u32 s47, s47, 0
    global_load_dwordx4 a[184:187], v4, s[46:47] offset:0
    s_add_u32 s48, s48, 4096
    s_addc_u32 s49, s49, 0
    global_load_dwordx4 a[240:243], v4, s[48:49] offset:0
    s_add_u32 s50, s50, 4096
    s_addc_u32 s51, s51, 0
    global_load_dwordx4 v[160:163], v4, s[50:51] offset:0
    s_add_u32 s52, s52, 4096
    s_addc_u32 s53, s53, 0
    global_load_dwordx4 v[216:219], v4, s[52:53] offset:0
    global_load_dwordx4 a[20:23], v4, s[40:41] offset:1024
    global_load_dwordx4 a[76:79], v4, s[42:43] offset:1024
    global_load_dwordx4 a[132:135], v4, s[44:45] offset:1024
    global_load_dwordx4 a[188:191], v4, s[46:47] offset:1024
    global_load_dwordx4 a[244:247], v4, s[48:49] offset:1024
    global_load_dwordx4 v[164:167], v4, s[50:51] offset:1024
    global_load_dwordx4 v[220:223], v4, s[52:53] offset:1024
    global_load_dwordx4 a[24:27], v4, s[40:41] offset:2048
    global_load_dwordx4 a[80:83], v4, s[42:43] offset:2048
    global_load_dwordx4 a[136:139], v4, s[44:45] offset:2048
    global_load_dwordx4 a[192:195], v4, s[46:47] offset:2048
    global_load_dwordx4 a[248:251], v4, s[48:49] offset:2048
    global_load_dwordx4 v[168:171], v4, s[50:51] offset:2048
    global_load_dwordx4 v[224:227], v4, s[52:53] offset:2048
    global_load_dwordx4 a[28:31], v4, s[40:41] offset:3072
    global_load_dwordx4 a[84:87], v4, s[42:43] offset:3072
    global_load_dwordx4 a[140:143], v4, s[44:45] offset:3072
    global_load_dwordx4 a[196:199], v4, s[46:47] offset:3072
    global_load_dwordx4 a[252:255], v4, s[48:49] offset:3072
    global_load_dwordx4 v[172:175], v4, s[50:51] offset:3072
    global_load_dwordx4 v[228:231], v4, s[52:53] offset:3072
    s_add_u32 s40, s40, 4096
    s_addc_u32 s41, s41, 0
    global_load_dwordx4 a[32:35], v4, s[40:41] offset:0
    s_add_u32 s42, s42, 4096
    s_addc_u32 s43, s43, 0
    global_load_dwordx4 a[88:91], v4, s[42:43] offset:0
    s_add_u32 s44, s44, 4096
    s_addc_u32 s45, s45, 0
    global_load_dwordx4 a[144:147], v4, s[44:45] offset:0
    s_add_u32 s46, s46, 4096
    s_addc_u32 s47, s47, 0
    global_load_dwordx4 a[200:203], v4, s[46:47] offset:0
    s_add_u32 s48, s48, 4096
    s_addc_u32 s49, s49, 0
    global_load_dwordx4 v[120:123], v4, s[48:49] offset:0
    s_add_u32 s50, s50, 4096
    s_addc_u32 s51, s51, 0
    global_load_dwordx4 v[176:179], v4, s[50:51] offset:0
    s_add_u32 s52, s52, 4096
    s_addc_u32 s53, s53, 0
    global_load_dwordx4 v[232:235], v4, s[52:53] offset:0
    global_load_dwordx4 a[36:39], v4, s[40:41] offset:1024
    global_load_dwordx4 a[92:95], v4, s[42:43] offset:1024
    global_load_dwordx4 a[148:151], v4, s[44:45] offset:1024
    global_load_dwordx4 a[204:207], v4, s[46:47] offset:1024
    global_load_dwordx4 v[124:127], v4, s[48:49] offset:1024
    global_load_dwordx4 v[180:183], v4, s[50:51] offset:1024
    global_load_dwordx4 v[236:239], v4, s[52:53] offset:1024
    global_load_dwordx4 a[40:43], v4, s[40:41] offset:2048
    global_load_dwordx4 a[96:99], v4, s[42:43] offset:2048
    global_load_dwordx4 a[152:155], v4, s[44:45] offset:2048
    global_load_dwordx4 a[208:211], v4, s[46:47] offset:2048
    global_load_dwordx4 v[128:131], v4, s[48:49] offset:2048
    global_load_dwordx4 v[184:187], v4, s[50:51] offset:2048
    global_load_dwordx4 v[240:243], v4, s[52:53] offset:2048
    global_load_dwordx4 a[44:47], v4, s[40:41] offset:3072
    global_load_dwordx4 a[100:103], v4, s[42:43] offset:3072
    global_load_dwordx4 a[156:159], v4, s[44:45] offset:3072
    global_load_dwordx4 a[212:215], v4, s[46:47] offset:3072
    global_load_dwordx4 v[132:135], v4, s[48:49] offset:3072
    global_load_dwordx4 v[188:191], v4, s[50:51] offset:3072
    global_load_dwordx4 v[244:247], v4, s[52:53] offset:3072
    s_add_u32 s40, s40, 4096
    s_addc_u32 s41, s41, 0
    global_load_dwordx4 a[48:51], v4, s[40:41] offset:0
    s_add_u32 s42, s42, 4096
    s_addc_u32 s43, s43, 0
    global_load_dwordx4 a[104:107], v4, s[42:43] offset:0
    s_add_u32 s44, s44, 4096
    s_addc_u32 s45, s45, 0
    global_load_dwordx4 a[160:163], v4, s[44:45] offset:0
    s_add_u32 s46, s46, 4096
    s_addc_u32 s47, s47, 0
    global_load_dwordx4 a[216:219], v4, s[46:47] offset:0
    s_add_u32 s48, s48, 4096
    s_addc_u32 s49, s49, 0
    global_load_dwordx4 v[136:139], v4, s[48:49] offset:0
    s_add_u32 s50, s50, 4096
    s_addc_u32 s51, s51, 0
    global_load_dwordx4 v[192:195], v4, s[50:51] offset:0
    s_add_u32 s52, s52, 4096
    s_addc_u32 s53, s53, 0
    global_load_dwordx4 v[248:251], v4, s[52:53] offset:0
    global_load_dwordx4 a[52:55], v4, s[40:41] offset:1024
    global_load_dwordx4 a[108:111], v4, s[42:43] offset:1024
    global_load_dwordx4 a[164:167], v4, s[44:45] offset:1024
    global_load_dwordx4 a[220:223], v4, s[46:47] offset:1024
    global_load_dwordx4 v[140:143], v4, s[48:49] offset:1024
    global_load_dwordx4 v[196:199], v4, s[50:51] offset:1024
    global_load_dwordx4 v[252:255], v4, s[52:53] offset:1024
    s_lshl_b32 s22, s21, 4
    s_add_u32 s22, s22, s20
    s_mul_i32 s22, s22, 28
    s_add_u32 s22, s22, s23
    s_lshl_b32 s22, s22, 10
    s_add_u32 s22, s22, 0x26b9000
    s_add_u32 s28, s16, s22
    s_addc_u32 s29, s17, 0
    s_add_u32 s26, s26, 4096
    s_addc_u32 s27, s27, 0
    global_load_dwordx4 v[40:43], v4, s[26:27] offset:0
    global_load_dwordx4 v[44:47], v5, s[26:27] offset:0
    s_waitcnt vmcnt(63)
    v_mfma_f32_16x16x32_bf16 v[48:51], v[8:11], a[0:3], 0
    v_mfma_f32_16x16x32_bf16 v[52:55], v[12:15], a[0:3], 0
    v_mfma_f32_16x16x32_bf16 v[56:59], v[8:11], a[56:59], 0
    v_mfma_f32_16x16x32_bf16 v[60:63], v[12:15], a[56:59], 0
    v_mfma_f32_16x16x32_bf16 v[64:67], v[8:11], a[112:115], 0
    v_mfma_f32_16x16x32_bf16 v[68:71], v[12:15], a[112:115], 0
    v_mfma_f32_16x16x32_bf16 v[72:75], v[8:11], a[168:171], 0
    v_mfma_f32_16x16x32_bf16 v[76:79], v[12:15], a[168:171], 0
    v_mfma_f32_16x16x32_bf16 v[80:83], v[8:11], a[224:227], 0
    v_mfma_f32_16x16x32_bf16 v[84:87], v[12:15], a[224:227], 0
    v_mfma_f32_16x16x32_bf16 v[88:91], v[8:11], v[144:147], 0
    v_mfma_f32_16x16x32_bf16 v[92:95], v[12:15], v[144:147], 0
    v_mfma_f32_16x16x32_bf16 v[96:99], v[8:11], v[200:203], 0
    v_mfma_f32_16x16x32_bf16 v[100:103], v[12:15], v[200:203], 0
    global_load_dwordx4 v[8:11], v4, s[26:27] offset:1024
    global_load_dwordx4 v[12:15], v5, s[26:27] offset:1024
    s_waitcnt vmcnt(63)
    v_mfma_f32_16x16x32_bf16 v[48:51], v[16:19], a[4:7], v[48:51]
    v_mfma_f32_16x16x32_bf16 v[52:55], v[20:23], a[4:7], v[52:55]
    v_mfma_f32_16x16x32_bf16 v[56:59], v[16:19], a[60:63], v[56:59]
    v_mfma_f32_16x16x32_bf16 v[60:63], v[20:23], a[60:63], v[60:63]
    v_mfma_f32_16x16x32_bf16 v[64:67], v[16:19], a[116:119], v[64:67]
    v_mfma_f32_16x16x32_bf16 v[68:71], v[20:23], a[116:119], v[68:71]
    v_mfma_f32_16x16x32_bf16 v[72:75], v[16:19], a[172:175], v[72:75]
    v_mfma_f32_16x16x32_bf16 v[76:79], v[20:23], a[172:175], v[76:79]
    v_mfma_f32_16x16x32_bf16 v[80:83], v[16:19], a[228:231], v[80:83]
    v_mfma_f32_16x16x32_bf16 v[84:87], v[20:23], a[228:231], v[84:87]
    v_mfma_f32_16x16x32_bf16 v[88:91], v[16:19], v[148:151], v[88:91]
    v_mfma_f32_16x16x32_bf16 v[92:95], v[20:23], v[148:151], v[92:95]
    v_mfma_f32_16x16x32_bf16 v[96:99], v[16:19], v[204:207], v[96:99]
    v_mfma_f32_16x16x32_bf16 v[100:103], v[20:23], v[204:207], v[100:103]
    global_load_dwordx4 v[16:19], v4, s[26:27] offset:2048
    global_load_dwordx4 v[20:23], v5, s[26:27] offset:2048
    s_waitcnt vmcnt(63)
    v_mfma_f32_16x16x32_bf16 v[48:51], v[24:27], a[8:11], v[48:51]
    v_mfma_f32_16x16x32_bf16 v[52:55], v[28:31], a[8:11], v[52:55]
    v_mfma_f32_16x16x32_bf16 v[56:59], v[24:27], a[64:67], v[56:59]
    v_mfma_f32_16x16x32_bf16 v[60:63], v[28:31], a[64:67], v[60:63]
    v_mfma_f32_16x16x32_bf16 v[64:67], v[24:27], a[120:123], v[64:67]
    v_mfma_f32_16x16x32_bf16 v[68:71], v[28:31], a[120:123], v[68:71]
    v_mfma_f32_16x16x32_bf16 v[72:75], v[24:27], a[176:179], v[72:75]
    v_mfma_f32_16x16x32_bf16 v[76:79], v[28:31], a[176:179], v[76:79]
    v_mfma_f32_16x16x32_bf16 v[80:83], v[24:27], a[232:235], v[80:83]
    v_mfma_f32_16x16x32_bf16 v[84:87], v[28:31], a[232:235], v[84:87]
    v_mfma_f32_16x16x32_bf16 v[88:91], v[24:27], v[152:155], v[88:91]
    v_mfma_f32_16x16x32_bf16 v[92:95], v[28:31], v[152:155], v[92:95]
    v_mfma_f32_16x16x32_bf16 v[96:99], v[24:27], v[208:211], v[96:99]
    v_mfma_f32_16x16x32_bf16 v[100:103], v[28:31], v[208:211], v[100:103]
    global_load_dwordx4 v[24:27], v4, s[26:27] offset:3072
    global_load_dwordx4 v[28:31], v5, s[26:27] offset:3072
    s_waitcnt vmcnt(63)
    v_mfma_f32_16x16x32_bf16 v[48:51], v[32:35], a[12:15], v[48:51]
    v_mfma_f32_16x16x32_bf16 v[52:55], v[36:39], a[12:15], v[52:55]
    v_mfma_f32_16x16x32_bf16 v[56:59], v[32:35], a[68:71], v[56:59]
    v_mfma_f32_16x16x32_bf16 v[60:63], v[36:39], a[68:71], v[60:63]
    v_mfma_f32_16x16x32_bf16 v[64:67], v[32:35], a[124:127], v[64:67]
    v_mfma_f32_16x16x32_bf16 v[68:71], v[36:39], a[124:127], v[68:71]
    v_mfma_f32_16x16x32_bf16 v[72:75], v[32:35], a[180:183], v[72:75]
    v_mfma_f32_16x16x32_bf16 v[76:79], v[36:39], a[180:183], v[76:79]
    v_mfma_f32_16x16x32_bf16 v[80:83], v[32:35], a[236:239], v[80:83]
    v_mfma_f32_16x16x32_bf16 v[84:87], v[36:39], a[236:239], v[84:87]
    v_mfma_f32_16x16x32_bf16 v[88:91], v[32:35], v[156:159], v[88:91]
    v_mfma_f32_16x16x32_bf16 v[92:95], v[36:39], v[156:159], v[92:95]
    v_mfma_f32_16x16x32_bf16 v[96:99], v[32:35], v[212:215], v[96:99]
    v_mfma_f32_16x16x32_bf16 v[100:103], v[36:39], v[212:215], v[100:103]
    s_add_u32 s26, s26, 4096
    s_addc_u32 s27, s27, 0
    global_load_dwordx4 v[32:35], v4, s[26:27] offset:0
    global_load_dwordx4 v[36:39], v5, s[26:27] offset:0
    s_waitcnt vmcnt(8)
    v_mfma_f32_16x16x32_bf16 v[48:51], v[40:43], a[16:19], v[48:51]
    v_mfma_f32_16x16x32_bf16 v[52:55], v[44:47], a[16:19], v[52:55]
    v_mfma_f32_16x16x32_bf16 v[56:59], v[40:43], a[72:75], v[56:59]
    v_mfma_f32_16x16x32_bf16 v[60:63], v[44:47], a[72:75], v[60:63]
    v_mfma_f32_16x16x32_bf16 v[64:67], v[40:43], a[128:131], v[64:67]
    v_mfma_f32_16x16x32_bf16 v[68:71], v[44:47], a[128:131], v[68:71]
    v_mfma_f32_16x16x32_bf16 v[72:75], v[40:43], a[184:187], v[72:75]
    v_mfma_f32_16x16x32_bf16 v[76:79], v[44:47], a[184:187], v[76:79]
    v_mfma_f32_16x16x32_bf16 v[80:83], v[40:43], a[240:243], v[80:83]
    v_mfma_f32_16x16x32_bf16 v[84:87], v[44:47], a[240:243], v[84:87]
    v_mfma_f32_16x16x32_bf16 v[88:91], v[40:43], v[160:163], v[88:91]
    v_mfma_f32_16x16x32_bf16 v[92:95], v[44:47], v[160:163], v[92:95]
    v_mfma_f32_16x16x32_bf16 v[96:99], v[40:43], v[216:219], v[96:99]
    v_mfma_f32_16x16x32_bf16 v[100:103], v[44:47], v[216:219], v[100:103]
    global_load_dwordx4 v[40:43], v4, s[26:27] offset:1024
    global_load_dwordx4 v[44:47], v5, s[26:27] offset:1024
    s_waitcnt vmcnt(8)
    v_mfma_f32_16x16x32_bf16 v[48:51], v[8:11], a[20:23], v[48:51]
    v_mfma_f32_16x16x32_bf16 v[52:55], v[12:15], a[20:23], v[52:55]
    v_mfma_f32_16x16x32_bf16 v[56:59], v[8:11], a[76:79], v[56:59]
    v_mfma_f32_16x16x32_bf16 v[60:63], v[12:15], a[76:79], v[60:63]
    v_mfma_f32_16x16x32_bf16 v[64:67], v[8:11], a[132:135], v[64:67]
    v_mfma_f32_16x16x32_bf16 v[68:71], v[12:15], a[132:135], v[68:71]
    v_mfma_f32_16x16x32_bf16 v[72:75], v[8:11], a[188:191], v[72:75]
    v_mfma_f32_16x16x32_bf16 v[76:79], v[12:15], a[188:191], v[76:79]
    v_mfma_f32_16x16x32_bf16 v[80:83], v[8:11], a[244:247], v[80:83]
    v_mfma_f32_16x16x32_bf16 v[84:87], v[12:15], a[244:247], v[84:87]
    v_mfma_f32_16x16x32_bf16 v[88:91], v[8:11], v[164:167], v[88:91]
    v_mfma_f32_16x16x32_bf16 v[92:95], v[12:15], v[164:167], v[92:95]
    v_mfma_f32_16x16x32_bf16 v[96:99], v[8:11], v[220:223], v[96:99]
    v_mfma_f32_16x16x32_bf16 v[100:103], v[12:15], v[220:223], v[100:103]
    global_load_dwordx4 v[8:11], v4, s[26:27] offset:2048
    global_load_dwordx4 v[12:15], v5, s[26:27] offset:2048
    s_waitcnt vmcnt(8)
    v_mfma_f32_16x16x32_bf16 v[48:51], v[16:19], a[24:27], v[48:51]
    v_mfma_f32_16x16x32_bf16 v[52:55], v[20:23], a[24:27], v[52:55]
    v_mfma_f32_16x16x32_bf16 v[56:59], v[16:19], a[80:83], v[56:59]
    v_mfma_f32_16x16x32_bf16 v[60:63], v[20:23], a[80:83], v[60:63]
    v_mfma_f32_16x16x32_bf16 v[64:67], v[16:19], a[136:139], v[64:67]
    v_mfma_f32_16x16x32_bf16 v[68:71], v[20:23], a[136:139], v[68:71]
    v_mfma_f32_16x16x32_bf16 v[72:75], v[16:19], a[192:195], v[72:75]
    v_mfma_f32_16x16x32_bf16 v[76:79], v[20:23], a[192:195], v[76:79]
    v_mfma_f32_16x16x32_bf16 v[80:83], v[16:19], a[248:251], v[80:83]
    v_mfma_f32_16x16x32_bf16 v[84:87], v[20:23], a[248:251], v[84:87]
    v_mfma_f32_16x16x32_bf16 v[88:91], v[16:19], v[168:171], v[88:91]
    v_mfma_f32_16x16x32_bf16 v[92:95], v[20:23], v[168:171], v[92:95]
    v_mfma_f32_16x16x32_bf16 v[96:99], v[16:19], v[224:227], v[96:99]
    v_mfma_f32_16x16x32_bf16 v[100:103], v[20:23], v[224:227], v[100:103]
    global_load_dwordx4 v[16:19], v4, s[26:27] offset:3072
    global_load_dwordx4 v[20:23], v5, s[26:27] offset:3072
    s_waitcnt vmcnt(8)
    v_mfma_f32_16x16x32_bf16 v[48:51], v[24:27], a[28:31], v[48:51]
    v_mfma_f32_16x16x32_bf16 v[52:55], v[28:31], a[28:31], v[52:55]
    v_mfma_f32_16x16x32_bf16 v[56:59], v[24:27], a[84:87], v[56:59]
    v_mfma_f32_16x16x32_bf16 v[60:63], v[28:31], a[84:87], v[60:63]
    v_mfma_f32_16x16x32_bf16 v[64:67], v[24:27], a[140:143], v[64:67]
    v_mfma_f32_16x16x32_bf16 v[68:71], v[28:31], a[140:143], v[68:71]
    v_mfma_f32_16x16x32_bf16 v[72:75], v[24:27], a[196:199], v[72:75]
    v_mfma_f32_16x16x32_bf16 v[76:79], v[28:31], a[196:199], v[76:79]
    v_mfma_f32_16x16x32_bf16 v[80:83], v[24:27], a[252:255], v[80:83]
    v_mfma_f32_16x16x32_bf16 v[84:87], v[28:31], a[252:255], v[84:87]
    v_mfma_f32_16x16x32_bf16 v[88:91], v[24:27], v[172:175], v[88:91]
    v_mfma_f32_16x16x32_bf16 v[92:95], v[28:31], v[172:175], v[92:95]
    v_mfma_f32_16x16x32_bf16 v[96:99], v[24:27], v[228:231], v[96:99]
    v_mfma_f32_16x16x32_bf16 v[100:103], v[28:31], v[228:231], v[100:103]
    s_add_u32 s26, s26, 4096
    s_addc_u32 s27, s27, 0
    global_load_dwordx4 v[24:27], v4, s[26:27] offset:0
    global_load_dwordx4 v[28:31], v5, s[26:27] offset:0
    s_waitcnt vmcnt(8)
    v_mfma_f32_16x16x32_bf16 v[48:51], v[32:35], a[32:35], v[48:51]
    v_mfma_f32_16x16x32_bf16 v[52:55], v[36:39], a[32:35], v[52:55]
    v_mfma_f32_16x16x32_bf16 v[56:59], v[32:35], a[88:91], v[56:59]
    v_mfma_f32_16x16x32_bf16 v[60:63], v[36:39], a[88:91], v[60:63]
    v_mfma_f32_16x16x32_bf16 v[64:67], v[32:35], a[144:147], v[64:67]
    v_mfma_f32_16x16x32_bf16 v[68:71], v[36:39], a[144:147], v[68:71]
    v_mfma_f32_16x16x32_bf16 v[72:75], v[32:35], a[200:203], v[72:75]
    v_mfma_f32_16x16x32_bf16 v[76:79], v[36:39], a[200:203], v[76:79]
    v_mfma_f32_16x16x32_bf16 v[80:83], v[32:35], v[120:123], v[80:83]
    v_mfma_f32_16x16x32_bf16 v[84:87], v[36:39], v[120:123], v[84:87]
    v_mfma_f32_16x16x32_bf16 v[88:91], v[32:35], v[176:179], v[88:91]
    v_mfma_f32_16x16x32_bf16 v[92:95], v[36:39], v[176:179], v[92:95]
    v_mfma_f32_16x16x32_bf16 v[96:99], v[32:35], v[232:235], v[96:99]
    v_mfma_f32_16x16x32_bf16 v[100:103], v[36:39], v[232:235], v[100:103]
    global_load_dwordx4 v[32:35], v4, s[26:27] offset:1024
    global_load_dwordx4 v[36:39], v5, s[26:27] offset:1024
    s_waitcnt vmcnt(8)
    v_mfma_f32_16x16x32_bf16 v[48:51], v[40:43], a[36:39], v[48:51]
    v_mfma_f32_16x16x32_bf16 v[52:55], v[44:47], a[36:39], v[52:55]
    v_mfma_f32_16x16x32_bf16 v[56:59], v[40:43], a[92:95], v[56:59]
    v_mfma_f32_16x16x32_bf16 v[60:63], v[44:47], a[92:95], v[60:63]
    v_mfma_f32_16x16x32_bf16 v[64:67], v[40:43], a[148:151], v[64:67]
    v_mfma_f32_16x16x32_bf16 v[68:71], v[44:47], a[148:151], v[68:71]
    v_mfma_f32_16x16x32_bf16 v[72:75], v[40:43], a[204:207], v[72:75]
    v_mfma_f32_16x16x32_bf16 v[76:79], v[44:47], a[204:207], v[76:79]
    v_mfma_f32_16x16x32_bf16 v[80:83], v[40:43], v[124:127], v[80:83]
    v_mfma_f32_16x16x32_bf16 v[84:87], v[44:47], v[124:127], v[84:87]
    v_mfma_f32_16x16x32_bf16 v[88:91], v[40:43], v[180:183], v[88:91]
    v_mfma_f32_16x16x32_bf16 v[92:95], v[44:47], v[180:183], v[92:95]
    v_mfma_f32_16x16x32_bf16 v[96:99], v[40:43], v[236:239], v[96:99]
    v_mfma_f32_16x16x32_bf16 v[100:103], v[44:47], v[236:239], v[100:103]
    s_waitcnt vmcnt(6)
    v_mfma_f32_16x16x32_bf16 v[48:51], v[8:11], a[40:43], v[48:51]
    v_mfma_f32_16x16x32_bf16 v[52:55], v[12:15], a[40:43], v[52:55]
    v_mfma_f32_16x16x32_bf16 v[56:59], v[8:11], a[96:99], v[56:59]
    v_mfma_f32_16x16x32_bf16 v[60:63], v[12:15], a[96:99], v[60:63]
    v_mfma_f32_16x16x32_bf16 v[64:67], v[8:11], a[152:155], v[64:67]
    v_mfma_f32_16x16x32_bf16 v[68:71], v[12:15], a[152:155], v[68:71]
    v_mfma_f32_16x16x32_bf16 v[72:75], v[8:11], a[208:211], v[72:75]
    v_mfma_f32_16x16x32_bf16 v[76:79], v[12:15], a[208:211], v[76:79]
    v_mfma_f32_16x16x32_bf16 v[80:83], v[8:11], v[128:131], v[80:83]
    v_mfma_f32_16x16x32_bf16 v[84:87], v[12:15], v[128:131], v[84:87]
    v_mfma_f32_16x16x32_bf16 v[88:91], v[8:11], v[184:187], v[88:91]
    v_mfma_f32_16x16x32_bf16 v[92:95], v[12:15], v[184:187], v[92:95]
    v_mfma_f32_16x16x32_bf16 v[96:99], v[8:11], v[240:243], v[96:99]
    v_mfma_f32_16x16x32_bf16 v[100:103], v[12:15], v[240:243], v[100:103]
    s_waitcnt vmcnt(4)
    v_mfma_f32_16x16x32_bf16 v[48:51], v[16:19], a[44:47], v[48:51]
    v_mfma_f32_16x16x32_bf16 v[52:55], v[20:23], a[44:47], v[52:55]
    v_mfma_f32_16x16x32_bf16 v[56:59], v[16:19], a[100:103], v[56:59]
    v_mfma_f32_16x16x32_bf16 v[60:63], v[20:23], a[100:103], v[60:63]
    v_mfma_f32_16x16x32_bf16 v[64:67], v[16:19], a[156:159], v[64:67]
    v_mfma_f32_16x16x32_bf16 v[68:71], v[20:23], a[156:159], v[68:71]
    v_mfma_f32_16x16x32_bf16 v[72:75], v[16:19], a[212:215], v[72:75]
    v_mfma_f32_16x16x32_bf16 v[76:79], v[20:23], a[212:215], v[76:79]
    v_mfma_f32_16x16x32_bf16 v[80:83], v[16:19], v[132:135], v[80:83]
    v_mfma_f32_16x16x32_bf16 v[84:87], v[20:23], v[132:135], v[84:87]
    v_mfma_f32_16x16x32_bf16 v[88:91], v[16:19], v[188:191], v[88:91]
    v_mfma_f32_16x16x32_bf16 v[92:95], v[20:23], v[188:191], v[92:95]
    v_mfma_f32_16x16x32_bf16 v[96:99], v[16:19], v[244:247], v[96:99]
    v_mfma_f32_16x16x32_bf16 v[100:103], v[20:23], v[244:247], v[100:103]
    s_waitcnt vmcnt(2)
    v_mfma_f32_16x16x32_bf16 v[48:51], v[24:27], a[48:51], v[48:51]
    v_mfma_f32_16x16x32_bf16 v[52:55], v[28:31], a[48:51], v[52:55]
    v_mfma_f32_16x16x32_bf16 v[56:59], v[24:27], a[104:107], v[56:59]
    v_mfma_f32_16x16x32_bf16 v[60:63], v[28:31], a[104:107], v[60:63]
    v_mfma_f32_16x16x32_bf16 v[64:67], v[24:27], a[160:163], v[64:67]
    v_mfma_f32_16x16x32_bf16 v[68:71], v[28:31], a[160:163], v[68:71]
    v_mfma_f32_16x16x32_bf16 v[72:75], v[24:27], a[216:219], v[72:75]
    v_mfma_f32_16x16x32_bf16 v[76:79], v[28:31], a[216:219], v[76:79]
    v_mfma_f32_16x16x32_bf16 v[80:83], v[24:27], v[136:139], v[80:83]
    v_mfma_f32_16x16x32_bf16 v[84:87], v[28:31], v[136:139], v[84:87]
    v_mfma_f32_16x16x32_bf16 v[88:91], v[24:27], v[192:195], v[88:91]
    v_mfma_f32_16x16x32_bf16 v[92:95], v[28:31], v[192:195], v[92:95]
    v_mfma_f32_16x16x32_bf16 v[96:99], v[24:27], v[248:251], v[96:99]
    v_mfma_f32_16x16x32_bf16 v[100:103], v[28:31], v[248:251], v[100:103]
    s_waitcnt vmcnt(0)
    v_mfma_f32_16x16x32_bf16 v[48:51], v[32:35], a[52:55], v[48:51]
    v_mfma_f32_16x16x32_bf16 v[52:55], v[36:39], a[52:55], v[52:55]
    v_mfma_f32_16x16x32_bf16 v[56:59], v[32:35], a[108:111], v[56:59]
    v_mfma_f32_16x16x32_bf16 v[60:63], v[36:39], a[108:111], v[60:63]
    v_mfma_f32_16x16x32_bf16 v[64:67], v[32:35], a[164:167], v[64:67]
    v_mfma_f32_16x16x32_bf16 v[68:71], v[36:39], a[164:167], v[68:71]
    v_mfma_f32_16x16x32_bf16 v[72:75], v[32:35], a[220:223], v[72:75]
    v_mfma_f32_16x16x32_bf16 v[76:79], v[36:39], a[220:223], v[76:79]
    v_mfma_f32_16x16x32_bf16 v[80:83], v[32:35], v[140:143], v[80:83]
    v_mfma_f32_16x16x32_bf16 v[84:87], v[36:39], v[140:143], v[84:87]
    v_mfma_f32_16x16x32_bf16 v[88:91], v[32:35], v[196:199], v[88:91]
    v_mfma_f32_16x16x32_bf16 v[92:95], v[36:39], v[196:199], v[92:95]
    v_mfma_f32_16x16x32_bf16 v[96:99], v[32:35], v[252:255], v[96:99]
    v_mfma_f32_16x16x32_bf16 v[100:103], v[36:39], v[252:255], v[100:103]
    s_nop 7
    s_add_u32 s38, s28, 0x1000
    s_addc_u32 s39, s29, 0
    v_cvt_pk_bf16_f32 v104, v48, v49
    v_cvt_pk_bf16_f32 v105, v50, v51
    v_cvt_pk_bf16_f32 v106, v52, v53
    v_cvt_pk_bf16_f32 v107, v54, v55
    global_store_dwordx4 v4, v[104:107], s[28:29] offset:0 sc1
    v_cvt_pk_bf16_f32 v108, v56, v57
    v_cvt_pk_bf16_f32 v109, v58, v59
    v_cvt_pk_bf16_f32 v110, v60, v61
    v_cvt_pk_bf16_f32 v111, v62, v63
    global_store_dwordx4 v4, v[108:111], s[28:29] offset:1024 sc1
    v_cvt_pk_bf16_f32 v112, v64, v65
    v_cvt_pk_bf16_f32 v113, v66, v67
    v_cvt_pk_bf16_f32 v114, v68, v69
    v_cvt_pk_bf16_f32 v115, v70, v71
    global_store_dwordx4 v4, v[112:115], s[28:29] offset:2048 sc1
    v_cvt_pk_bf16_f32 v116, v72, v73
    v_cvt_pk_bf16_f32 v117, v74, v75
    v_cvt_pk_bf16_f32 v118, v76, v77
    v_cvt_pk_bf16_f32 v119, v78, v79
    global_store_dwordx4 v4, v[116:119], s[28:29] offset:3072 sc1
    v_cvt_pk_bf16_f32 v104, v80, v81
    v_cvt_pk_bf16_f32 v105, v82, v83
    v_cvt_pk_bf16_f32 v106, v84, v85
    v_cvt_pk_bf16_f32 v107, v86, v87
    global_store_dwordx4 v4, v[104:107], s[38:39] offset:0 sc1
    v_cvt_pk_bf16_f32 v108, v88, v89
    v_cvt_pk_bf16_f32 v109, v90, v91
    v_cvt_pk_bf16_f32 v110, v92, v93
    v_cvt_pk_bf16_f32 v111, v94, v95
    global_store_dwordx4 v4, v[108:111], s[38:39] offset:1024 sc1
    v_cvt_pk_bf16_f32 v112, v96, v97
    v_cvt_pk_bf16_f32 v113, v98, v99
    v_cvt_pk_bf16_f32 v114, v100, v101
    v_cvt_pk_bf16_f32 v115, v102, v103
    global_store_dwordx4 v4, v[112:115], s[38:39] offset:2048 sc1
    s_add_u32 s28, s28, 458752
    s_addc_u32 s29, s29, 0
    s_nop 1
.chain_kernel_fin79:
    s_add_u32 s46, s16, 0x0
    s_addc_u32 s47, s17, 0
    s_waitcnt vmcnt(0)
    s_barrier
    s_cmp_lg_u32 s18, 0
    s_cbranch_scc1 .chain_kernel_work7
    s_cmp_eq_u32 s92, 0
    s_cbranch_scc1 .chain_kernel_work7
    s_mov_b64 exec, 1
    v_mov_b32 v10, s92
    v_mov_b32 v11, 1
    global_atomic_add v10, v11, s[46:47] sc1
    s_mov_b64 exec, -1
    s_branch .chain_kernel_work7
.chain_kernel_end1:
.chain_kernel_end22:
    s_endpgm
.section .rodata,"a"
.p2align 6
.amdhsa_kernel prep_kernel
  .amdhsa_next_free_vgpr 200
  .amdhsa_next_free_sgpr 100
  .amdhsa_accum_offset 200
  .amdhsa_group_segment_fixed_size 0
  .amdhsa_kernarg_size 112
  .amdhsa_user_sgpr_count 2
  .amdhsa_user_sgpr_kernarg_segment_ptr 1
  .amdhsa_system_sgpr_workgroup_id_x 1
  .amdhsa_float_denorm_mode_32 3
  .amdhsa_float_denorm_mode_16_64 3
.end_amdhsa_kernel
.p2align 6
.amdhsa_kernel fold_kernel
  .amdhsa_next_free_vgpr 192
  .amdhsa_next_free_sgpr 100
  .amdhsa_accum_offset 192
  .amdhsa_group_segment_fixed_size 0
  .amdhsa_kernarg_size 112
  .amdhsa_user_sgpr_count 2
  .amdhsa_user_sgpr_kernarg_segment_ptr 1
  .amdhsa_system_sgpr_workgroup_id_x 1
  .amdhsa_float_denorm_mode_32 3
  .amdhsa_float_denorm_mode_16_64 3
.end_amdhsa_kernel
.p2align 6
.amdhsa_kernel chain_kernel
  .amdhsa_next_free_vgpr 512
  .amdhsa_next_free_sgpr 100
  .amdhsa_accum_offset 256
  .amdhsa_group_segment_fixed_size 0
  .amdhsa_kernarg_size 112
  .amdhsa_user_sgpr_count 2
  .amdhsa_user_sgpr_kernarg_segment_ptr 1
  .amdhsa_system_sgpr_workgroup_id_x 1
  .amdhsa_float_denorm_mode_32 3
  .amdhsa_float_denorm_mode_16_64 3
.end_amdhsa_kernel
```
